```python
import torch

def _softmax(x, axis=-1):
    return torch.softmax(x, dim=axis)
def _gelu(x):
    return torch.nn.functional.gelu(x, approximate="tanh")
def _silu(x):
    return torch.nn.functional.silu(x)
def _sigmoid(x):
    return torch.sigmoid(x)
def _layernorm(x, axis=-1, eps=1e-5):
    m = x.mean(dim=axis, keepdim=True)
    v = x.var(dim=axis, keepdim=True, unbiased=False)
    return (x - m) / torch.sqrt(v + eps)
def _scatter_add(tgt, idx, src, axis=0):
    return tgt.clone().index_add_(axis, idx, src)
def _segment_sum(src, seg, n):
    out = torch.zeros((n,) + src.shape[1:], dtype=src.dtype)
    return out.index_add_(0, seg, src)
def _pad(x, pw):
    flat = tuple(v for pair in reversed(pw) for v in pair)
    return torch.nn.functional.pad(x, flat)

kernel_name = 'concat_heads__gqa_block_cached__mha_block_cached__near_ridge'

def setup_inputs():

    _w = (lambda a: (lambda t: t.to(torch.bfloat16) if t.is_floating_point() else t)(torch.as_tensor(a)))
    def _A_setup():
        B, Sq, D = 8, 192, 640
        Hq, Hkv, Sk, Dh = 32, 32, 512, 128
        assert Hq % Hkv == 0, (Hq, Hkv)
        return {
            "x": _w((lambda *s: torch.randn(*s, dtype=torch.bfloat16) * 0.8)(B, Sq, D)),
            "k_cache": _w((lambda *s: torch.randn(*s, dtype=torch.bfloat16) * 0.8)(B, Hkv, Sk, Dh)),
            "v_cache": _w((lambda *s: torch.randn(*s, dtype=torch.bfloat16) * 0.05)(B, Hkv, Sk, Dh)),
            "wq": _w((lambda *s: torch.randn(*s, dtype=torch.bfloat16) * 0.8)(D, Hq * Dh) * (D ** -0.5)),
            "wo": _w((lambda *s: torch.randn(*s, dtype=torch.bfloat16) * 0.05)(Hq * Dh, D) * ((Hq * Dh) ** -0.5)),
        }
    _A_in = _A_setup()

    def _B_setup():
        B, Sq, D = 8, 192, 640
        H, Sk, Dh = 32, 512, 128
        return {
            "x": _w((lambda *s: torch.randn(*s, dtype=torch.bfloat16) * 0.8)(B, Sq, D)),
            "k_cache": _w((lambda *s: torch.randn(*s, dtype=torch.bfloat16) * 0.8)(B, H, Sk, Dh)),
            "v_cache": _w((lambda *s: torch.randn(*s, dtype=torch.bfloat16) * 0.05)(B, H, Sk, Dh)),
            "wq": _w((lambda *s: torch.randn(*s, dtype=torch.bfloat16) * 0.8)(D, H * Dh) * (D ** -0.5)),
            "wo": _w((lambda *s: torch.randn(*s, dtype=torch.bfloat16) * 0.05)(H * Dh, D) * ((H * Dh) ** -0.5)),
        }
    _B_in = _B_setup()

    return {
        "A_x": _A_in["x"],
        "A_k_cache": _A_in["k_cache"],
        "A_v_cache": _A_in["v_cache"],
        "A_wq": _A_in["wq"],
        "A_wo": _A_in["wo"],
        "B_x": _B_in["x"],
        "B_k_cache": _B_in["k_cache"],
        "B_v_cache": _B_in["v_cache"],
        "B_wq": _B_in["wq"],
        "B_wo": _B_in["wo"],
    }

def reference(A_x, A_k_cache, A_v_cache, A_wq, A_wo, B_x, B_k_cache, B_v_cache, B_wq, B_wo):
    def _A_ref(x, k_cache, v_cache, wq, wo):
        B, Sq, D = x.shape
        Hq, Dh = 32, 128
        Hkv = k_cache.shape[1]
        rep = Hq // Hkv
        q = (lambda x, *d: x.permute(*d))((x @ wq).reshape(B, Sq, Hq, Dh), 0, 2, 1, 3)
        k = (lambda x, n, axis: torch.repeat_interleave(x, n, dim=axis))(k_cache, rep, axis=1)
        v = (lambda x, n, axis: torch.repeat_interleave(x, n, dim=axis))(v_cache, rep, axis=1)
        scores = torch.einsum("bhqd,bhkd->bhqk", q, k) * (Dh ** -0.5)
        p = _softmax(scores, axis=-1)
        o = torch.einsum("bhqk,bhkd->bhqd", p, v)
        return (lambda x, *d: x.permute(*d))(o, 0, 2, 1, 3).reshape(B, Sq, Hq * Dh) @ wo

    def _B_ref(x, k_cache, v_cache, wq, wo):
        B, Sq, D = x.shape
        H, Dh = 32, 128
        q = (lambda x, *d: x.permute(*d))((x @ wq).reshape(B, Sq, H, Dh), 0, 2, 1, 3)
        scores = torch.einsum("bhqd,bhkd->bhqk", q, k_cache) * (Dh ** -0.5)
        p = _softmax(scores, axis=-1)
        o = torch.einsum("bhqk,bhkd->bhqd", p, v_cache)
        return (lambda x, *d: x.permute(*d))(o, 0, 2, 1, 3).reshape(B, Sq, H * Dh) @ wo

    a = _A_ref(A_x, A_k_cache, A_v_cache, A_wq, A_wo)
    b = _B_ref(B_x, B_k_cache, B_v_cache, B_wq, B_wo)
    return torch.concatenate([a, b], axis=-1)
```

```asm
; @launch kernel=attn_kernel grid=(256,1,1) block=(768,1,1) lds=163840
; @launch kernel=oproj_kernel grid=(256,1,1) block=(256,1,1) lds=126976
.amdgcn_target "amdgcn-amd-amdhsa--gfx950"
.text
.globl attn_kernel
.p2align 8
.type attn_kernel,@function
attn_kernel:
    s_cmp_ge_u32 s2, 256
    s_cbranch_scc1 L_k1_end
    s_bfe_u32 s3, s2, 0x10002
    s_lshr_b32 s4, s2, 5
    s_and_b32 s5, s2, 3
    s_lshl_b32 s5, s5, 2
    s_bfe_u32 s64, s2, 0x20003
    s_add_u32 s5, s5, s64
    s_mul_i32 s64, s3, 40
    s_add_u32 s8, s0, s64
    s_addc_u32 s9, s1, 0
    s_load_dwordx8 s[12:19], s[8:9], 0
    s_load_dwordx2 s[10:11], s[0:1], 96
    s_lshr_b32 s65, s2, 7
    s_mul_i32 s64, s65, 40
    s_add_u32 s8, s0, s64
    s_addc_u32 s9, s1, 0
    s_load_dwordx2 s[46:47], s[8:9], 32
    v_lshrrev_b32 v1, 6, v0
    v_and_b32 v0, 63, v0
    s_nop 0
    v_readfirstlane_b32 s6, v1
    s_nop 3
    s_cmp_ge_u32 s6, 6
    s_cselect_b32 s7, 1, 0
    s_mul_i32 s64, s7, 6
    s_sub_u32 s44, s6, s64
    s_lshr_b32 s68, s6, 2
    s_mov_b32 s70, 0x3e0293ee
    s_mov_b32 s71, 0x3e0293ee
    s_waitcnt lgkmcnt(0)
    s_mov_b32 s20, s12
    s_and_b32 s21, s13, 0xffff
    s_mov_b32 s22, 0x1e0000
    s_mov_b32 s23, 0x00020000
    s_mov_b32 s24, s14
    s_and_b32 s25, s15, 0xffff
    s_mov_b32 s26, 0x2000000
    s_mov_b32 s27, 0x00020000
    s_mov_b32 s28, s16
    s_and_b32 s29, s17, 0xffff
    s_mov_b32 s30, 0x2000000
    s_mov_b32 s31, 0x00020000
    s_mov_b32 s32, s18
    s_and_b32 s33, s19, 0xffff
    s_mov_b32 s34, 0x500000
    s_mov_b32 s35, 0x00020000
    s_mov_b32 s40, s10
    s_and_b32 s41, s11, 0xffff
    s_mov_b32 s42, 0x10000000
    s_mov_b32 s43, 0x00020000
    s_mov_b32 s36, s46
    s_and_b32 s37, s47, 0xffff
    s_mov_b32 s38, 0x500000
    s_mov_b32 s39, 0x00020000
    v_and_b32 v1, 31, v0
    v_lshrrev_b32 v2, 5, v0
    v_bfe_u32 v3, v0, 4, 1
    v_bfe_u32 v4, v0, 2, 2
    v_and_b32 v5, 3, v0
    s_cmp_eq_u32 s68, 0
    s_cselect_b32 s48, s20, s32
    s_cselect_b32 s49, s21, s33
    s_cselect_b32 s50, s22, s34
    s_mov_b32 s51, 0x00020000
    s_mov_b32 s64, 8192
    s_cselect_b32 s57, 20480, s64
    s_cselect_b32 s58, 64, 262144
    s_mov_b32 s64, 1088
    s_cselect_b32 s60, 1024, s64
    s_mul_i32 s64, s4, 192
    s_mul_i32 s65, s6, 48
    s_add_u32 s64, s64, s65
    s_mul_i32 s64, s64, 1280
    s_mul_i32 s65, s6, 3072
    s_add_u32 s65, s65, 69632
    s_sub_u32 s66, s6, 4
    s_lshl_b32 s67, s66, 16
    s_lshl_b32 s98, s5, 9
    s_add_u32 s67, s67, s98
    s_mul_i32 s66, s66, 4352
    s_add_u32 s66, s66, 81920
    s_cmp_eq_u32 s68, 0
    s_cselect_b32 s56, s64, s67
    s_cselect_b32 s59, s65, s66
    v_lshrrev_b32 v6, 2, v0
    v_bfe_u32 v7, v0, 4, 2
    v_xor_b32 v7, v5, v7
    v_mul_u32_u24 v6, 1280, v6
    v_lshl_add_u32 v6, v7, 4, v6
    v_lshlrev_b32 v7, 15, v2
    v_lshl_add_u32 v7, v1, 4, v7
    s_cselect_b64 vcc, -1, 0
    v_cndmask_b32 v147, v7, v6, vcc
    s_sub_u32 s64, s6, 8
    s_and_b32 s65, s64, 1
    s_lshl_b32 s66, s4, 5
    s_lshl_b32 s67, s5, 1
    s_add_u32 s66, s66, s67
    s_add_u32 s66, s66, s65
    s_lshl_b32 s61, s66, 17
    s_mul_i32 s63, s64, 8704
    s_and_b32 s65, s2, 127
    s_mul_i32 s47, s65, 40960
    s_lshl_b32 s66, s64, 8
    s_add_u32 s47, s47, s66
    s_lshr_b32 s66, s2, 7
    s_lshl_b32 s66, s66, 10
    s_add_u32 s66, s66, s65
    s_mul_i32 s66, s66, 5120
    s_add_u32 s46, s66, 0x1800000
    s_lshl_b32 s45, s64, 3
    s_cmp_lt_u32 s6, 10
    s_cselect_b32 s52, s24, s28
    s_cselect_b32 s53, s25, s29
    s_cselect_b32 s54, s26, s30
    s_mov_b32 s55, 0x00020000
    v_lshrrev_b32 v6, 4, v0
    v_and_b32 v7, 15, v0
    v_xor_b32 v8, v7, v6
    v_lshlrev_b32 v8, 4, v8
    v_lshl_add_u32 v8, v6, 8, v8
    v_lshlrev_b32 v7, 4, v7
    v_mul_u32_u24 v9, 5120, v6
    v_add_u32 v148, v9, v7
    v_lshl_add_u32 v7, v6, 10, v7
    s_cselect_b64 vcc, -1, 0
    v_cndmask_b32 v163, v7, v8, vcc
    v_mul_u32_u24 v151, 128, v0
    s_cmp_ge_u32 s68, 2
    s_cbranch_scc1 L_qd_0_e
    s_mov_b32 s64, s56
    s_add_u32 s65, s59, 0
    s_cmp_eq_u32 s68, 0
    s_cbranch_scc0 L_qd_0_w
    s_mov_b32 m0, s65
    s_nop 0
    buffer_load_dwordx4 v147, s[48:51], s64 offen lds
    s_add_u32 s64, s64, s57
    s_add_u32 s65, s65, s60
    s_mov_b32 m0, s65
    s_nop 0
    buffer_load_dwordx4 v147, s[48:51], s64 offen lds
    s_add_u32 s64, s64, s57
    s_add_u32 s65, s65, s60
    s_mov_b32 m0, s65
    s_nop 0
    buffer_load_dwordx4 v147, s[48:51], s64 offen lds
    s_branch L_qd_0_x
L_qd_0_w:
    s_mov_b32 m0, s65
    s_nop 0
    buffer_load_dwordx4 v147, s[48:51], s64 offen lds
    s_add_u32 s64, s64, s57
    s_add_u32 s65, s65, s60
    s_mov_b32 m0, s65
    s_nop 0
    buffer_load_dwordx4 v147, s[48:51], s64 offen lds
    s_add_u32 s64, s64, s57
    s_add_u32 s65, s65, s60
    s_mov_b32 m0, s65
    s_nop 0
    buffer_load_dwordx4 v147, s[48:51], s64 offen lds
    s_add_u32 s64, s64, s57
    s_add_u32 s65, s65, s60
    s_mov_b32 m0, s65
    s_nop 0
    buffer_load_dwordx4 v147, s[48:51], s64 offen lds
L_qd_0_x:
    s_add_u32 s56, s56, s58
L_qd_0_e:
    s_cmp_ge_u32 s68, 2
    s_cbranch_scc1 L_qd_1_e
    s_mov_b32 s64, s56
    s_add_u32 s65, s59, 29696
    s_cmp_eq_u32 s68, 0
    s_cbranch_scc0 L_qd_1_w
    s_mov_b32 m0, s65
    s_nop 0
    buffer_load_dwordx4 v147, s[48:51], s64 offen lds
    s_add_u32 s64, s64, s57
    s_add_u32 s65, s65, s60
    s_mov_b32 m0, s65
    s_nop 0
    buffer_load_dwordx4 v147, s[48:51], s64 offen lds
    s_add_u32 s64, s64, s57
    s_add_u32 s65, s65, s60
    s_mov_b32 m0, s65
    s_nop 0
    buffer_load_dwordx4 v147, s[48:51], s64 offen lds
    s_branch L_qd_1_x
L_qd_1_w:
    s_mov_b32 m0, s65
    s_nop 0
    buffer_load_dwordx4 v147, s[48:51], s64 offen lds
    s_add_u32 s64, s64, s57
    s_add_u32 s65, s65, s60
    s_mov_b32 m0, s65
    s_nop 0
    buffer_load_dwordx4 v147, s[48:51], s64 offen lds
    s_add_u32 s64, s64, s57
    s_add_u32 s65, s65, s60
    s_mov_b32 m0, s65
    s_nop 0
    buffer_load_dwordx4 v147, s[48:51], s64 offen lds
    s_add_u32 s64, s64, s57
    s_add_u32 s65, s65, s60
    s_mov_b32 m0, s65
    s_nop 0
    buffer_load_dwordx4 v147, s[48:51], s64 offen lds
L_qd_1_x:
    s_add_u32 s56, s56, s58
L_qd_1_e:
    s_cmp_ge_u32 s68, 2
    s_cbranch_scc1 L_qd_2_e
    s_mov_b32 s64, s56
    s_add_u32 s65, s59, 59392
    s_cmp_eq_u32 s68, 0
    s_cbranch_scc0 L_qd_2_w
    s_mov_b32 m0, s65
    s_nop 0
    buffer_load_dwordx4 v147, s[48:51], s64 offen lds
    s_add_u32 s64, s64, s57
    s_add_u32 s65, s65, s60
    s_mov_b32 m0, s65
    s_nop 0
    buffer_load_dwordx4 v147, s[48:51], s64 offen lds
    s_add_u32 s64, s64, s57
    s_add_u32 s65, s65, s60
    s_mov_b32 m0, s65
    s_nop 0
    buffer_load_dwordx4 v147, s[48:51], s64 offen lds
    s_branch L_qd_2_x
L_qd_2_w:
    s_mov_b32 m0, s65
    s_nop 0
    buffer_load_dwordx4 v147, s[48:51], s64 offen lds
    s_add_u32 s64, s64, s57
    s_add_u32 s65, s65, s60
    s_mov_b32 m0, s65
    s_nop 0
    buffer_load_dwordx4 v147, s[48:51], s64 offen lds
    s_add_u32 s64, s64, s57
    s_add_u32 s65, s65, s60
    s_mov_b32 m0, s65
    s_nop 0
    buffer_load_dwordx4 v147, s[48:51], s64 offen lds
    s_add_u32 s64, s64, s57
    s_add_u32 s65, s65, s60
    s_mov_b32 m0, s65
    s_nop 0
    buffer_load_dwordx4 v147, s[48:51], s64 offen lds
L_qd_2_x:
    s_add_u32 s56, s56, s58
L_qd_2_e:
    s_barrier
    s_cmp_lt_u32 s68, 2
    s_cbranch_scc1 L_r2_xwt
    s_sub_u32 s67, s6, 8
    s_bfe_u32 s64, s2, 0x20003
    s_mul_i32 s64, s64, 48
    s_mul_i32 s65, s4, 192
    s_add_u32 s64, s64, s65
    s_mul_i32 s64, s64, 1280
    s_lshl_b32 s65, s67, 7
    s_add_u32 s64, s64, s65
    v_min_u32 v6, 47, v0
    v_mul_u32_u24 v6, 1280, v6
    buffer_load_dword v165, v6, s[20:23], s64 offen
    buffer_load_dword v165, v6, s[20:23], s64 offen offset:512
    s_cmp_ge_u32 s67, 2
    s_cbranch_scc1 L_xwt_skip
    buffer_load_dword v165, v6, s[20:23], s64 offen offset:1024
L_xwt_skip:
    s_mul_i32 s64, s4, 80
    s_lshl_b32 s65, s67, 4
    s_add_u32 s64, s64, s65
    s_lshl_b32 s64, s64, 13
    s_lshl_b32 s65, s5, 9
    s_add_u32 s64, s64, s65
    v_lshrrev_b32 v6, 2, v0
    v_lshlrev_b32 v6, 13, v6
    v_lshl_add_u32 v6, v5, 7, v6
    buffer_load_dword v165, v6, s[32:35], s64 offen
    s_cmp_lg_u32 s67, 0
    s_cbranch_scc1 L_xwt_skip2
    s_add_u32 s64, s64, 524288
    buffer_load_dword v165, v6, s[32:35], s64 offen
L_xwt_skip2:
L_r2_xwt:
    s_lshl_b32 s64, s44, 5
    v_add_u32 v6, s64, v1
    v_bfe_u32 v7, v6, 2, 2
    v_xor_b32 v8, v2, v7
    v_lshlrev_b32 v6, 6, v6
    v_lshl_add_u32 v144, v8, 4, v6
    v_xor_b32 v8, 2, v8
    v_lshl_add_u32 v145, v8, 4, v6
    v_add_u32 v144, 69632, v144
    v_add_u32 v145, 69632, v145
    v_lshl_add_u32 v6, v2, 2, v4
    v_mul_u32_u24 v6, 1088, v6
    v_lshl_add_u32 v6, v3, 5, v6
    v_and_b32 v7, 1, v5
    v_lshl_add_u32 v6, v7, 4, v6
    v_lshrrev_b32 v7, 1, v5
    v_lshl_add_u32 v6, v7, 3, v6
    s_lshl_b32 s64, s7, 8
    s_add_u32 s64, s64, 81920
    v_add_u32 v146, s64, v6
    v_lshrrev_b32 v6, 2, v1
    v_mul_u32_u24 v6, 1088, v6
    v_and_b32 v7, 3, v1
    v_lshl_add_u32 v6, v7, 8, v6
    v_xor_b32 v8, v2, v7
    s_mul_i32 s64, s7, 8704
    v_add_u32 v6, s64, v6
    v_lshl_add_u32 v160, v8, 4, v6
    v_xor_b32 v8, 2, v8
    v_lshl_add_u32 v161, v8, 4, v6
    v_mul_u32_u24 v6, 1088, v4
    v_lshl_add_u32 v6, v2, 8, v6
    v_lshl_add_u32 v6, v3, 5, v6
    v_lshl_add_u32 v6, v5, 3, v6
    s_add_u32 s64, s64, 17408
    v_add_u32 v162, s64, v6
    v_lshl_add_u32 v6, v2, 2, v4
    v_mul_u32_u24 v6, 1088, v6
    v_lshl_add_u32 v6, v3, 8, v6
    v_lshl_add_u32 v6, v5, 3, v6
    v_add_u32 v149, s63, v6
    v_lshlrev_b32 v150, 4, v0
    v_mov_b32 v167, v0
    s_cmp_lg_u32 s68, 0
    s_cbranch_scc1 L_rw_pre_0
    s_waitcnt vmcnt(6)
L_rw_pre_0:
    s_cmp_lg_u32 s68, 1
    s_cbranch_scc1 L_rw_pre_1
    s_waitcnt vmcnt(8)
L_rw_pre_1:
    s_barrier
    ds_read_b128 v[64:67], v144
    ds_read_b64_tr_b16 v[72:73], v146 offset:0
    ds_read_b64_tr_b16 v[74:75], v146 offset:512
    ds_read_b64_tr_b16 v[76:77], v146 offset:64
    ds_read_b64_tr_b16 v[78:79], v146 offset:576
    ds_read_b64_tr_b16 v[80:81], v146 offset:128
    ds_read_b64_tr_b16 v[82:83], v146 offset:640
    ds_read_b64_tr_b16 v[84:85], v146 offset:192
    ds_read_b64_tr_b16 v[86:87], v146 offset:704
    ds_read_b128 v[68:71], v145
    ds_read_b64_tr_b16 v[88:89], v146 offset:8704
    ds_read_b64_tr_b16 v[90:91], v146 offset:9216
    ds_read_b64_tr_b16 v[92:93], v146 offset:8768
    ds_read_b64_tr_b16 v[94:95], v146 offset:9280
    ds_read_b64_tr_b16 v[96:97], v146 offset:8832
    ds_read_b64_tr_b16 v[98:99], v146 offset:9344
    ds_read_b64_tr_b16 v[100:101], v146 offset:8896
    ds_read_b64_tr_b16 v[102:103], v146 offset:9408
    v_add_u32 v144, 29696, v144
    v_add_u32 v145, 29696, v145
    v_add_u32 v146, 29696, v146
    s_cmp_lg_u32 s68, 0
    s_cbranch_scc1 L_rw_q0_0
    s_waitcnt vmcnt(3)
L_rw_q0_0:
    s_cmp_lg_u32 s68, 1
    s_cbranch_scc1 L_rw_q0_1
    s_waitcnt vmcnt(4)
L_rw_q0_1:
    s_waitcnt lgkmcnt(0)
    s_barrier
    s_cmp_ge_u32 s68, 2
    s_cbranch_scc1 L_qd_3_e
    s_mov_b32 s64, s56
    s_add_u32 s65, s59, 0
    s_cmp_eq_u32 s68, 0
    s_cbranch_scc0 L_qd_3_w
    s_mov_b32 m0, s65
    s_nop 0
    buffer_load_dwordx4 v147, s[48:51], s64 offen lds
    s_add_u32 s64, s64, s57
    s_add_u32 s65, s65, s60
    s_mov_b32 m0, s65
    s_nop 0
    buffer_load_dwordx4 v147, s[48:51], s64 offen lds
    s_add_u32 s64, s64, s57
    s_add_u32 s65, s65, s60
    s_mov_b32 m0, s65
    s_nop 0
    buffer_load_dwordx4 v147, s[48:51], s64 offen lds
    s_branch L_qd_3_x
L_qd_3_w:
    s_mov_b32 m0, s65
    s_nop 0
    buffer_load_dwordx4 v147, s[48:51], s64 offen lds
    s_add_u32 s64, s64, s57
    s_add_u32 s65, s65, s60
    s_mov_b32 m0, s65
    s_nop 0
    buffer_load_dwordx4 v147, s[48:51], s64 offen lds
    s_add_u32 s64, s64, s57
    s_add_u32 s65, s65, s60
    s_mov_b32 m0, s65
    s_nop 0
    buffer_load_dwordx4 v147, s[48:51], s64 offen lds
    s_add_u32 s64, s64, s57
    s_add_u32 s65, s65, s60
    s_mov_b32 m0, s65
    s_nop 0
    buffer_load_dwordx4 v147, s[48:51], s64 offen lds
L_qd_3_x:
    s_add_u32 s56, s56, s58
L_qd_3_e:
    s_waitcnt lgkmcnt(0)
    v_mfma_f32_32x32x16_bf16 v[0:15], v[72:75], v[64:67], 0
    ds_read_b128 v[104:107], v144
    ds_read_b64_tr_b16 v[112:113], v146 offset:0
    ds_read_b64_tr_b16 v[114:115], v146 offset:512
    v_mfma_f32_32x32x16_bf16 v[16:31], v[76:79], v[64:67], 0
    ds_read_b64_tr_b16 v[116:117], v146 offset:64
    ds_read_b64_tr_b16 v[118:119], v146 offset:576
    ds_read_b64_tr_b16 v[120:121], v146 offset:128
    v_mfma_f32_32x32x16_bf16 v[32:47], v[80:83], v[64:67], 0
    ds_read_b64_tr_b16 v[122:123], v146 offset:640
    ds_read_b64_tr_b16 v[124:125], v146 offset:192
    v_mfma_f32_32x32x16_bf16 v[48:63], v[84:87], v[64:67], 0
    ds_read_b64_tr_b16 v[126:127], v146 offset:704
    ds_read_b128 v[108:111], v145
    v_mfma_f32_32x32x16_bf16 v[0:15], v[88:91], v[68:71], v[0:15]
    ds_read_b64_tr_b16 v[128:129], v146 offset:8704
    ds_read_b64_tr_b16 v[130:131], v146 offset:9216
    v_mfma_f32_32x32x16_bf16 v[16:31], v[92:95], v[68:71], v[16:31]
    ds_read_b64_tr_b16 v[132:133], v146 offset:8768
    ds_read_b64_tr_b16 v[134:135], v146 offset:9280
    v_mfma_f32_32x32x16_bf16 v[32:47], v[96:99], v[68:71], v[32:47]
    ds_read_b64_tr_b16 v[136:137], v146 offset:8832
    ds_read_b64_tr_b16 v[138:139], v146 offset:9344
    v_mfma_f32_32x32x16_bf16 v[48:63], v[100:103], v[68:71], v[48:63]
    ds_read_b64_tr_b16 v[140:141], v146 offset:8896
    ds_read_b64_tr_b16 v[142:143], v146 offset:9408
    v_add_u32 v144, 29696, v144
    v_add_u32 v145, 29696, v145
    v_add_u32 v146, 29696, v146
    s_cmp_lg_u32 s68, 0
    s_cbranch_scc1 L_rw_q1_0
    s_waitcnt vmcnt(3)
L_rw_q1_0:
    s_cmp_lg_u32 s68, 1
    s_cbranch_scc1 L_rw_q1_1
    s_waitcnt vmcnt(4)
L_rw_q1_1:
    s_waitcnt lgkmcnt(0)
    s_barrier
    s_cmp_ge_u32 s68, 2
    s_cbranch_scc1 L_qd_4_e
    s_mov_b32 s64, s56
    s_add_u32 s65, s59, 29696
    s_cmp_eq_u32 s68, 0
    s_cbranch_scc0 L_qd_4_w
    s_mov_b32 m0, s65
    s_nop 0
    buffer_load_dwordx4 v147, s[48:51], s64 offen lds
    s_add_u32 s64, s64, s57
    s_add_u32 s65, s65, s60
    s_mov_b32 m0, s65
    s_nop 0
    buffer_load_dwordx4 v147, s[48:51], s64 offen lds
    s_add_u32 s64, s64, s57
    s_add_u32 s65, s65, s60
    s_mov_b32 m0, s65
    s_nop 0
    buffer_load_dwordx4 v147, s[48:51], s64 offen lds
    s_branch L_qd_4_x
L_qd_4_w:
    s_mov_b32 m0, s65
    s_nop 0
    buffer_load_dwordx4 v147, s[48:51], s64 offen lds
    s_add_u32 s64, s64, s57
    s_add_u32 s65, s65, s60
    s_mov_b32 m0, s65
    s_nop 0
    buffer_load_dwordx4 v147, s[48:51], s64 offen lds
    s_add_u32 s64, s64, s57
    s_add_u32 s65, s65, s60
    s_mov_b32 m0, s65
    s_nop 0
    buffer_load_dwordx4 v147, s[48:51], s64 offen lds
    s_add_u32 s64, s64, s57
    s_add_u32 s65, s65, s60
    s_mov_b32 m0, s65
    s_nop 0
    buffer_load_dwordx4 v147, s[48:51], s64 offen lds
L_qd_4_x:
    s_add_u32 s56, s56, s58
L_qd_4_e:
    s_waitcnt lgkmcnt(0)
    v_mfma_f32_32x32x16_bf16 v[0:15], v[112:115], v[104:107], v[0:15]
    ds_read_b128 v[64:67], v144
    ds_read_b64_tr_b16 v[72:73], v146 offset:0
    ds_read_b64_tr_b16 v[74:75], v146 offset:512
    v_mfma_f32_32x32x16_bf16 v[16:31], v[116:119], v[104:107], v[16:31]
    ds_read_b64_tr_b16 v[76:77], v146 offset:64
    ds_read_b64_tr_b16 v[78:79], v146 offset:576
    ds_read_b64_tr_b16 v[80:81], v146 offset:128
    v_mfma_f32_32x32x16_bf16 v[32:47], v[120:123], v[104:107], v[32:47]
    ds_read_b64_tr_b16 v[82:83], v146 offset:640
    ds_read_b64_tr_b16 v[84:85], v146 offset:192
    v_mfma_f32_32x32x16_bf16 v[48:63], v[124:127], v[104:107], v[48:63]
    ds_read_b64_tr_b16 v[86:87], v146 offset:704
    ds_read_b128 v[68:71], v145
    v_mfma_f32_32x32x16_bf16 v[0:15], v[128:131], v[108:111], v[0:15]
    ds_read_b64_tr_b16 v[88:89], v146 offset:8704
    ds_read_b64_tr_b16 v[90:91], v146 offset:9216
    v_mfma_f32_32x32x16_bf16 v[16:31], v[132:135], v[108:111], v[16:31]
    ds_read_b64_tr_b16 v[92:93], v146 offset:8768
    ds_read_b64_tr_b16 v[94:95], v146 offset:9280
    v_mfma_f32_32x32x16_bf16 v[32:47], v[136:139], v[108:111], v[32:47]
    ds_read_b64_tr_b16 v[96:97], v146 offset:8832
    ds_read_b64_tr_b16 v[98:99], v146 offset:9344
    v_mfma_f32_32x32x16_bf16 v[48:63], v[140:143], v[108:111], v[48:63]
    ds_read_b64_tr_b16 v[100:101], v146 offset:8896
    ds_read_b64_tr_b16 v[102:103], v146 offset:9408
    v_subrev_u32 v144, 59392, v144
    v_subrev_u32 v145, 59392, v145
    v_subrev_u32 v146, 59392, v146
    s_cmp_lg_u32 s68, 0
    s_cbranch_scc1 L_rw_q2_0
    s_waitcnt vmcnt(3)
L_rw_q2_0:
    s_cmp_lg_u32 s68, 1
    s_cbranch_scc1 L_rw_q2_1
    s_waitcnt vmcnt(4)
L_rw_q2_1:
    s_waitcnt lgkmcnt(0)
    s_barrier
    s_cmp_ge_u32 s68, 2
    s_cbranch_scc1 L_qd_5_e
    s_mov_b32 s64, s56
    s_add_u32 s65, s59, 59392
    s_cmp_eq_u32 s68, 0
    s_cbranch_scc0 L_qd_5_w
    s_mov_b32 m0, s65
    s_nop 0
    buffer_load_dwordx4 v147, s[48:51], s64 offen lds
    s_add_u32 s64, s64, s57
    s_add_u32 s65, s65, s60
    s_mov_b32 m0, s65
    s_nop 0
    buffer_load_dwordx4 v147, s[48:51], s64 offen lds
    s_add_u32 s64, s64, s57
    s_add_u32 s65, s65, s60
    s_mov_b32 m0, s65
    s_nop 0
    buffer_load_dwordx4 v147, s[48:51], s64 offen lds
    s_branch L_qd_5_x
L_qd_5_w:
    s_mov_b32 m0, s65
    s_nop 0
    buffer_load_dwordx4 v147, s[48:51], s64 offen lds
    s_add_u32 s64, s64, s57
    s_add_u32 s65, s65, s60
    s_mov_b32 m0, s65
    s_nop 0
    buffer_load_dwordx4 v147, s[48:51], s64 offen lds
    s_add_u32 s64, s64, s57
    s_add_u32 s65, s65, s60
    s_mov_b32 m0, s65
    s_nop 0
    buffer_load_dwordx4 v147, s[48:51], s64 offen lds
    s_add_u32 s64, s64, s57
    s_add_u32 s65, s65, s60
    s_mov_b32 m0, s65
    s_nop 0
    buffer_load_dwordx4 v147, s[48:51], s64 offen lds
L_qd_5_x:
    s_add_u32 s56, s56, s58
L_qd_5_e:
    s_waitcnt lgkmcnt(0)
    v_mfma_f32_32x32x16_bf16 v[0:15], v[72:75], v[64:67], v[0:15]
    ds_read_b128 v[104:107], v144
    ds_read_b64_tr_b16 v[112:113], v146 offset:0
    ds_read_b64_tr_b16 v[114:115], v146 offset:512
    v_mfma_f32_32x32x16_bf16 v[16:31], v[76:79], v[64:67], v[16:31]
    ds_read_b64_tr_b16 v[116:117], v146 offset:64
    ds_read_b64_tr_b16 v[118:119], v146 offset:576
    ds_read_b64_tr_b16 v[120:121], v146 offset:128
    v_mfma_f32_32x32x16_bf16 v[32:47], v[80:83], v[64:67], v[32:47]
    ds_read_b64_tr_b16 v[122:123], v146 offset:640
    ds_read_b64_tr_b16 v[124:125], v146 offset:192
    v_mfma_f32_32x32x16_bf16 v[48:63], v[84:87], v[64:67], v[48:63]
    ds_read_b64_tr_b16 v[126:127], v146 offset:704
    ds_read_b128 v[108:111], v145
    v_mfma_f32_32x32x16_bf16 v[0:15], v[88:91], v[68:71], v[0:15]
    ds_read_b64_tr_b16 v[128:129], v146 offset:8704
    ds_read_b64_tr_b16 v[130:131], v146 offset:9216
    v_mfma_f32_32x32x16_bf16 v[16:31], v[92:95], v[68:71], v[16:31]
    ds_read_b64_tr_b16 v[132:133], v146 offset:8768
    ds_read_b64_tr_b16 v[134:135], v146 offset:9280
    v_mfma_f32_32x32x16_bf16 v[32:47], v[96:99], v[68:71], v[32:47]
    ds_read_b64_tr_b16 v[136:137], v146 offset:8832
    ds_read_b64_tr_b16 v[138:139], v146 offset:9344
    v_mfma_f32_32x32x16_bf16 v[48:63], v[100:103], v[68:71], v[48:63]
    ds_read_b64_tr_b16 v[140:141], v146 offset:8896
    ds_read_b64_tr_b16 v[142:143], v146 offset:9408
    v_add_u32 v144, 29696, v144
    v_add_u32 v145, 29696, v145
    v_add_u32 v146, 29696, v146
    s_cmp_lg_u32 s68, 0
    s_cbranch_scc1 L_rw_q3_0
    s_waitcnt vmcnt(3)
L_rw_q3_0:
    s_cmp_lg_u32 s68, 1
    s_cbranch_scc1 L_rw_q3_1
    s_waitcnt vmcnt(4)
L_rw_q3_1:
    s_waitcnt lgkmcnt(0)
    s_barrier
    s_cmp_ge_u32 s68, 2
    s_cbranch_scc1 L_qd_6_e
    s_mov_b32 s64, s56
    s_add_u32 s65, s59, 0
    s_cmp_eq_u32 s68, 0
    s_cbranch_scc0 L_qd_6_w
    s_mov_b32 m0, s65
    s_nop 0
    buffer_load_dwordx4 v147, s[48:51], s64 offen lds
    s_add_u32 s64, s64, s57
    s_add_u32 s65, s65, s60
    s_mov_b32 m0, s65
    s_nop 0
    buffer_load_dwordx4 v147, s[48:51], s64 offen lds
    s_add_u32 s64, s64, s57
    s_add_u32 s65, s65, s60
    s_mov_b32 m0, s65
    s_nop 0
    buffer_load_dwordx4 v147, s[48:51], s64 offen lds
    s_branch L_qd_6_x
L_qd_6_w:
    s_mov_b32 m0, s65
    s_nop 0
    buffer_load_dwordx4 v147, s[48:51], s64 offen lds
    s_add_u32 s64, s64, s57
    s_add_u32 s65, s65, s60
    s_mov_b32 m0, s65
    s_nop 0
    buffer_load_dwordx4 v147, s[48:51], s64 offen lds
    s_add_u32 s64, s64, s57
    s_add_u32 s65, s65, s60
    s_mov_b32 m0, s65
    s_nop 0
    buffer_load_dwordx4 v147, s[48:51], s64 offen lds
    s_add_u32 s64, s64, s57
    s_add_u32 s65, s65, s60
    s_mov_b32 m0, s65
    s_nop 0
    buffer_load_dwordx4 v147, s[48:51], s64 offen lds
L_qd_6_x:
    s_add_u32 s56, s56, s58
L_qd_6_e:
    s_waitcnt lgkmcnt(0)
    v_mfma_f32_32x32x16_bf16 v[0:15], v[112:115], v[104:107], v[0:15]
    ds_read_b128 v[64:67], v144
    ds_read_b64_tr_b16 v[72:73], v146 offset:0
    ds_read_b64_tr_b16 v[74:75], v146 offset:512
    v_mfma_f32_32x32x16_bf16 v[16:31], v[116:119], v[104:107], v[16:31]
    ds_read_b64_tr_b16 v[76:77], v146 offset:64
    ds_read_b64_tr_b16 v[78:79], v146 offset:576
    ds_read_b64_tr_b16 v[80:81], v146 offset:128
    v_mfma_f32_32x32x16_bf16 v[32:47], v[120:123], v[104:107], v[32:47]
    ds_read_b64_tr_b16 v[82:83], v146 offset:640
    ds_read_b64_tr_b16 v[84:85], v146 offset:192
    v_mfma_f32_32x32x16_bf16 v[48:63], v[124:127], v[104:107], v[48:63]
    ds_read_b64_tr_b16 v[86:87], v146 offset:704
    ds_read_b128 v[68:71], v145
    v_mfma_f32_32x32x16_bf16 v[0:15], v[128:131], v[108:111], v[0:15]
    ds_read_b64_tr_b16 v[88:89], v146 offset:8704
    ds_read_b64_tr_b16 v[90:91], v146 offset:9216
    v_mfma_f32_32x32x16_bf16 v[16:31], v[132:135], v[108:111], v[16:31]
    ds_read_b64_tr_b16 v[92:93], v146 offset:8768
    ds_read_b64_tr_b16 v[94:95], v146 offset:9280
    v_mfma_f32_32x32x16_bf16 v[32:47], v[136:139], v[108:111], v[32:47]
    ds_read_b64_tr_b16 v[96:97], v146 offset:8832
    ds_read_b64_tr_b16 v[98:99], v146 offset:9344
    v_mfma_f32_32x32x16_bf16 v[48:63], v[140:143], v[108:111], v[48:63]
    ds_read_b64_tr_b16 v[100:101], v146 offset:8896
    ds_read_b64_tr_b16 v[102:103], v146 offset:9408
    v_add_u32 v144, 29696, v144
    v_add_u32 v145, 29696, v145
    v_add_u32 v146, 29696, v146
    s_cmp_lg_u32 s68, 0
    s_cbranch_scc1 L_rw_q4_0
    s_waitcnt vmcnt(3)
L_rw_q4_0:
    s_cmp_lg_u32 s68, 1
    s_cbranch_scc1 L_rw_q4_1
    s_waitcnt vmcnt(4)
L_rw_q4_1:
    s_waitcnt lgkmcnt(0)
    s_barrier
    s_cmp_ge_u32 s68, 2
    s_cbranch_scc1 L_qd_7_e
    s_mov_b32 s64, s56
    s_add_u32 s65, s59, 29696
    s_cmp_eq_u32 s68, 0
    s_cbranch_scc0 L_qd_7_w
    s_mov_b32 m0, s65
    s_nop 0
    buffer_load_dwordx4 v147, s[48:51], s64 offen lds
    s_add_u32 s64, s64, s57
    s_add_u32 s65, s65, s60
    s_mov_b32 m0, s65
    s_nop 0
    buffer_load_dwordx4 v147, s[48:51], s64 offen lds
    s_add_u32 s64, s64, s57
    s_add_u32 s65, s65, s60
    s_mov_b32 m0, s65
    s_nop 0
    buffer_load_dwordx4 v147, s[48:51], s64 offen lds
    s_branch L_qd_7_x
L_qd_7_w:
    s_mov_b32 m0, s65
    s_nop 0
    buffer_load_dwordx4 v147, s[48:51], s64 offen lds
    s_add_u32 s64, s64, s57
    s_add_u32 s65, s65, s60
    s_mov_b32 m0, s65
    s_nop 0
    buffer_load_dwordx4 v147, s[48:51], s64 offen lds
    s_add_u32 s64, s64, s57
    s_add_u32 s65, s65, s60
    s_mov_b32 m0, s65
    s_nop 0
    buffer_load_dwordx4 v147, s[48:51], s64 offen lds
    s_add_u32 s64, s64, s57
    s_add_u32 s65, s65, s60
    s_mov_b32 m0, s65
    s_nop 0
    buffer_load_dwordx4 v147, s[48:51], s64 offen lds
L_qd_7_x:
    s_add_u32 s56, s56, s58
L_qd_7_e:
    s_waitcnt lgkmcnt(0)
    v_mfma_f32_32x32x16_bf16 v[0:15], v[72:75], v[64:67], v[0:15]
    ds_read_b128 v[104:107], v144
    ds_read_b64_tr_b16 v[112:113], v146 offset:0
    ds_read_b64_tr_b16 v[114:115], v146 offset:512
    v_mfma_f32_32x32x16_bf16 v[16:31], v[76:79], v[64:67], v[16:31]
    ds_read_b64_tr_b16 v[116:117], v146 offset:64
    ds_read_b64_tr_b16 v[118:119], v146 offset:576
    ds_read_b64_tr_b16 v[120:121], v146 offset:128
    v_mfma_f32_32x32x16_bf16 v[32:47], v[80:83], v[64:67], v[32:47]
    ds_read_b64_tr_b16 v[122:123], v146 offset:640
    ds_read_b64_tr_b16 v[124:125], v146 offset:192
    v_mfma_f32_32x32x16_bf16 v[48:63], v[84:87], v[64:67], v[48:63]
    ds_read_b64_tr_b16 v[126:127], v146 offset:704
    ds_read_b128 v[108:111], v145
    v_mfma_f32_32x32x16_bf16 v[0:15], v[88:91], v[68:71], v[0:15]
    ds_read_b64_tr_b16 v[128:129], v146 offset:8704
    ds_read_b64_tr_b16 v[130:131], v146 offset:9216
    v_mfma_f32_32x32x16_bf16 v[16:31], v[92:95], v[68:71], v[16:31]
    ds_read_b64_tr_b16 v[132:133], v146 offset:8768
    ds_read_b64_tr_b16 v[134:135], v146 offset:9280
    v_mfma_f32_32x32x16_bf16 v[32:47], v[96:99], v[68:71], v[32:47]
    ds_read_b64_tr_b16 v[136:137], v146 offset:8832
    ds_read_b64_tr_b16 v[138:139], v146 offset:9344
    v_mfma_f32_32x32x16_bf16 v[48:63], v[100:103], v[68:71], v[48:63]
    ds_read_b64_tr_b16 v[140:141], v146 offset:8896
    ds_read_b64_tr_b16 v[142:143], v146 offset:9408
    v_subrev_u32 v144, 59392, v144
    v_subrev_u32 v145, 59392, v145
    v_subrev_u32 v146, 59392, v146
    s_cmp_lg_u32 s68, 0
    s_cbranch_scc1 L_rw_q5_0
    s_waitcnt vmcnt(3)
L_rw_q5_0:
    s_cmp_lg_u32 s68, 1
    s_cbranch_scc1 L_rw_q5_1
    s_waitcnt vmcnt(4)
L_rw_q5_1:
    s_waitcnt lgkmcnt(0)
    s_barrier
    s_cmp_ge_u32 s68, 2
    s_cbranch_scc1 L_qd_8_e
    s_mov_b32 s64, s56
    s_add_u32 s65, s59, 59392
    s_cmp_eq_u32 s68, 0
    s_cbranch_scc0 L_qd_8_w
    s_mov_b32 m0, s65
    s_nop 0
    buffer_load_dwordx4 v147, s[48:51], s64 offen lds
    s_add_u32 s64, s64, s57
    s_add_u32 s65, s65, s60
    s_mov_b32 m0, s65
    s_nop 0
    buffer_load_dwordx4 v147, s[48:51], s64 offen lds
    s_add_u32 s64, s64, s57
    s_add_u32 s65, s65, s60
    s_mov_b32 m0, s65
    s_nop 0
    buffer_load_dwordx4 v147, s[48:51], s64 offen lds
    s_branch L_qd_8_x
L_qd_8_w:
    s_mov_b32 m0, s65
    s_nop 0
    buffer_load_dwordx4 v147, s[48:51], s64 offen lds
    s_add_u32 s64, s64, s57
    s_add_u32 s65, s65, s60
    s_mov_b32 m0, s65
    s_nop 0
    buffer_load_dwordx4 v147, s[48:51], s64 offen lds
    s_add_u32 s64, s64, s57
    s_add_u32 s65, s65, s60
    s_mov_b32 m0, s65
    s_nop 0
    buffer_load_dwordx4 v147, s[48:51], s64 offen lds
    s_add_u32 s64, s64, s57
    s_add_u32 s65, s65, s60
    s_mov_b32 m0, s65
    s_nop 0
    buffer_load_dwordx4 v147, s[48:51], s64 offen lds
L_qd_8_x:
    s_add_u32 s56, s56, s58
L_qd_8_e:
    s_waitcnt lgkmcnt(0)
    v_mfma_f32_32x32x16_bf16 v[0:15], v[112:115], v[104:107], v[0:15]
    ds_read_b128 v[64:67], v144
    ds_read_b64_tr_b16 v[72:73], v146 offset:0
    ds_read_b64_tr_b16 v[74:75], v146 offset:512
    v_mfma_f32_32x32x16_bf16 v[16:31], v[116:119], v[104:107], v[16:31]
    ds_read_b64_tr_b16 v[76:77], v146 offset:64
    ds_read_b64_tr_b16 v[78:79], v146 offset:576
    ds_read_b64_tr_b16 v[80:81], v146 offset:128
    v_mfma_f32_32x32x16_bf16 v[32:47], v[120:123], v[104:107], v[32:47]
    ds_read_b64_tr_b16 v[82:83], v146 offset:640
    ds_read_b64_tr_b16 v[84:85], v146 offset:192
    v_mfma_f32_32x32x16_bf16 v[48:63], v[124:127], v[104:107], v[48:63]
    ds_read_b64_tr_b16 v[86:87], v146 offset:704
    ds_read_b128 v[68:71], v145
    v_mfma_f32_32x32x16_bf16 v[0:15], v[128:131], v[108:111], v[0:15]
    ds_read_b64_tr_b16 v[88:89], v146 offset:8704
    ds_read_b64_tr_b16 v[90:91], v146 offset:9216
    v_mfma_f32_32x32x16_bf16 v[16:31], v[132:135], v[108:111], v[16:31]
    ds_read_b64_tr_b16 v[92:93], v146 offset:8768
    ds_read_b64_tr_b16 v[94:95], v146 offset:9280
    v_mfma_f32_32x32x16_bf16 v[32:47], v[136:139], v[108:111], v[32:47]
    ds_read_b64_tr_b16 v[96:97], v146 offset:8832
    ds_read_b64_tr_b16 v[98:99], v146 offset:9344
    v_mfma_f32_32x32x16_bf16 v[48:63], v[140:143], v[108:111], v[48:63]
    ds_read_b64_tr_b16 v[100:101], v146 offset:8896
    ds_read_b64_tr_b16 v[102:103], v146 offset:9408
    v_add_u32 v144, 29696, v144
    v_add_u32 v145, 29696, v145
    v_add_u32 v146, 29696, v146
    s_cmp_lg_u32 s68, 0
    s_cbranch_scc1 L_rw_q6_0
    s_waitcnt vmcnt(3)
L_rw_q6_0:
    s_cmp_lg_u32 s68, 1
    s_cbranch_scc1 L_rw_q6_1
    s_waitcnt vmcnt(4)
L_rw_q6_1:
    s_waitcnt lgkmcnt(0)
    s_barrier
    s_cmp_ge_u32 s68, 2
    s_cbranch_scc1 L_qd_9_e
    s_mov_b32 s64, s56
    s_add_u32 s65, s59, 0
    s_cmp_eq_u32 s68, 0
    s_cbranch_scc0 L_qd_9_w
    s_mov_b32 m0, s65
    s_nop 0
    buffer_load_dwordx4 v147, s[48:51], s64 offen lds
    s_add_u32 s64, s64, s57
    s_add_u32 s65, s65, s60
    s_mov_b32 m0, s65
    s_nop 0
    buffer_load_dwordx4 v147, s[48:51], s64 offen lds
    s_add_u32 s64, s64, s57
    s_add_u32 s65, s65, s60
    s_mov_b32 m0, s65
    s_nop 0
    buffer_load_dwordx4 v147, s[48:51], s64 offen lds
    s_branch L_qd_9_x
L_qd_9_w:
    s_mov_b32 m0, s65
    s_nop 0
    buffer_load_dwordx4 v147, s[48:51], s64 offen lds
    s_add_u32 s64, s64, s57
    s_add_u32 s65, s65, s60
    s_mov_b32 m0, s65
    s_nop 0
    buffer_load_dwordx4 v147, s[48:51], s64 offen lds
    s_add_u32 s64, s64, s57
    s_add_u32 s65, s65, s60
    s_mov_b32 m0, s65
    s_nop 0
    buffer_load_dwordx4 v147, s[48:51], s64 offen lds
    s_add_u32 s64, s64, s57
    s_add_u32 s65, s65, s60
    s_mov_b32 m0, s65
    s_nop 0
    buffer_load_dwordx4 v147, s[48:51], s64 offen lds
L_qd_9_x:
    s_add_u32 s56, s56, s58
L_qd_9_e:
    s_waitcnt lgkmcnt(0)
    v_mfma_f32_32x32x16_bf16 v[0:15], v[72:75], v[64:67], v[0:15]
    ds_read_b128 v[104:107], v144
    ds_read_b64_tr_b16 v[112:113], v146 offset:0
    ds_read_b64_tr_b16 v[114:115], v146 offset:512
    v_mfma_f32_32x32x16_bf16 v[16:31], v[76:79], v[64:67], v[16:31]
    ds_read_b64_tr_b16 v[116:117], v146 offset:64
    ds_read_b64_tr_b16 v[118:119], v146 offset:576
    ds_read_b64_tr_b16 v[120:121], v146 offset:128
    v_mfma_f32_32x32x16_bf16 v[32:47], v[80:83], v[64:67], v[32:47]
    ds_read_b64_tr_b16 v[122:123], v146 offset:640
    ds_read_b64_tr_b16 v[124:125], v146 offset:192
    v_mfma_f32_32x32x16_bf16 v[48:63], v[84:87], v[64:67], v[48:63]
    ds_read_b64_tr_b16 v[126:127], v146 offset:704
    ds_read_b128 v[108:111], v145
    v_mfma_f32_32x32x16_bf16 v[0:15], v[88:91], v[68:71], v[0:15]
    ds_read_b64_tr_b16 v[128:129], v146 offset:8704
    ds_read_b64_tr_b16 v[130:131], v146 offset:9216
    v_mfma_f32_32x32x16_bf16 v[16:31], v[92:95], v[68:71], v[16:31]
    ds_read_b64_tr_b16 v[132:133], v146 offset:8768
    ds_read_b64_tr_b16 v[134:135], v146 offset:9280
    v_mfma_f32_32x32x16_bf16 v[32:47], v[96:99], v[68:71], v[32:47]
    ds_read_b64_tr_b16 v[136:137], v146 offset:8832
    ds_read_b64_tr_b16 v[138:139], v146 offset:9344
    v_mfma_f32_32x32x16_bf16 v[48:63], v[100:103], v[68:71], v[48:63]
    ds_read_b64_tr_b16 v[140:141], v146 offset:8896
    ds_read_b64_tr_b16 v[142:143], v146 offset:9408
    v_add_u32 v144, 29696, v144
    v_add_u32 v145, 29696, v145
    v_add_u32 v146, 29696, v146
    s_cmp_lg_u32 s68, 0
    s_cbranch_scc1 L_rw_q7_0
    s_waitcnt vmcnt(3)
L_rw_q7_0:
    s_cmp_lg_u32 s68, 1
    s_cbranch_scc1 L_rw_q7_1
    s_waitcnt vmcnt(4)
L_rw_q7_1:
    s_waitcnt lgkmcnt(0)
    s_barrier
    s_cmp_ge_u32 s68, 2
    s_cbranch_scc1 L_qd_10_e
    s_mov_b32 s64, s56
    s_add_u32 s65, s59, 29696
    s_cmp_eq_u32 s68, 0
    s_cbranch_scc0 L_qd_10_w
    s_mov_b32 m0, s65
    s_nop 0
    buffer_load_dwordx4 v147, s[48:51], s64 offen lds
    s_add_u32 s64, s64, s57
    s_add_u32 s65, s65, s60
    s_mov_b32 m0, s65
    s_nop 0
    buffer_load_dwordx4 v147, s[48:51], s64 offen lds
    s_add_u32 s64, s64, s57
    s_add_u32 s65, s65, s60
    s_mov_b32 m0, s65
    s_nop 0
    buffer_load_dwordx4 v147, s[48:51], s64 offen lds
    s_branch L_qd_10_x
L_qd_10_w:
    s_mov_b32 m0, s65
    s_nop 0
    buffer_load_dwordx4 v147, s[48:51], s64 offen lds
    s_add_u32 s64, s64, s57
    s_add_u32 s65, s65, s60
    s_mov_b32 m0, s65
    s_nop 0
    buffer_load_dwordx4 v147, s[48:51], s64 offen lds
    s_add_u32 s64, s64, s57
    s_add_u32 s65, s65, s60
    s_mov_b32 m0, s65
    s_nop 0
    buffer_load_dwordx4 v147, s[48:51], s64 offen lds
    s_add_u32 s64, s64, s57
    s_add_u32 s65, s65, s60
    s_mov_b32 m0, s65
    s_nop 0
    buffer_load_dwordx4 v147, s[48:51], s64 offen lds
L_qd_10_x:
    s_add_u32 s56, s56, s58
L_qd_10_e:
    s_waitcnt lgkmcnt(0)
    v_mfma_f32_32x32x16_bf16 v[0:15], v[112:115], v[104:107], v[0:15]
    ds_read_b128 v[64:67], v144
    ds_read_b64_tr_b16 v[72:73], v146 offset:0
    ds_read_b64_tr_b16 v[74:75], v146 offset:512
    v_mfma_f32_32x32x16_bf16 v[16:31], v[116:119], v[104:107], v[16:31]
    ds_read_b64_tr_b16 v[76:77], v146 offset:64
    ds_read_b64_tr_b16 v[78:79], v146 offset:576
    ds_read_b64_tr_b16 v[80:81], v146 offset:128
    v_mfma_f32_32x32x16_bf16 v[32:47], v[120:123], v[104:107], v[32:47]
    ds_read_b64_tr_b16 v[82:83], v146 offset:640
    ds_read_b64_tr_b16 v[84:85], v146 offset:192
    v_mfma_f32_32x32x16_bf16 v[48:63], v[124:127], v[104:107], v[48:63]
    ds_read_b64_tr_b16 v[86:87], v146 offset:704
    ds_read_b128 v[68:71], v145
    v_mfma_f32_32x32x16_bf16 v[0:15], v[128:131], v[108:111], v[0:15]
    ds_read_b64_tr_b16 v[88:89], v146 offset:8704
    ds_read_b64_tr_b16 v[90:91], v146 offset:9216
    v_mfma_f32_32x32x16_bf16 v[16:31], v[132:135], v[108:111], v[16:31]
    ds_read_b64_tr_b16 v[92:93], v146 offset:8768
    ds_read_b64_tr_b16 v[94:95], v146 offset:9280
    v_mfma_f32_32x32x16_bf16 v[32:47], v[136:139], v[108:111], v[32:47]
    ds_read_b64_tr_b16 v[96:97], v146 offset:8832
    ds_read_b64_tr_b16 v[98:99], v146 offset:9344
    v_mfma_f32_32x32x16_bf16 v[48:63], v[140:143], v[108:111], v[48:63]
    ds_read_b64_tr_b16 v[100:101], v146 offset:8896
    ds_read_b64_tr_b16 v[102:103], v146 offset:9408
    v_subrev_u32 v144, 59392, v144
    v_subrev_u32 v145, 59392, v145
    v_subrev_u32 v146, 59392, v146
    s_cmp_lg_u32 s68, 0
    s_cbranch_scc1 L_rw_q8_0
    s_waitcnt vmcnt(3)
L_rw_q8_0:
    s_cmp_lg_u32 s68, 1
    s_cbranch_scc1 L_rw_q8_1
    s_waitcnt vmcnt(4)
L_rw_q8_1:
    s_waitcnt lgkmcnt(0)
    s_barrier
    s_cmp_ge_u32 s68, 2
    s_cbranch_scc1 L_qd_11_e
    s_mov_b32 s64, s56
    s_add_u32 s65, s59, 59392
    s_cmp_eq_u32 s68, 0
    s_cbranch_scc0 L_qd_11_w
    s_mov_b32 m0, s65
    s_nop 0
    buffer_load_dwordx4 v147, s[48:51], s64 offen lds
    s_add_u32 s64, s64, s57
    s_add_u32 s65, s65, s60
    s_mov_b32 m0, s65
    s_nop 0
    buffer_load_dwordx4 v147, s[48:51], s64 offen lds
    s_add_u32 s64, s64, s57
    s_add_u32 s65, s65, s60
    s_mov_b32 m0, s65
    s_nop 0
    buffer_load_dwordx4 v147, s[48:51], s64 offen lds
    s_branch L_qd_11_x
L_qd_11_w:
    s_mov_b32 m0, s65
    s_nop 0
    buffer_load_dwordx4 v147, s[48:51], s64 offen lds
    s_add_u32 s64, s64, s57
    s_add_u32 s65, s65, s60
    s_mov_b32 m0, s65
    s_nop 0
    buffer_load_dwordx4 v147, s[48:51], s64 offen lds
    s_add_u32 s64, s64, s57
    s_add_u32 s65, s65, s60
    s_mov_b32 m0, s65
    s_nop 0
    buffer_load_dwordx4 v147, s[48:51], s64 offen lds
    s_add_u32 s64, s64, s57
    s_add_u32 s65, s65, s60
    s_mov_b32 m0, s65
    s_nop 0
    buffer_load_dwordx4 v147, s[48:51], s64 offen lds
L_qd_11_x:
    s_add_u32 s56, s56, s58
L_qd_11_e:
    s_waitcnt lgkmcnt(0)
    v_mfma_f32_32x32x16_bf16 v[0:15], v[72:75], v[64:67], v[0:15]
    ds_read_b128 v[104:107], v144
    ds_read_b64_tr_b16 v[112:113], v146 offset:0
    ds_read_b64_tr_b16 v[114:115], v146 offset:512
    v_mfma_f32_32x32x16_bf16 v[16:31], v[76:79], v[64:67], v[16:31]
    ds_read_b64_tr_b16 v[116:117], v146 offset:64
    ds_read_b64_tr_b16 v[118:119], v146 offset:576
    ds_read_b64_tr_b16 v[120:121], v146 offset:128
    v_mfma_f32_32x32x16_bf16 v[32:47], v[80:83], v[64:67], v[32:47]
    ds_read_b64_tr_b16 v[122:123], v146 offset:640
    ds_read_b64_tr_b16 v[124:125], v146 offset:192
    v_mfma_f32_32x32x16_bf16 v[48:63], v[84:87], v[64:67], v[48:63]
    ds_read_b64_tr_b16 v[126:127], v146 offset:704
    ds_read_b128 v[108:111], v145
    v_mfma_f32_32x32x16_bf16 v[0:15], v[88:91], v[68:71], v[0:15]
    ds_read_b64_tr_b16 v[128:129], v146 offset:8704
    ds_read_b64_tr_b16 v[130:131], v146 offset:9216
    v_mfma_f32_32x32x16_bf16 v[16:31], v[92:95], v[68:71], v[16:31]
    ds_read_b64_tr_b16 v[132:133], v146 offset:8768
    ds_read_b64_tr_b16 v[134:135], v146 offset:9280
    v_mfma_f32_32x32x16_bf16 v[32:47], v[96:99], v[68:71], v[32:47]
    ds_read_b64_tr_b16 v[136:137], v146 offset:8832
    ds_read_b64_tr_b16 v[138:139], v146 offset:9344
    v_mfma_f32_32x32x16_bf16 v[48:63], v[100:103], v[68:71], v[48:63]
    ds_read_b64_tr_b16 v[140:141], v146 offset:8896
    ds_read_b64_tr_b16 v[142:143], v146 offset:9408
    v_add_u32 v144, 29696, v144
    v_add_u32 v145, 29696, v145
    v_add_u32 v146, 29696, v146
    s_cmp_lg_u32 s68, 0
    s_cbranch_scc1 L_rw_q9_0
    s_waitcnt vmcnt(3)
L_rw_q9_0:
    s_cmp_lg_u32 s68, 1
    s_cbranch_scc1 L_rw_q9_1
    s_waitcnt vmcnt(4)
L_rw_q9_1:
    s_waitcnt lgkmcnt(0)
    s_barrier
    s_cmp_ge_u32 s68, 2
    s_cbranch_scc1 L_qd_12_e
    s_mov_b32 s64, s56
    s_add_u32 s65, s59, 0
    s_cmp_eq_u32 s68, 0
    s_cbranch_scc0 L_qd_12_w
    s_mov_b32 m0, s65
    s_nop 0
    buffer_load_dwordx4 v147, s[48:51], s64 offen lds
    s_add_u32 s64, s64, s57
    s_add_u32 s65, s65, s60
    s_mov_b32 m0, s65
    s_nop 0
    buffer_load_dwordx4 v147, s[48:51], s64 offen lds
    s_add_u32 s64, s64, s57
    s_add_u32 s65, s65, s60
    s_mov_b32 m0, s65
    s_nop 0
    buffer_load_dwordx4 v147, s[48:51], s64 offen lds
    s_branch L_qd_12_x
L_qd_12_w:
    s_mov_b32 m0, s65
    s_nop 0
    buffer_load_dwordx4 v147, s[48:51], s64 offen lds
    s_add_u32 s64, s64, s57
    s_add_u32 s65, s65, s60
    s_mov_b32 m0, s65
    s_nop 0
    buffer_load_dwordx4 v147, s[48:51], s64 offen lds
    s_add_u32 s64, s64, s57
    s_add_u32 s65, s65, s60
    s_mov_b32 m0, s65
    s_nop 0
    buffer_load_dwordx4 v147, s[48:51], s64 offen lds
    s_add_u32 s64, s64, s57
    s_add_u32 s65, s65, s60
    s_mov_b32 m0, s65
    s_nop 0
    buffer_load_dwordx4 v147, s[48:51], s64 offen lds
L_qd_12_x:
    s_add_u32 s56, s56, s58
L_qd_12_e:
    s_waitcnt lgkmcnt(0)
    v_mfma_f32_32x32x16_bf16 v[0:15], v[112:115], v[104:107], v[0:15]
    ds_read_b128 v[64:67], v144
    ds_read_b64_tr_b16 v[72:73], v146 offset:0
    ds_read_b64_tr_b16 v[74:75], v146 offset:512
    v_mfma_f32_32x32x16_bf16 v[16:31], v[116:119], v[104:107], v[16:31]
    ds_read_b64_tr_b16 v[76:77], v146 offset:64
    ds_read_b64_tr_b16 v[78:79], v146 offset:576
    ds_read_b64_tr_b16 v[80:81], v146 offset:128
    v_mfma_f32_32x32x16_bf16 v[32:47], v[120:123], v[104:107], v[32:47]
    ds_read_b64_tr_b16 v[82:83], v146 offset:640
    ds_read_b64_tr_b16 v[84:85], v146 offset:192
    v_mfma_f32_32x32x16_bf16 v[48:63], v[124:127], v[104:107], v[48:63]
    ds_read_b64_tr_b16 v[86:87], v146 offset:704
    ds_read_b128 v[68:71], v145
    v_mfma_f32_32x32x16_bf16 v[0:15], v[128:131], v[108:111], v[0:15]
    ds_read_b64_tr_b16 v[88:89], v146 offset:8704
    ds_read_b64_tr_b16 v[90:91], v146 offset:9216
    v_mfma_f32_32x32x16_bf16 v[16:31], v[132:135], v[108:111], v[16:31]
    ds_read_b64_tr_b16 v[92:93], v146 offset:8768
    ds_read_b64_tr_b16 v[94:95], v146 offset:9280
    v_mfma_f32_32x32x16_bf16 v[32:47], v[136:139], v[108:111], v[32:47]
    ds_read_b64_tr_b16 v[96:97], v146 offset:8832
    ds_read_b64_tr_b16 v[98:99], v146 offset:9344
    v_mfma_f32_32x32x16_bf16 v[48:63], v[140:143], v[108:111], v[48:63]
    ds_read_b64_tr_b16 v[100:101], v146 offset:8896
    ds_read_b64_tr_b16 v[102:103], v146 offset:9408
    v_add_u32 v144, 29696, v144
    v_add_u32 v145, 29696, v145
    v_add_u32 v146, 29696, v146
    s_cmp_lg_u32 s68, 0
    s_cbranch_scc1 L_rw_q10_0
    s_waitcnt vmcnt(3)
L_rw_q10_0:
    s_cmp_lg_u32 s68, 1
    s_cbranch_scc1 L_rw_q10_1
    s_waitcnt vmcnt(4)
L_rw_q10_1:
    s_waitcnt lgkmcnt(0)
    s_barrier
    s_cmp_ge_u32 s68, 2
    s_cbranch_scc1 L_qd_13_e
    s_mov_b32 s64, s56
    s_add_u32 s65, s59, 29696
    s_cmp_eq_u32 s68, 0
    s_cbranch_scc0 L_qd_13_w
    s_mov_b32 m0, s65
    s_nop 0
    buffer_load_dwordx4 v147, s[48:51], s64 offen lds
    s_add_u32 s64, s64, s57
    s_add_u32 s65, s65, s60
    s_mov_b32 m0, s65
    s_nop 0
    buffer_load_dwordx4 v147, s[48:51], s64 offen lds
    s_add_u32 s64, s64, s57
    s_add_u32 s65, s65, s60
    s_mov_b32 m0, s65
    s_nop 0
    buffer_load_dwordx4 v147, s[48:51], s64 offen lds
    s_branch L_qd_13_x
L_qd_13_w:
    s_mov_b32 m0, s65
    s_nop 0
    buffer_load_dwordx4 v147, s[48:51], s64 offen lds
    s_add_u32 s64, s64, s57
    s_add_u32 s65, s65, s60
    s_mov_b32 m0, s65
    s_nop 0
    buffer_load_dwordx4 v147, s[48:51], s64 offen lds
    s_add_u32 s64, s64, s57
    s_add_u32 s65, s65, s60
    s_mov_b32 m0, s65
    s_nop 0
    buffer_load_dwordx4 v147, s[48:51], s64 offen lds
    s_add_u32 s64, s64, s57
    s_add_u32 s65, s65, s60
    s_mov_b32 m0, s65
    s_nop 0
    buffer_load_dwordx4 v147, s[48:51], s64 offen lds
L_qd_13_x:
    s_add_u32 s56, s56, s58
L_qd_13_e:
    s_waitcnt lgkmcnt(0)
    v_mfma_f32_32x32x16_bf16 v[0:15], v[72:75], v[64:67], v[0:15]
    ds_read_b128 v[104:107], v144
    ds_read_b64_tr_b16 v[112:113], v146 offset:0
    ds_read_b64_tr_b16 v[114:115], v146 offset:512
    v_mfma_f32_32x32x16_bf16 v[16:31], v[76:79], v[64:67], v[16:31]
    ds_read_b64_tr_b16 v[116:117], v146 offset:64
    ds_read_b64_tr_b16 v[118:119], v146 offset:576
    ds_read_b64_tr_b16 v[120:121], v146 offset:128
    v_mfma_f32_32x32x16_bf16 v[32:47], v[80:83], v[64:67], v[32:47]
    ds_read_b64_tr_b16 v[122:123], v146 offset:640
    ds_read_b64_tr_b16 v[124:125], v146 offset:192
    v_mfma_f32_32x32x16_bf16 v[48:63], v[84:87], v[64:67], v[48:63]
    ds_read_b64_tr_b16 v[126:127], v146 offset:704
    ds_read_b128 v[108:111], v145
    v_mfma_f32_32x32x16_bf16 v[0:15], v[88:91], v[68:71], v[0:15]
    ds_read_b64_tr_b16 v[128:129], v146 offset:8704
    ds_read_b64_tr_b16 v[130:131], v146 offset:9216
    v_mfma_f32_32x32x16_bf16 v[16:31], v[92:95], v[68:71], v[16:31]
    ds_read_b64_tr_b16 v[132:133], v146 offset:8768
    ds_read_b64_tr_b16 v[134:135], v146 offset:9280
    v_mfma_f32_32x32x16_bf16 v[32:47], v[96:99], v[68:71], v[32:47]
    ds_read_b64_tr_b16 v[136:137], v146 offset:8832
    ds_read_b64_tr_b16 v[138:139], v146 offset:9344
    v_mfma_f32_32x32x16_bf16 v[48:63], v[100:103], v[68:71], v[48:63]
    ds_read_b64_tr_b16 v[140:141], v146 offset:8896
    ds_read_b64_tr_b16 v[142:143], v146 offset:9408
    v_subrev_u32 v144, 59392, v144
    v_subrev_u32 v145, 59392, v145
    v_subrev_u32 v146, 59392, v146
    s_cmp_lg_u32 s68, 0
    s_cbranch_scc1 L_rw_q11_0
    s_waitcnt vmcnt(3)
L_rw_q11_0:
    s_cmp_lg_u32 s68, 1
    s_cbranch_scc1 L_rw_q11_1
    s_waitcnt vmcnt(4)
L_rw_q11_1:
    s_waitcnt lgkmcnt(0)
    s_barrier
    s_cmp_ge_u32 s68, 2
    s_cbranch_scc1 L_qd_14_e
    s_mov_b32 s64, s56
    s_add_u32 s65, s59, 59392
    s_cmp_eq_u32 s68, 0
    s_cbranch_scc0 L_qd_14_w
    s_mov_b32 m0, s65
    s_nop 0
    buffer_load_dwordx4 v147, s[48:51], s64 offen lds
    s_add_u32 s64, s64, s57
    s_add_u32 s65, s65, s60
    s_mov_b32 m0, s65
    s_nop 0
    buffer_load_dwordx4 v147, s[48:51], s64 offen lds
    s_add_u32 s64, s64, s57
    s_add_u32 s65, s65, s60
    s_mov_b32 m0, s65
    s_nop 0
    buffer_load_dwordx4 v147, s[48:51], s64 offen lds
    s_branch L_qd_14_x
L_qd_14_w:
    s_mov_b32 m0, s65
    s_nop 0
    buffer_load_dwordx4 v147, s[48:51], s64 offen lds
    s_add_u32 s64, s64, s57
    s_add_u32 s65, s65, s60
    s_mov_b32 m0, s65
    s_nop 0
    buffer_load_dwordx4 v147, s[48:51], s64 offen lds
    s_add_u32 s64, s64, s57
    s_add_u32 s65, s65, s60
    s_mov_b32 m0, s65
    s_nop 0
    buffer_load_dwordx4 v147, s[48:51], s64 offen lds
    s_add_u32 s64, s64, s57
    s_add_u32 s65, s65, s60
    s_mov_b32 m0, s65
    s_nop 0
    buffer_load_dwordx4 v147, s[48:51], s64 offen lds
L_qd_14_x:
    s_add_u32 s56, s56, s58
L_qd_14_e:
    s_waitcnt lgkmcnt(0)
    v_mfma_f32_32x32x16_bf16 v[0:15], v[112:115], v[104:107], v[0:15]
    ds_read_b128 v[64:67], v144
    ds_read_b64_tr_b16 v[72:73], v146 offset:0
    ds_read_b64_tr_b16 v[74:75], v146 offset:512
    v_mfma_f32_32x32x16_bf16 v[16:31], v[116:119], v[104:107], v[16:31]
    ds_read_b64_tr_b16 v[76:77], v146 offset:64
    ds_read_b64_tr_b16 v[78:79], v146 offset:576
    ds_read_b64_tr_b16 v[80:81], v146 offset:128
    v_mfma_f32_32x32x16_bf16 v[32:47], v[120:123], v[104:107], v[32:47]
    ds_read_b64_tr_b16 v[82:83], v146 offset:640
    ds_read_b64_tr_b16 v[84:85], v146 offset:192
    v_mfma_f32_32x32x16_bf16 v[48:63], v[124:127], v[104:107], v[48:63]
    ds_read_b64_tr_b16 v[86:87], v146 offset:704
    ds_read_b128 v[68:71], v145
    v_mfma_f32_32x32x16_bf16 v[0:15], v[128:131], v[108:111], v[0:15]
    ds_read_b64_tr_b16 v[88:89], v146 offset:8704
    ds_read_b64_tr_b16 v[90:91], v146 offset:9216
    v_mfma_f32_32x32x16_bf16 v[16:31], v[132:135], v[108:111], v[16:31]
    ds_read_b64_tr_b16 v[92:93], v146 offset:8768
    ds_read_b64_tr_b16 v[94:95], v146 offset:9280
    v_mfma_f32_32x32x16_bf16 v[32:47], v[136:139], v[108:111], v[32:47]
    ds_read_b64_tr_b16 v[96:97], v146 offset:8832
    ds_read_b64_tr_b16 v[98:99], v146 offset:9344
    v_mfma_f32_32x32x16_bf16 v[48:63], v[140:143], v[108:111], v[48:63]
    ds_read_b64_tr_b16 v[100:101], v146 offset:8896
    ds_read_b64_tr_b16 v[102:103], v146 offset:9408
    v_add_u32 v144, 29696, v144
    v_add_u32 v145, 29696, v145
    v_add_u32 v146, 29696, v146
    s_cmp_lg_u32 s68, 0
    s_cbranch_scc1 L_rw_q12_0
    s_waitcnt vmcnt(3)
L_rw_q12_0:
    s_cmp_lg_u32 s68, 1
    s_cbranch_scc1 L_rw_q12_1
    s_waitcnt vmcnt(4)
L_rw_q12_1:
    s_waitcnt lgkmcnt(0)
    s_barrier
    s_cmp_ge_u32 s68, 2
    s_cbranch_scc1 L_qd_15_e
    s_mov_b32 s64, s56
    s_add_u32 s65, s59, 0
    s_cmp_eq_u32 s68, 0
    s_cbranch_scc0 L_qd_15_w
    s_mov_b32 m0, s65
    s_nop 0
    buffer_load_dwordx4 v147, s[48:51], s64 offen lds
    s_add_u32 s64, s64, s57
    s_add_u32 s65, s65, s60
    s_mov_b32 m0, s65
    s_nop 0
    buffer_load_dwordx4 v147, s[48:51], s64 offen lds
    s_add_u32 s64, s64, s57
    s_add_u32 s65, s65, s60
    s_mov_b32 m0, s65
    s_nop 0
    buffer_load_dwordx4 v147, s[48:51], s64 offen lds
    s_branch L_qd_15_x
L_qd_15_w:
    s_mov_b32 m0, s65
    s_nop 0
    buffer_load_dwordx4 v147, s[48:51], s64 offen lds
    s_add_u32 s64, s64, s57
    s_add_u32 s65, s65, s60
    s_mov_b32 m0, s65
    s_nop 0
    buffer_load_dwordx4 v147, s[48:51], s64 offen lds
    s_add_u32 s64, s64, s57
    s_add_u32 s65, s65, s60
    s_mov_b32 m0, s65
    s_nop 0
    buffer_load_dwordx4 v147, s[48:51], s64 offen lds
    s_add_u32 s64, s64, s57
    s_add_u32 s65, s65, s60
    s_mov_b32 m0, s65
    s_nop 0
    buffer_load_dwordx4 v147, s[48:51], s64 offen lds
L_qd_15_x:
    s_add_u32 s56, s56, s58
L_qd_15_e:
    s_cmp_lt_u32 s68, 2
    s_cbranch_scc1 L_r2_L_kd_p0
    s_cmp_lt_u32 s6, 10
    s_cbranch_scc0 L_kd_p0_v
    s_add_u32 s64, s61, 0
    s_add_u32 m0, s63, 0
    s_nop 0
    buffer_load_dwordx4 v163, s[52:55], s64 offen nt lds
    s_add_u32 s64, s61, 1024
    s_add_u32 m0, s63, 1088
    s_nop 0
    buffer_load_dwordx4 v163, s[52:55], s64 offen nt lds
    s_add_u32 s64, s61, 2048
    s_add_u32 m0, s63, 2176
    s_nop 0
    buffer_load_dwordx4 v163, s[52:55], s64 offen nt lds
    s_add_u32 s64, s61, 3072
    s_add_u32 m0, s63, 3264
    s_nop 0
    buffer_load_dwordx4 v163, s[52:55], s64 offen nt lds
    s_add_u32 s64, s61, 4096
    s_add_u32 m0, s63, 4352
    s_nop 0
    buffer_load_dwordx4 v163, s[52:55], s64 offen nt lds
    s_add_u32 s64, s61, 5120
    s_add_u32 m0, s63, 5440
    s_nop 0
    buffer_load_dwordx4 v163, s[52:55], s64 offen nt lds
    s_add_u32 s64, s61, 6144
    s_add_u32 m0, s63, 6528
    s_nop 0
    buffer_load_dwordx4 v163, s[52:55], s64 offen nt lds
    s_add_u32 s64, s61, 7168
    s_add_u32 m0, s63, 7616
    s_nop 0
    buffer_load_dwordx4 v163, s[52:55], s64 offen nt lds
    s_branch L_r2_L_kd_p0
L_kd_p0_v:
    s_add_u32 s64, s61, 0
    s_add_u32 m0, s63, 0
    s_nop 0
    buffer_load_dwordx4 v163, s[52:55], s64 offen nt lds
    s_add_u32 s64, s61, 256
    s_add_u32 m0, s63, 1088
    s_nop 0
    buffer_load_dwordx4 v163, s[52:55], s64 offen nt lds
    s_add_u32 s64, s61, 512
    s_add_u32 m0, s63, 2176
    s_nop 0
    buffer_load_dwordx4 v163, s[52:55], s64 offen nt lds
    s_add_u32 s64, s61, 768
    s_add_u32 m0, s63, 3264
    s_nop 0
    buffer_load_dwordx4 v163, s[52:55], s64 offen nt lds
    s_add_u32 s64, s61, 4096
    s_add_u32 m0, s63, 4352
    s_nop 0
    buffer_load_dwordx4 v163, s[52:55], s64 offen nt lds
    s_add_u32 s64, s61, 4352
    s_add_u32 m0, s63, 5440
    s_nop 0
    buffer_load_dwordx4 v163, s[52:55], s64 offen nt lds
    s_add_u32 s64, s61, 4608
    s_add_u32 m0, s63, 6528
    s_nop 0
    buffer_load_dwordx4 v163, s[52:55], s64 offen nt lds
    s_add_u32 s64, s61, 4864
    s_add_u32 m0, s63, 7616
    s_nop 0
    buffer_load_dwordx4 v163, s[52:55], s64 offen nt lds
L_r2_L_kd_p0:
    s_waitcnt lgkmcnt(0)
    v_mfma_f32_32x32x16_bf16 v[0:15], v[72:75], v[64:67], v[0:15]
    ds_read_b128 v[104:107], v144
    ds_read_b64_tr_b16 v[112:113], v146 offset:0
    ds_read_b64_tr_b16 v[114:115], v146 offset:512
    v_mfma_f32_32x32x16_bf16 v[16:31], v[76:79], v[64:67], v[16:31]
    ds_read_b64_tr_b16 v[116:117], v146 offset:64
    ds_read_b64_tr_b16 v[118:119], v146 offset:576
    ds_read_b64_tr_b16 v[120:121], v146 offset:128
    v_mfma_f32_32x32x16_bf16 v[32:47], v[80:83], v[64:67], v[32:47]
    ds_read_b64_tr_b16 v[122:123], v146 offset:640
    ds_read_b64_tr_b16 v[124:125], v146 offset:192
    v_mfma_f32_32x32x16_bf16 v[48:63], v[84:87], v[64:67], v[48:63]
    ds_read_b64_tr_b16 v[126:127], v146 offset:704
    ds_read_b128 v[108:111], v145
    v_mfma_f32_32x32x16_bf16 v[0:15], v[88:91], v[68:71], v[0:15]
    ds_read_b64_tr_b16 v[128:129], v146 offset:8704
    ds_read_b64_tr_b16 v[130:131], v146 offset:9216
    v_mfma_f32_32x32x16_bf16 v[16:31], v[92:95], v[68:71], v[16:31]
    ds_read_b64_tr_b16 v[132:133], v146 offset:8768
    ds_read_b64_tr_b16 v[134:135], v146 offset:9280
    v_mfma_f32_32x32x16_bf16 v[32:47], v[96:99], v[68:71], v[32:47]
    ds_read_b64_tr_b16 v[136:137], v146 offset:8832
    ds_read_b64_tr_b16 v[138:139], v146 offset:9344
    v_mfma_f32_32x32x16_bf16 v[48:63], v[100:103], v[68:71], v[48:63]
    ds_read_b64_tr_b16 v[140:141], v146 offset:8896
    ds_read_b64_tr_b16 v[142:143], v146 offset:9408
    v_add_u32 v144, 29696, v144
    v_add_u32 v145, 29696, v145
    v_add_u32 v146, 29696, v146
    s_cmp_lg_u32 s68, 0
    s_cbranch_scc1 L_rw_q13_0
    s_waitcnt vmcnt(3)
L_rw_q13_0:
    s_cmp_lg_u32 s68, 1
    s_cbranch_scc1 L_rw_q13_1
    s_waitcnt vmcnt(4)
L_rw_q13_1:
    s_waitcnt lgkmcnt(0)
    s_barrier
    s_cmp_ge_u32 s68, 2
    s_cbranch_scc1 L_qd_16_e
    s_mov_b32 s64, s56
    s_add_u32 s65, s59, 29696
    s_cmp_eq_u32 s68, 0
    s_cbranch_scc0 L_qd_16_w
    s_mov_b32 m0, s65
    s_nop 0
    buffer_load_dwordx4 v147, s[48:51], s64 offen lds
    s_add_u32 s64, s64, s57
    s_add_u32 s65, s65, s60
    s_mov_b32 m0, s65
    s_nop 0
    buffer_load_dwordx4 v147, s[48:51], s64 offen lds
    s_add_u32 s64, s64, s57
    s_add_u32 s65, s65, s60
    s_mov_b32 m0, s65
    s_nop 0
    buffer_load_dwordx4 v147, s[48:51], s64 offen lds
    s_branch L_qd_16_x
L_qd_16_w:
    s_mov_b32 m0, s65
    s_nop 0
    buffer_load_dwordx4 v147, s[48:51], s64 offen lds
    s_add_u32 s64, s64, s57
    s_add_u32 s65, s65, s60
    s_mov_b32 m0, s65
    s_nop 0
    buffer_load_dwordx4 v147, s[48:51], s64 offen lds
    s_add_u32 s64, s64, s57
    s_add_u32 s65, s65, s60
    s_mov_b32 m0, s65
    s_nop 0
    buffer_load_dwordx4 v147, s[48:51], s64 offen lds
    s_add_u32 s64, s64, s57
    s_add_u32 s65, s65, s60
    s_mov_b32 m0, s65
    s_nop 0
    buffer_load_dwordx4 v147, s[48:51], s64 offen lds
L_qd_16_x:
    s_add_u32 s56, s56, s58
L_qd_16_e:
    s_waitcnt lgkmcnt(0)
    v_mfma_f32_32x32x16_bf16 v[0:15], v[112:115], v[104:107], v[0:15]
    ds_read_b128 v[64:67], v144
    ds_read_b64_tr_b16 v[72:73], v146 offset:0
    ds_read_b64_tr_b16 v[74:75], v146 offset:512
    v_mfma_f32_32x32x16_bf16 v[16:31], v[116:119], v[104:107], v[16:31]
    ds_read_b64_tr_b16 v[76:77], v146 offset:64
    ds_read_b64_tr_b16 v[78:79], v146 offset:576
    ds_read_b64_tr_b16 v[80:81], v146 offset:128
    v_mfma_f32_32x32x16_bf16 v[32:47], v[120:123], v[104:107], v[32:47]
    ds_read_b64_tr_b16 v[82:83], v146 offset:640
    ds_read_b64_tr_b16 v[84:85], v146 offset:192
    v_mfma_f32_32x32x16_bf16 v[48:63], v[124:127], v[104:107], v[48:63]
    ds_read_b64_tr_b16 v[86:87], v146 offset:704
    ds_read_b128 v[68:71], v145
    v_mfma_f32_32x32x16_bf16 v[0:15], v[128:131], v[108:111], v[0:15]
    ds_read_b64_tr_b16 v[88:89], v146 offset:8704
    ds_read_b64_tr_b16 v[90:91], v146 offset:9216
    v_mfma_f32_32x32x16_bf16 v[16:31], v[132:135], v[108:111], v[16:31]
    ds_read_b64_tr_b16 v[92:93], v146 offset:8768
    ds_read_b64_tr_b16 v[94:95], v146 offset:9280
    v_mfma_f32_32x32x16_bf16 v[32:47], v[136:139], v[108:111], v[32:47]
    ds_read_b64_tr_b16 v[96:97], v146 offset:8832
    ds_read_b64_tr_b16 v[98:99], v146 offset:9344
    v_mfma_f32_32x32x16_bf16 v[48:63], v[140:143], v[108:111], v[48:63]
    ds_read_b64_tr_b16 v[100:101], v146 offset:8896
    ds_read_b64_tr_b16 v[102:103], v146 offset:9408
    v_subrev_u32 v144, 59392, v144
    v_subrev_u32 v145, 59392, v145
    v_subrev_u32 v146, 59392, v146
    s_cmp_lg_u32 s68, 0
    s_cbranch_scc1 L_rw_q14_0
    s_waitcnt vmcnt(3)
L_rw_q14_0:
    s_cmp_lg_u32 s68, 1
    s_cbranch_scc1 L_rw_q14_1
    s_waitcnt vmcnt(4)
L_rw_q14_1:
    s_waitcnt lgkmcnt(0)
    s_barrier
    s_cmp_ge_u32 s68, 2
    s_cbranch_scc1 L_qd_17_e
    s_mov_b32 s64, s56
    s_add_u32 s65, s59, 59392
    s_cmp_eq_u32 s68, 0
    s_cbranch_scc0 L_qd_17_w
    s_mov_b32 m0, s65
    s_nop 0
    buffer_load_dwordx4 v147, s[48:51], s64 offen lds
    s_add_u32 s64, s64, s57
    s_add_u32 s65, s65, s60
    s_mov_b32 m0, s65
    s_nop 0
    buffer_load_dwordx4 v147, s[48:51], s64 offen lds
    s_add_u32 s64, s64, s57
    s_add_u32 s65, s65, s60
    s_mov_b32 m0, s65
    s_nop 0
    buffer_load_dwordx4 v147, s[48:51], s64 offen lds
    s_branch L_qd_17_x
L_qd_17_w:
    s_mov_b32 m0, s65
    s_nop 0
    buffer_load_dwordx4 v147, s[48:51], s64 offen lds
    s_add_u32 s64, s64, s57
    s_add_u32 s65, s65, s60
    s_mov_b32 m0, s65
    s_nop 0
    buffer_load_dwordx4 v147, s[48:51], s64 offen lds
    s_add_u32 s64, s64, s57
    s_add_u32 s65, s65, s60
    s_mov_b32 m0, s65
    s_nop 0
    buffer_load_dwordx4 v147, s[48:51], s64 offen lds
    s_add_u32 s64, s64, s57
    s_add_u32 s65, s65, s60
    s_mov_b32 m0, s65
    s_nop 0
    buffer_load_dwordx4 v147, s[48:51], s64 offen lds
L_qd_17_x:
    s_add_u32 s56, s56, s58
L_qd_17_e:
    s_waitcnt lgkmcnt(0)
    v_mfma_f32_32x32x16_bf16 v[0:15], v[72:75], v[64:67], v[0:15]
    ds_read_b128 v[104:107], v144
    ds_read_b64_tr_b16 v[112:113], v146 offset:0
    ds_read_b64_tr_b16 v[114:115], v146 offset:512
    v_mfma_f32_32x32x16_bf16 v[16:31], v[76:79], v[64:67], v[16:31]
    ds_read_b64_tr_b16 v[116:117], v146 offset:64
    ds_read_b64_tr_b16 v[118:119], v146 offset:576
    ds_read_b64_tr_b16 v[120:121], v146 offset:128
    v_mfma_f32_32x32x16_bf16 v[32:47], v[80:83], v[64:67], v[32:47]
    ds_read_b64_tr_b16 v[122:123], v146 offset:640
    ds_read_b64_tr_b16 v[124:125], v146 offset:192
    v_mfma_f32_32x32x16_bf16 v[48:63], v[84:87], v[64:67], v[48:63]
    ds_read_b64_tr_b16 v[126:127], v146 offset:704
    ds_read_b128 v[108:111], v145
    v_mfma_f32_32x32x16_bf16 v[0:15], v[88:91], v[68:71], v[0:15]
    ds_read_b64_tr_b16 v[128:129], v146 offset:8704
    ds_read_b64_tr_b16 v[130:131], v146 offset:9216
    v_mfma_f32_32x32x16_bf16 v[16:31], v[92:95], v[68:71], v[16:31]
    ds_read_b64_tr_b16 v[132:133], v146 offset:8768
    ds_read_b64_tr_b16 v[134:135], v146 offset:9280
    v_mfma_f32_32x32x16_bf16 v[32:47], v[96:99], v[68:71], v[32:47]
    ds_read_b64_tr_b16 v[136:137], v146 offset:8832
    ds_read_b64_tr_b16 v[138:139], v146 offset:9344
    v_mfma_f32_32x32x16_bf16 v[48:63], v[100:103], v[68:71], v[48:63]
    ds_read_b64_tr_b16 v[140:141], v146 offset:8896
    ds_read_b64_tr_b16 v[142:143], v146 offset:9408
    v_add_u32 v144, 29696, v144
    v_add_u32 v145, 29696, v145
    v_add_u32 v146, 29696, v146
    s_cmp_lg_u32 s68, 0
    s_cbranch_scc1 L_rw_q15_0
    s_waitcnt vmcnt(3)
L_rw_q15_0:
    s_cmp_lg_u32 s68, 1
    s_cbranch_scc1 L_rw_q15_1
    s_waitcnt vmcnt(4)
L_rw_q15_1:
    s_waitcnt lgkmcnt(0)
    s_barrier
    s_cmp_ge_u32 s68, 2
    s_cbranch_scc1 L_qd_18_e
    s_mov_b32 s64, s56
    s_add_u32 s65, s59, 0
    s_cmp_eq_u32 s68, 0
    s_cbranch_scc0 L_qd_18_w
    s_mov_b32 m0, s65
    s_nop 0
    buffer_load_dwordx4 v147, s[48:51], s64 offen lds
    s_add_u32 s64, s64, s57
    s_add_u32 s65, s65, s60
    s_mov_b32 m0, s65
    s_nop 0
    buffer_load_dwordx4 v147, s[48:51], s64 offen lds
    s_add_u32 s64, s64, s57
    s_add_u32 s65, s65, s60
    s_mov_b32 m0, s65
    s_nop 0
    buffer_load_dwordx4 v147, s[48:51], s64 offen lds
    s_branch L_qd_18_x
L_qd_18_w:
    s_mov_b32 m0, s65
    s_nop 0
    buffer_load_dwordx4 v147, s[48:51], s64 offen lds
    s_add_u32 s64, s64, s57
    s_add_u32 s65, s65, s60
    s_mov_b32 m0, s65
    s_nop 0
    buffer_load_dwordx4 v147, s[48:51], s64 offen lds
    s_add_u32 s64, s64, s57
    s_add_u32 s65, s65, s60
    s_mov_b32 m0, s65
    s_nop 0
    buffer_load_dwordx4 v147, s[48:51], s64 offen lds
    s_add_u32 s64, s64, s57
    s_add_u32 s65, s65, s60
    s_mov_b32 m0, s65
    s_nop 0
    buffer_load_dwordx4 v147, s[48:51], s64 offen lds
L_qd_18_x:
    s_add_u32 s56, s56, s58
L_qd_18_e:
    s_cmp_lt_u32 s68, 2
    s_cbranch_scc1 L_r2_L_kd_p1
    s_cmp_lt_u32 s6, 10
    s_cbranch_scc0 L_kd_p1_v
    s_add_u32 s64, s61, 8192
    s_add_u32 m0, s63, 34816
    s_nop 0
    buffer_load_dwordx4 v163, s[52:55], s64 offen nt lds
    s_add_u32 s64, s61, 9216
    s_add_u32 m0, s63, 35904
    s_nop 0
    buffer_load_dwordx4 v163, s[52:55], s64 offen nt lds
    s_add_u32 s64, s61, 10240
    s_add_u32 m0, s63, 36992
    s_nop 0
    buffer_load_dwordx4 v163, s[52:55], s64 offen nt lds
    s_add_u32 s64, s61, 11264
    s_add_u32 m0, s63, 38080
    s_nop 0
    buffer_load_dwordx4 v163, s[52:55], s64 offen nt lds
    s_add_u32 s64, s61, 12288
    s_add_u32 m0, s63, 39168
    s_nop 0
    buffer_load_dwordx4 v163, s[52:55], s64 offen nt lds
    s_add_u32 s64, s61, 13312
    s_add_u32 m0, s63, 40256
    s_nop 0
    buffer_load_dwordx4 v163, s[52:55], s64 offen nt lds
    s_add_u32 s64, s61, 14336
    s_add_u32 m0, s63, 41344
    s_nop 0
    buffer_load_dwordx4 v163, s[52:55], s64 offen nt lds
    s_add_u32 s64, s61, 15360
    s_add_u32 m0, s63, 42432
    s_nop 0
    buffer_load_dwordx4 v163, s[52:55], s64 offen nt lds
    s_branch L_r2_L_kd_p1
L_kd_p1_v:
    s_add_u32 s64, s61, 8192
    s_add_u32 m0, s63, 34816
    s_nop 0
    buffer_load_dwordx4 v163, s[52:55], s64 offen nt lds
    s_add_u32 s64, s61, 8448
    s_add_u32 m0, s63, 35904
    s_nop 0
    buffer_load_dwordx4 v163, s[52:55], s64 offen nt lds
    s_add_u32 s64, s61, 8704
    s_add_u32 m0, s63, 36992
    s_nop 0
    buffer_load_dwordx4 v163, s[52:55], s64 offen nt lds
    s_add_u32 s64, s61, 8960
    s_add_u32 m0, s63, 38080
    s_nop 0
    buffer_load_dwordx4 v163, s[52:55], s64 offen nt lds
    s_add_u32 s64, s61, 12288
    s_add_u32 m0, s63, 39168
    s_nop 0
    buffer_load_dwordx4 v163, s[52:55], s64 offen nt lds
    s_add_u32 s64, s61, 12544
    s_add_u32 m0, s63, 40256
    s_nop 0
    buffer_load_dwordx4 v163, s[52:55], s64 offen nt lds
    s_add_u32 s64, s61, 12800
    s_add_u32 m0, s63, 41344
    s_nop 0
    buffer_load_dwordx4 v163, s[52:55], s64 offen nt lds
    s_add_u32 s64, s61, 13056
    s_add_u32 m0, s63, 42432
    s_nop 0
    buffer_load_dwordx4 v163, s[52:55], s64 offen nt lds
L_r2_L_kd_p1:
    s_waitcnt lgkmcnt(0)
    v_mfma_f32_32x32x16_bf16 v[0:15], v[112:115], v[104:107], v[0:15]
    ds_read_b128 v[64:67], v144
    ds_read_b64_tr_b16 v[72:73], v146 offset:0
    ds_read_b64_tr_b16 v[74:75], v146 offset:512
    v_mfma_f32_32x32x16_bf16 v[16:31], v[116:119], v[104:107], v[16:31]
    ds_read_b64_tr_b16 v[76:77], v146 offset:64
    ds_read_b64_tr_b16 v[78:79], v146 offset:576
    ds_read_b64_tr_b16 v[80:81], v146 offset:128
    v_mfma_f32_32x32x16_bf16 v[32:47], v[120:123], v[104:107], v[32:47]
    ds_read_b64_tr_b16 v[82:83], v146 offset:640
    ds_read_b64_tr_b16 v[84:85], v146 offset:192
    v_mfma_f32_32x32x16_bf16 v[48:63], v[124:127], v[104:107], v[48:63]
    ds_read_b64_tr_b16 v[86:87], v146 offset:704
    ds_read_b128 v[68:71], v145
    v_mfma_f32_32x32x16_bf16 v[0:15], v[128:131], v[108:111], v[0:15]
    ds_read_b64_tr_b16 v[88:89], v146 offset:8704
    ds_read_b64_tr_b16 v[90:91], v146 offset:9216
    v_mfma_f32_32x32x16_bf16 v[16:31], v[132:135], v[108:111], v[16:31]
    ds_read_b64_tr_b16 v[92:93], v146 offset:8768
    ds_read_b64_tr_b16 v[94:95], v146 offset:9280
    v_mfma_f32_32x32x16_bf16 v[32:47], v[136:139], v[108:111], v[32:47]
    ds_read_b64_tr_b16 v[96:97], v146 offset:8832
    ds_read_b64_tr_b16 v[98:99], v146 offset:9344
    v_mfma_f32_32x32x16_bf16 v[48:63], v[140:143], v[108:111], v[48:63]
    ds_read_b64_tr_b16 v[100:101], v146 offset:8896
    ds_read_b64_tr_b16 v[102:103], v146 offset:9408
    v_add_u32 v144, 29696, v144
    v_add_u32 v145, 29696, v145
    v_add_u32 v146, 29696, v146
    s_cmp_lg_u32 s68, 0
    s_cbranch_scc1 L_rw_q16_0
    s_waitcnt vmcnt(3)
L_rw_q16_0:
    s_cmp_lg_u32 s68, 1
    s_cbranch_scc1 L_rw_q16_1
    s_waitcnt vmcnt(4)
L_rw_q16_1:
    s_waitcnt lgkmcnt(0)
    s_barrier
    s_cmp_ge_u32 s68, 2
    s_cbranch_scc1 L_qd_19_e
    s_mov_b32 s64, s56
    s_add_u32 s65, s59, 29696
    s_cmp_eq_u32 s68, 0
    s_cbranch_scc0 L_qd_19_w
    s_mov_b32 m0, s65
    s_nop 0
    buffer_load_dwordx4 v147, s[48:51], s64 offen lds
    s_add_u32 s64, s64, s57
    s_add_u32 s65, s65, s60
    s_mov_b32 m0, s65
    s_nop 0
    buffer_load_dwordx4 v147, s[48:51], s64 offen lds
    s_add_u32 s64, s64, s57
    s_add_u32 s65, s65, s60
    s_mov_b32 m0, s65
    s_nop 0
    buffer_load_dwordx4 v147, s[48:51], s64 offen lds
    s_branch L_qd_19_x
L_qd_19_w:
    s_mov_b32 m0, s65
    s_nop 0
    buffer_load_dwordx4 v147, s[48:51], s64 offen lds
    s_add_u32 s64, s64, s57
    s_add_u32 s65, s65, s60
    s_mov_b32 m0, s65
    s_nop 0
    buffer_load_dwordx4 v147, s[48:51], s64 offen lds
    s_add_u32 s64, s64, s57
    s_add_u32 s65, s65, s60
    s_mov_b32 m0, s65
    s_nop 0
    buffer_load_dwordx4 v147, s[48:51], s64 offen lds
    s_add_u32 s64, s64, s57
    s_add_u32 s65, s65, s60
    s_mov_b32 m0, s65
    s_nop 0
    buffer_load_dwordx4 v147, s[48:51], s64 offen lds
L_qd_19_x:
    s_add_u32 s56, s56, s58
L_qd_19_e:
    s_waitcnt lgkmcnt(0)
    v_mfma_f32_32x32x16_bf16 v[0:15], v[72:75], v[64:67], v[0:15]
    ds_read_b128 v[104:107], v144
    ds_read_b64_tr_b16 v[112:113], v146 offset:0
    ds_read_b64_tr_b16 v[114:115], v146 offset:512
    v_mfma_f32_32x32x16_bf16 v[16:31], v[76:79], v[64:67], v[16:31]
    ds_read_b64_tr_b16 v[116:117], v146 offset:64
    ds_read_b64_tr_b16 v[118:119], v146 offset:576
    ds_read_b64_tr_b16 v[120:121], v146 offset:128
    v_mfma_f32_32x32x16_bf16 v[32:47], v[80:83], v[64:67], v[32:47]
    ds_read_b64_tr_b16 v[122:123], v146 offset:640
    ds_read_b64_tr_b16 v[124:125], v146 offset:192
    v_mfma_f32_32x32x16_bf16 v[48:63], v[84:87], v[64:67], v[48:63]
    ds_read_b64_tr_b16 v[126:127], v146 offset:704
    ds_read_b128 v[108:111], v145
    v_mfma_f32_32x32x16_bf16 v[0:15], v[88:91], v[68:71], v[0:15]
    ds_read_b64_tr_b16 v[128:129], v146 offset:8704
    ds_read_b64_tr_b16 v[130:131], v146 offset:9216
    v_mfma_f32_32x32x16_bf16 v[16:31], v[92:95], v[68:71], v[16:31]
    ds_read_b64_tr_b16 v[132:133], v146 offset:8768
    ds_read_b64_tr_b16 v[134:135], v146 offset:9280
    v_mfma_f32_32x32x16_bf16 v[32:47], v[96:99], v[68:71], v[32:47]
    ds_read_b64_tr_b16 v[136:137], v146 offset:8832
    ds_read_b64_tr_b16 v[138:139], v146 offset:9344
    v_mfma_f32_32x32x16_bf16 v[48:63], v[100:103], v[68:71], v[48:63]
    ds_read_b64_tr_b16 v[140:141], v146 offset:8896
    ds_read_b64_tr_b16 v[142:143], v146 offset:9408
    v_subrev_u32 v144, 59392, v144
    v_subrev_u32 v145, 59392, v145
    v_subrev_u32 v146, 59392, v146
    s_cmp_lg_u32 s68, 0
    s_cbranch_scc1 L_rw_q17_0
    s_waitcnt vmcnt(3)
L_rw_q17_0:
    s_cmp_lg_u32 s68, 1
    s_cbranch_scc1 L_rw_q17_1
    s_waitcnt vmcnt(4)
L_rw_q17_1:
    s_waitcnt lgkmcnt(0)
    s_barrier
    s_waitcnt lgkmcnt(0)
    v_mfma_f32_32x32x16_bf16 v[0:15], v[112:115], v[104:107], v[0:15]
    ds_read_b128 v[64:67], v144
    ds_read_b64_tr_b16 v[72:73], v146 offset:0
    ds_read_b64_tr_b16 v[74:75], v146 offset:512
    v_mfma_f32_32x32x16_bf16 v[16:31], v[116:119], v[104:107], v[16:31]
    ds_read_b64_tr_b16 v[76:77], v146 offset:64
    ds_read_b64_tr_b16 v[78:79], v146 offset:576
    ds_read_b64_tr_b16 v[80:81], v146 offset:128
    v_mfma_f32_32x32x16_bf16 v[32:47], v[120:123], v[104:107], v[32:47]
    ds_read_b64_tr_b16 v[82:83], v146 offset:640
    ds_read_b64_tr_b16 v[84:85], v146 offset:192
    v_mfma_f32_32x32x16_bf16 v[48:63], v[124:127], v[104:107], v[48:63]
    ds_read_b64_tr_b16 v[86:87], v146 offset:704
    ds_read_b128 v[68:71], v145
    v_mfma_f32_32x32x16_bf16 v[0:15], v[128:131], v[108:111], v[0:15]
    ds_read_b64_tr_b16 v[88:89], v146 offset:8704
    ds_read_b64_tr_b16 v[90:91], v146 offset:9216
    v_mfma_f32_32x32x16_bf16 v[16:31], v[132:135], v[108:111], v[16:31]
    ds_read_b64_tr_b16 v[92:93], v146 offset:8768
    ds_read_b64_tr_b16 v[94:95], v146 offset:9280
    v_mfma_f32_32x32x16_bf16 v[32:47], v[136:139], v[108:111], v[32:47]
    ds_read_b64_tr_b16 v[96:97], v146 offset:8832
    ds_read_b64_tr_b16 v[98:99], v146 offset:9344
    v_mfma_f32_32x32x16_bf16 v[48:63], v[140:143], v[108:111], v[48:63]
    ds_read_b64_tr_b16 v[100:101], v146 offset:8896
    ds_read_b64_tr_b16 v[102:103], v146 offset:9408
    v_add_u32 v144, 29696, v144
    v_add_u32 v145, 29696, v145
    v_add_u32 v146, 29696, v146
    s_cmp_lg_u32 s68, 0
    s_cbranch_scc1 L_rw_q18_0
    s_waitcnt vmcnt(0)
L_rw_q18_0:
    s_cmp_lg_u32 s68, 1
    s_cbranch_scc1 L_rw_q18_1
    s_waitcnt vmcnt(0)
L_rw_q18_1:
    s_waitcnt lgkmcnt(0)
    s_barrier
    s_waitcnt lgkmcnt(0)
    v_mfma_f32_32x32x16_bf16 v[0:15], v[72:75], v[64:67], v[0:15]
    ds_read_b128 v[104:107], v144
    ds_read_b64_tr_b16 v[112:113], v146 offset:0
    ds_read_b64_tr_b16 v[114:115], v146 offset:512
    v_mfma_f32_32x32x16_bf16 v[16:31], v[76:79], v[64:67], v[16:31]
    ds_read_b64_tr_b16 v[116:117], v146 offset:64
    ds_read_b64_tr_b16 v[118:119], v146 offset:576
    ds_read_b64_tr_b16 v[120:121], v146 offset:128
    v_mfma_f32_32x32x16_bf16 v[32:47], v[80:83], v[64:67], v[32:47]
    ds_read_b64_tr_b16 v[122:123], v146 offset:640
    ds_read_b64_tr_b16 v[124:125], v146 offset:192
    v_mfma_f32_32x32x16_bf16 v[48:63], v[84:87], v[64:67], v[48:63]
    ds_read_b64_tr_b16 v[126:127], v146 offset:704
    ds_read_b128 v[108:111], v145
    v_mfma_f32_32x32x16_bf16 v[0:15], v[88:91], v[68:71], v[0:15]
    ds_read_b64_tr_b16 v[128:129], v146 offset:8704
    ds_read_b64_tr_b16 v[130:131], v146 offset:9216
    v_mfma_f32_32x32x16_bf16 v[16:31], v[92:95], v[68:71], v[16:31]
    ds_read_b64_tr_b16 v[132:133], v146 offset:8768
    ds_read_b64_tr_b16 v[134:135], v146 offset:9280
    v_mfma_f32_32x32x16_bf16 v[32:47], v[96:99], v[68:71], v[32:47]
    ds_read_b64_tr_b16 v[136:137], v146 offset:8832
    ds_read_b64_tr_b16 v[138:139], v146 offset:9344
    v_mfma_f32_32x32x16_bf16 v[48:63], v[100:103], v[68:71], v[48:63]
    ds_read_b64_tr_b16 v[140:141], v146 offset:8896
    ds_read_b64_tr_b16 v[142:143], v146 offset:9408
    v_add_u32 v144, 29696, v144
    v_add_u32 v145, 29696, v145
    v_add_u32 v146, 29696, v146
    s_waitcnt lgkmcnt(0)
    s_barrier
    s_cmp_lt_u32 s68, 2
    s_cbranch_scc1 L_r2_L_kd_q19a
    s_cmp_lt_u32 s6, 10
    s_cbranch_scc0 L_kd_q19a_v
    s_add_u32 s64, s61, 16384
    s_add_u32 m0, s63, 69632
    s_nop 0
    buffer_load_dwordx4 v163, s[52:55], s64 offen nt lds
    s_add_u32 s64, s61, 17408
    s_add_u32 m0, s63, 70720
    s_nop 0
    buffer_load_dwordx4 v163, s[52:55], s64 offen nt lds
    s_add_u32 s64, s61, 18432
    s_add_u32 m0, s63, 71808
    s_nop 0
    buffer_load_dwordx4 v163, s[52:55], s64 offen nt lds
    s_add_u32 s64, s61, 19456
    s_add_u32 m0, s63, 72896
    s_nop 0
    buffer_load_dwordx4 v163, s[52:55], s64 offen nt lds
    s_add_u32 s64, s61, 20480
    s_add_u32 m0, s63, 73984
    s_nop 0
    buffer_load_dwordx4 v163, s[52:55], s64 offen nt lds
    s_add_u32 s64, s61, 21504
    s_add_u32 m0, s63, 75072
    s_nop 0
    buffer_load_dwordx4 v163, s[52:55], s64 offen nt lds
    s_add_u32 s64, s61, 22528
    s_add_u32 m0, s63, 76160
    s_nop 0
    buffer_load_dwordx4 v163, s[52:55], s64 offen nt lds
    s_add_u32 s64, s61, 23552
    s_add_u32 m0, s63, 77248
    s_nop 0
    buffer_load_dwordx4 v163, s[52:55], s64 offen nt lds
    s_branch L_r2_L_kd_q19a
L_kd_q19a_v:
    s_add_u32 s64, s61, 16384
    s_add_u32 m0, s63, 69632
    s_nop 0
    buffer_load_dwordx4 v163, s[52:55], s64 offen nt lds
    s_add_u32 s64, s61, 16640
    s_add_u32 m0, s63, 70720
    s_nop 0
    buffer_load_dwordx4 v163, s[52:55], s64 offen nt lds
    s_add_u32 s64, s61, 16896
    s_add_u32 m0, s63, 71808
    s_nop 0
    buffer_load_dwordx4 v163, s[52:55], s64 offen nt lds
    s_add_u32 s64, s61, 17152
    s_add_u32 m0, s63, 72896
    s_nop 0
    buffer_load_dwordx4 v163, s[52:55], s64 offen nt lds
    s_add_u32 s64, s61, 20480
    s_add_u32 m0, s63, 73984
    s_nop 0
    buffer_load_dwordx4 v163, s[52:55], s64 offen nt lds
    s_add_u32 s64, s61, 20736
    s_add_u32 m0, s63, 75072
    s_nop 0
    buffer_load_dwordx4 v163, s[52:55], s64 offen nt lds
    s_add_u32 s64, s61, 20992
    s_add_u32 m0, s63, 76160
    s_nop 0
    buffer_load_dwordx4 v163, s[52:55], s64 offen nt lds
    s_add_u32 s64, s61, 21248
    s_add_u32 m0, s63, 77248
    s_nop 0
    buffer_load_dwordx4 v163, s[52:55], s64 offen nt lds
L_r2_L_kd_q19a:
    s_cmp_lt_u32 s68, 2
    s_cbranch_scc1 L_r2_L_kd_q19b
    s_cmp_lt_u32 s6, 10
    s_cbranch_scc0 L_kd_q19b_v
    s_add_u32 s64, s61, 24576
    s_add_u32 m0, s63, 104448
    s_nop 0
    buffer_load_dwordx4 v163, s[52:55], s64 offen nt lds
    s_add_u32 s64, s61, 25600
    s_add_u32 m0, s63, 105536
    s_nop 0
    buffer_load_dwordx4 v163, s[52:55], s64 offen nt lds
    s_add_u32 s64, s61, 26624
    s_add_u32 m0, s63, 106624
    s_nop 0
    buffer_load_dwordx4 v163, s[52:55], s64 offen nt lds
    s_add_u32 s64, s61, 27648
    s_add_u32 m0, s63, 107712
    s_nop 0
    buffer_load_dwordx4 v163, s[52:55], s64 offen nt lds
    s_add_u32 s64, s61, 28672
    s_add_u32 m0, s63, 108800
    s_nop 0
    buffer_load_dwordx4 v163, s[52:55], s64 offen nt lds
    s_add_u32 s64, s61, 29696
    s_add_u32 m0, s63, 109888
    s_nop 0
    buffer_load_dwordx4 v163, s[52:55], s64 offen nt lds
    s_add_u32 s64, s61, 30720
    s_add_u32 m0, s63, 110976
    s_nop 0
    buffer_load_dwordx4 v163, s[52:55], s64 offen nt lds
    s_add_u32 s64, s61, 31744
    s_add_u32 m0, s63, 112064
    s_nop 0
    buffer_load_dwordx4 v163, s[52:55], s64 offen nt lds
    s_branch L_r2_L_kd_q19b
L_kd_q19b_v:
    s_add_u32 s64, s61, 24576
    s_add_u32 m0, s63, 104448
    s_nop 0
    buffer_load_dwordx4 v163, s[52:55], s64 offen nt lds
    s_add_u32 s64, s61, 24832
    s_add_u32 m0, s63, 105536
    s_nop 0
    buffer_load_dwordx4 v163, s[52:55], s64 offen nt lds
    s_add_u32 s64, s61, 25088
    s_add_u32 m0, s63, 106624
    s_nop 0
    buffer_load_dwordx4 v163, s[52:55], s64 offen nt lds
    s_add_u32 s64, s61, 25344
    s_add_u32 m0, s63, 107712
    s_nop 0
    buffer_load_dwordx4 v163, s[52:55], s64 offen nt lds
    s_add_u32 s64, s61, 28672
    s_add_u32 m0, s63, 108800
    s_nop 0
    buffer_load_dwordx4 v163, s[52:55], s64 offen nt lds
    s_add_u32 s64, s61, 28928
    s_add_u32 m0, s63, 109888
    s_nop 0
    buffer_load_dwordx4 v163, s[52:55], s64 offen nt lds
    s_add_u32 s64, s61, 29184
    s_add_u32 m0, s63, 110976
    s_nop 0
    buffer_load_dwordx4 v163, s[52:55], s64 offen nt lds
    s_add_u32 s64, s61, 29440
    s_add_u32 m0, s63, 112064
    s_nop 0
    buffer_load_dwordx4 v163, s[52:55], s64 offen nt lds
L_r2_L_kd_q19b:
    s_waitcnt lgkmcnt(0)
    v_mfma_f32_32x32x16_bf16 v[0:15], v[112:115], v[104:107], v[0:15]
    v_mfma_f32_32x32x16_bf16 v[16:31], v[116:119], v[104:107], v[16:31]
    v_mfma_f32_32x32x16_bf16 v[32:47], v[120:123], v[104:107], v[32:47]
    v_mfma_f32_32x32x16_bf16 v[48:63], v[124:127], v[104:107], v[48:63]
    v_mfma_f32_32x32x16_bf16 v[0:15], v[128:131], v[108:111], v[0:15]
    v_mfma_f32_32x32x16_bf16 v[16:31], v[132:135], v[108:111], v[16:31]
    v_mfma_f32_32x32x16_bf16 v[32:47], v[136:139], v[108:111], v[32:47]
    v_mfma_f32_32x32x16_bf16 v[48:63], v[140:143], v[108:111], v[48:63]
    s_cmp_lg_u32 s68, 2
    s_cbranch_scc1 L_rw_a_pre2_2
    s_waitcnt vmcnt(24)
L_rw_a_pre2_2:
    s_nop 15
    v_pk_mul_f32 v[0:1], v[0:1], s[70:71]
    v_cvt_pk_bf16_f32 v64, v0, v1
    v_pk_mul_f32 v[2:3], v[2:3], s[70:71]
    v_cvt_pk_bf16_f32 v65, v2, v3
    v_pk_mul_f32 v[4:5], v[4:5], s[70:71]
    v_cvt_pk_bf16_f32 v66, v4, v5
    v_pk_mul_f32 v[6:7], v[6:7], s[70:71]
    v_cvt_pk_bf16_f32 v67, v6, v7
    v_pk_mul_f32 v[8:9], v[8:9], s[70:71]
    v_cvt_pk_bf16_f32 v68, v8, v9
    v_pk_mul_f32 v[10:11], v[10:11], s[70:71]
    v_cvt_pk_bf16_f32 v69, v10, v11
    v_pk_mul_f32 v[12:13], v[12:13], s[70:71]
    v_cvt_pk_bf16_f32 v70, v12, v13
    v_pk_mul_f32 v[14:15], v[14:15], s[70:71]
    v_cvt_pk_bf16_f32 v71, v14, v15
    v_pk_mul_f32 v[16:17], v[16:17], s[70:71]
    v_cvt_pk_bf16_f32 v72, v16, v17
    v_pk_mul_f32 v[18:19], v[18:19], s[70:71]
    v_cvt_pk_bf16_f32 v73, v18, v19
    v_pk_mul_f32 v[20:21], v[20:21], s[70:71]
    v_cvt_pk_bf16_f32 v74, v20, v21
    v_pk_mul_f32 v[22:23], v[22:23], s[70:71]
    v_cvt_pk_bf16_f32 v75, v22, v23
    v_pk_mul_f32 v[24:25], v[24:25], s[70:71]
    v_cvt_pk_bf16_f32 v76, v24, v25
    v_pk_mul_f32 v[26:27], v[26:27], s[70:71]
    v_cvt_pk_bf16_f32 v77, v26, v27
    v_pk_mul_f32 v[28:29], v[28:29], s[70:71]
    v_cvt_pk_bf16_f32 v78, v28, v29
    v_pk_mul_f32 v[30:31], v[30:31], s[70:71]
    v_cvt_pk_bf16_f32 v79, v30, v31
    v_pk_mul_f32 v[32:33], v[32:33], s[70:71]
    v_cvt_pk_bf16_f32 v80, v32, v33
    v_pk_mul_f32 v[34:35], v[34:35], s[70:71]
    v_cvt_pk_bf16_f32 v81, v34, v35
    v_pk_mul_f32 v[36:37], v[36:37], s[70:71]
    v_cvt_pk_bf16_f32 v82, v36, v37
    v_pk_mul_f32 v[38:39], v[38:39], s[70:71]
    v_cvt_pk_bf16_f32 v83, v38, v39
    v_pk_mul_f32 v[40:41], v[40:41], s[70:71]
    v_cvt_pk_bf16_f32 v84, v40, v41
    v_pk_mul_f32 v[42:43], v[42:43], s[70:71]
    v_cvt_pk_bf16_f32 v85, v42, v43
    v_pk_mul_f32 v[44:45], v[44:45], s[70:71]
    v_cvt_pk_bf16_f32 v86, v44, v45
    v_pk_mul_f32 v[46:47], v[46:47], s[70:71]
    v_cvt_pk_bf16_f32 v87, v46, v47
    v_pk_mul_f32 v[48:49], v[48:49], s[70:71]
    v_cvt_pk_bf16_f32 v88, v48, v49
    v_pk_mul_f32 v[50:51], v[50:51], s[70:71]
    v_cvt_pk_bf16_f32 v89, v50, v51
    v_pk_mul_f32 v[52:53], v[52:53], s[70:71]
    v_cvt_pk_bf16_f32 v90, v52, v53
    v_pk_mul_f32 v[54:55], v[54:55], s[70:71]
    v_cvt_pk_bf16_f32 v91, v54, v55
    v_pk_mul_f32 v[56:57], v[56:57], s[70:71]
    v_cvt_pk_bf16_f32 v92, v56, v57
    v_pk_mul_f32 v[58:59], v[58:59], s[70:71]
    v_cvt_pk_bf16_f32 v93, v58, v59
    v_pk_mul_f32 v[60:61], v[60:61], s[70:71]
    v_cvt_pk_bf16_f32 v94, v60, v61
    v_pk_mul_f32 v[62:63], v[62:63], s[70:71]
    v_cvt_pk_bf16_f32 v95, v62, v63
    v_mov_b32 v164, 0
    s_barrier
    ds_read_b128 v[128:131], v160 offset:0
    ds_read_b128 v[132:135], v161 offset:0
    ds_read_b128 v[136:139], v160 offset:64
    ds_read_b128 v[140:143], v161 offset:64
    ds_read_b128 v[144:147], v160 offset:128
    ds_read_b128 v[148:151], v161 offset:128
    ds_read_b128 v[152:155], v160 offset:192
    ds_read_b128 v[156:159], v161 offset:192
    v_add_u32 v160, 34816, v160
    v_add_u32 v161, 34816, v161
    s_cmp_lg_u32 s68, 2
    s_cbranch_scc1 L_rw_a0_2
    s_waitcnt vmcnt(16)
L_rw_a0_2:
    s_barrier
    s_setprio 1
    s_waitcnt lgkmcnt(0)
    v_mfma_f32_32x32x16_bf16 v[96:111], v[128:131], v[64:67], 0
    v_mfma_f32_32x32x16_bf16 v[96:111], v[132:135], v[68:71], v[96:111]
    ds_read_b64_tr_b16 v[128:129], v162 offset:0
    ds_read_b64_tr_b16 v[130:131], v162 offset:512
    v_mfma_f32_32x32x16_bf16 v[96:111], v[136:139], v[72:75], v[96:111]
    ds_read_b64_tr_b16 v[132:133], v162 offset:64
    ds_read_b64_tr_b16 v[134:135], v162 offset:576
    v_mfma_f32_32x32x16_bf16 v[96:111], v[140:143], v[76:79], v[96:111]
    ds_read_b64_tr_b16 v[136:137], v162 offset:128
    ds_read_b64_tr_b16 v[138:139], v162 offset:640
    v_mfma_f32_32x32x16_bf16 v[96:111], v[144:147], v[80:83], v[96:111]
    ds_read_b64_tr_b16 v[140:141], v162 offset:192
    ds_read_b64_tr_b16 v[142:143], v162 offset:704
    v_mfma_f32_32x32x16_bf16 v[96:111], v[148:151], v[84:87], v[96:111]
    ds_read_b64_tr_b16 v[144:145], v162 offset:4352
    ds_read_b64_tr_b16 v[146:147], v162 offset:4864
    v_mfma_f32_32x32x16_bf16 v[96:111], v[152:155], v[88:91], v[96:111]
    ds_read_b64_tr_b16 v[148:149], v162 offset:4416
    ds_read_b64_tr_b16 v[150:151], v162 offset:4928
    v_mfma_f32_32x32x16_bf16 v[96:111], v[156:159], v[92:95], v[96:111]
    ds_read_b64_tr_b16 v[152:153], v162 offset:4480
    ds_read_b64_tr_b16 v[154:155], v162 offset:4992
    ds_read_b64_tr_b16 v[156:157], v162 offset:4544
    ds_read_b64_tr_b16 v[158:159], v162 offset:5056
    v_add_u32 v162, 34816, v162
    s_setprio 2
    s_nop 7
    s_nop 1
    v_max3_f32 v165, v96, v97, v98
    v_max3_f32 v166, v99, v100, v101
    v_max3_f32 v165, v165, v102, v103
    v_max3_f32 v166, v166, v104, v105
    v_max3_f32 v165, v165, v106, v107
    v_max3_f32 v166, v166, v108, v109
    v_max3_f32 v165, v165, v110, v111
    v_max_f32 v165, v165, v166
    v_mov_b32 v166, v165
    s_nop 1
    v_permlane32_swap_b32 v165, v166
    s_nop 1
    v_max_f32 v165, v165, v166
    v_sub_f32 v96, v96, v165
    v_sub_f32 v97, v97, v165
    v_sub_f32 v98, v98, v165
    v_sub_f32 v99, v99, v165
    v_sub_f32 v100, v100, v165
    v_sub_f32 v101, v101, v165
    v_sub_f32 v102, v102, v165
    v_sub_f32 v103, v103, v165
    v_sub_f32 v104, v104, v165
    v_sub_f32 v105, v105, v165
    v_sub_f32 v106, v106, v165
    v_sub_f32 v107, v107, v165
    v_sub_f32 v108, v108, v165
    v_sub_f32 v109, v109, v165
    v_sub_f32 v110, v110, v165
    v_sub_f32 v111, v111, v165
    v_sub_f32 v112, 0, v165
    v_sub_f32 v113, 0, v165
    v_sub_f32 v114, 0, v165
    v_sub_f32 v115, 0, v165
    v_sub_f32 v116, 0, v165
    v_sub_f32 v117, 0, v165
    v_sub_f32 v118, 0, v165
    v_sub_f32 v119, 0, v165
    v_sub_f32 v120, 0, v165
    v_sub_f32 v121, 0, v165
    v_sub_f32 v122, 0, v165
    v_sub_f32 v123, 0, v165
    v_sub_f32 v124, 0, v165
    v_sub_f32 v125, 0, v165
    v_sub_f32 v126, 0, v165
    v_sub_f32 v127, 0, v165
    v_exp_f32 v96, v96
    v_exp_f32 v97, v97
    v_exp_f32 v98, v98
    v_exp_f32 v99, v99
    v_exp_f32 v100, v100
    v_exp_f32 v101, v101
    v_exp_f32 v102, v102
    v_exp_f32 v103, v103
    v_exp_f32 v104, v104
    v_exp_f32 v105, v105
    v_exp_f32 v106, v106
    v_exp_f32 v107, v107
    v_exp_f32 v108, v108
    v_exp_f32 v109, v109
    v_exp_f32 v110, v110
    v_exp_f32 v111, v111
    v_add_f32 v164, v164, v96
    v_add_f32 v164, v164, v97
    v_add_f32 v164, v164, v98
    v_add_f32 v164, v164, v99
    v_add_f32 v164, v164, v100
    v_add_f32 v164, v164, v101
    v_add_f32 v164, v164, v102
    v_add_f32 v164, v164, v103
    v_add_f32 v164, v164, v104
    v_add_f32 v164, v164, v105
    v_add_f32 v164, v164, v106
    v_add_f32 v164, v164, v107
    v_add_f32 v164, v164, v108
    v_add_f32 v164, v164, v109
    v_add_f32 v164, v164, v110
    v_add_f32 v164, v164, v111
    v_cvt_pk_bf16_f32 v96, v96, v97
    v_cvt_pk_bf16_f32 v97, v98, v99
    v_cvt_pk_bf16_f32 v98, v100, v101
    v_cvt_pk_bf16_f32 v99, v102, v103
    v_cvt_pk_bf16_f32 v104, v104, v105
    v_cvt_pk_bf16_f32 v105, v106, v107
    v_cvt_pk_bf16_f32 v106, v108, v109
    v_cvt_pk_bf16_f32 v107, v110, v111
    s_setprio 0
    s_waitcnt lgkmcnt(0)
    v_mfma_f32_32x32x16_bf16 v[0:15], v[128:131], v[96:99], 0
    v_mfma_f32_32x32x16_bf16 v[16:31], v[132:135], v[96:99], 0
    ds_read_b128 v[128:131], v160 offset:0
    v_mfma_f32_32x32x16_bf16 v[32:47], v[136:139], v[96:99], 0
    ds_read_b128 v[132:135], v161 offset:0
    v_mfma_f32_32x32x16_bf16 v[48:63], v[140:143], v[96:99], 0
    ds_read_b128 v[136:139], v160 offset:64
    v_mfma_f32_32x32x16_bf16 v[0:15], v[144:147], v[104:107], v[0:15]
    ds_read_b128 v[140:143], v161 offset:64
    v_mfma_f32_32x32x16_bf16 v[16:31], v[148:151], v[104:107], v[16:31]
    ds_read_b128 v[144:147], v160 offset:128
    v_mfma_f32_32x32x16_bf16 v[32:47], v[152:155], v[104:107], v[32:47]
    ds_read_b128 v[148:151], v161 offset:128
    v_mfma_f32_32x32x16_bf16 v[48:63], v[156:159], v[104:107], v[48:63]
    ds_read_b128 v[152:155], v160 offset:192
    ds_read_b128 v[156:159], v161 offset:192
    v_add_u32 v160, 34816, v160
    v_add_u32 v161, 34816, v161
    s_cmp_lg_u32 s68, 2
    s_cbranch_scc1 L_rw_a1_2
    s_waitcnt vmcnt(8)
L_rw_a1_2:
    s_barrier
    s_cmp_lt_u32 s68, 2
    s_cbranch_scc1 L_r2_L_kd_a1
    s_cmp_lt_u32 s6, 10
    s_cbranch_scc0 L_kd_a1_v
    s_add_u32 s64, s61, 32768
    s_add_u32 m0, s63, 0
    s_nop 0
    buffer_load_dwordx4 v163, s[52:55], s64 offen nt lds
    s_add_u32 s64, s61, 33792
    s_add_u32 m0, s63, 1088
    s_nop 0
    buffer_load_dwordx4 v163, s[52:55], s64 offen nt lds
    s_add_u32 s64, s61, 34816
    s_add_u32 m0, s63, 2176
    s_nop 0
    buffer_load_dwordx4 v163, s[52:55], s64 offen nt lds
    s_add_u32 s64, s61, 35840
    s_add_u32 m0, s63, 3264
    s_nop 0
    buffer_load_dwordx4 v163, s[52:55], s64 offen nt lds
    s_add_u32 s64, s61, 36864
    s_add_u32 m0, s63, 4352
    s_nop 0
    buffer_load_dwordx4 v163, s[52:55], s64 offen nt lds
    s_add_u32 s64, s61, 37888
    s_add_u32 m0, s63, 5440
    s_nop 0
    buffer_load_dwordx4 v163, s[52:55], s64 offen nt lds
    s_add_u32 s64, s61, 38912
    s_add_u32 m0, s63, 6528
    s_nop 0
    buffer_load_dwordx4 v163, s[52:55], s64 offen nt lds
    s_add_u32 s64, s61, 39936
    s_add_u32 m0, s63, 7616
    s_nop 0
    buffer_load_dwordx4 v163, s[52:55], s64 offen nt lds
    s_branch L_r2_L_kd_a1
L_kd_a1_v:
    s_add_u32 s64, s61, 32768
    s_add_u32 m0, s63, 0
    s_nop 0
    buffer_load_dwordx4 v163, s[52:55], s64 offen nt lds
    s_add_u32 s64, s61, 33024
    s_add_u32 m0, s63, 1088
    s_nop 0
    buffer_load_dwordx4 v163, s[52:55], s64 offen nt lds
    s_add_u32 s64, s61, 33280
    s_add_u32 m0, s63, 2176
    s_nop 0
    buffer_load_dwordx4 v163, s[52:55], s64 offen nt lds
    s_add_u32 s64, s61, 33536
    s_add_u32 m0, s63, 3264
    s_nop 0
    buffer_load_dwordx4 v163, s[52:55], s64 offen nt lds
    s_add_u32 s64, s61, 36864
    s_add_u32 m0, s63, 4352
    s_nop 0
    buffer_load_dwordx4 v163, s[52:55], s64 offen nt lds
    s_add_u32 s64, s61, 37120
    s_add_u32 m0, s63, 5440
    s_nop 0
    buffer_load_dwordx4 v163, s[52:55], s64 offen nt lds
    s_add_u32 s64, s61, 37376
    s_add_u32 m0, s63, 6528
    s_nop 0
    buffer_load_dwordx4 v163, s[52:55], s64 offen nt lds
    s_add_u32 s64, s61, 37632
    s_add_u32 m0, s63, 7616
    s_nop 0
    buffer_load_dwordx4 v163, s[52:55], s64 offen nt lds
L_r2_L_kd_a1:
    s_setprio 1
    s_waitcnt lgkmcnt(0)
    v_mfma_f32_32x32x16_bf16 v[96:111], v[128:131], v[64:67], v[112:127]
    v_mfma_f32_32x32x16_bf16 v[96:111], v[132:135], v[68:71], v[96:111]
    ds_read_b64_tr_b16 v[128:129], v162 offset:0
    ds_read_b64_tr_b16 v[130:131], v162 offset:512
    v_mfma_f32_32x32x16_bf16 v[96:111], v[136:139], v[72:75], v[96:111]
    ds_read_b64_tr_b16 v[132:133], v162 offset:64
    ds_read_b64_tr_b16 v[134:135], v162 offset:576
    v_mfma_f32_32x32x16_bf16 v[96:111], v[140:143], v[76:79], v[96:111]
    ds_read_b64_tr_b16 v[136:137], v162 offset:128
    ds_read_b64_tr_b16 v[138:139], v162 offset:640
    v_mfma_f32_32x32x16_bf16 v[96:111], v[144:147], v[80:83], v[96:111]
    ds_read_b64_tr_b16 v[140:141], v162 offset:192
    ds_read_b64_tr_b16 v[142:143], v162 offset:704
    v_mfma_f32_32x32x16_bf16 v[96:111], v[148:151], v[84:87], v[96:111]
    ds_read_b64_tr_b16 v[144:145], v162 offset:4352
    ds_read_b64_tr_b16 v[146:147], v162 offset:4864
    v_mfma_f32_32x32x16_bf16 v[96:111], v[152:155], v[88:91], v[96:111]
    ds_read_b64_tr_b16 v[148:149], v162 offset:4416
    ds_read_b64_tr_b16 v[150:151], v162 offset:4928
    v_mfma_f32_32x32x16_bf16 v[96:111], v[156:159], v[92:95], v[96:111]
    ds_read_b64_tr_b16 v[152:153], v162 offset:4480
    ds_read_b64_tr_b16 v[154:155], v162 offset:4992
    ds_read_b64_tr_b16 v[156:157], v162 offset:4544
    ds_read_b64_tr_b16 v[158:159], v162 offset:5056
    v_add_u32 v162, 34816, v162
    s_setprio 2
    s_nop 7
    s_nop 1
    v_max3_f32 v165, v96, v97, v98
    v_max3_f32 v166, v99, v100, v101
    v_max3_f32 v165, v165, v102, v103
    v_max3_f32 v166, v166, v104, v105
    v_max3_f32 v165, v165, v106, v107
    v_max3_f32 v166, v166, v108, v109
    v_max3_f32 v165, v165, v110, v111
    v_max_f32 v165, v165, v166
    v_cmp_lt_f32 vcc, 0x41000000, v165
    s_cbranch_vccnz L_rare_1
L_back_1:
    v_exp_f32 v96, v96
    v_exp_f32 v97, v97
    v_exp_f32 v98, v98
    v_exp_f32 v99, v99
    v_exp_f32 v100, v100
    v_exp_f32 v101, v101
    v_exp_f32 v102, v102
    v_exp_f32 v103, v103
    v_exp_f32 v104, v104
    v_exp_f32 v105, v105
    v_exp_f32 v106, v106
    v_exp_f32 v107, v107
    v_exp_f32 v108, v108
    v_exp_f32 v109, v109
    v_exp_f32 v110, v110
    v_exp_f32 v111, v111
    v_add_f32 v164, v164, v96
    v_add_f32 v164, v164, v97
    v_add_f32 v164, v164, v98
    v_add_f32 v164, v164, v99
    v_add_f32 v164, v164, v100
    v_add_f32 v164, v164, v101
    v_add_f32 v164, v164, v102
    v_add_f32 v164, v164, v103
    v_add_f32 v164, v164, v104
    v_add_f32 v164, v164, v105
    v_add_f32 v164, v164, v106
    v_add_f32 v164, v164, v107
    v_add_f32 v164, v164, v108
    v_add_f32 v164, v164, v109
    v_add_f32 v164, v164, v110
    v_add_f32 v164, v164, v111
    v_cvt_pk_bf16_f32 v96, v96, v97
    v_cvt_pk_bf16_f32 v97, v98, v99
    v_cvt_pk_bf16_f32 v98, v100, v101
    v_cvt_pk_bf16_f32 v99, v102, v103
    v_cvt_pk_bf16_f32 v104, v104, v105
    v_cvt_pk_bf16_f32 v105, v106, v107
    v_cvt_pk_bf16_f32 v106, v108, v109
    v_cvt_pk_bf16_f32 v107, v110, v111
    s_setprio 0
    s_waitcnt lgkmcnt(0)
    v_mfma_f32_32x32x16_bf16 v[0:15], v[128:131], v[96:99], v[0:15]
    v_mfma_f32_32x32x16_bf16 v[16:31], v[132:135], v[96:99], v[16:31]
    ds_read_b128 v[128:131], v160 offset:0
    v_mfma_f32_32x32x16_bf16 v[32:47], v[136:139], v[96:99], v[32:47]
    ds_read_b128 v[132:135], v161 offset:0
    v_mfma_f32_32x32x16_bf16 v[48:63], v[140:143], v[96:99], v[48:63]
    ds_read_b128 v[136:139], v160 offset:64
    v_mfma_f32_32x32x16_bf16 v[0:15], v[144:147], v[104:107], v[0:15]
    ds_read_b128 v[140:143], v161 offset:64
    v_mfma_f32_32x32x16_bf16 v[16:31], v[148:151], v[104:107], v[16:31]
    ds_read_b128 v[144:147], v160 offset:128
    v_mfma_f32_32x32x16_bf16 v[32:47], v[152:155], v[104:107], v[32:47]
    ds_read_b128 v[148:151], v161 offset:128
    v_mfma_f32_32x32x16_bf16 v[48:63], v[156:159], v[104:107], v[48:63]
    ds_read_b128 v[152:155], v160 offset:192
    ds_read_b128 v[156:159], v161 offset:192
    v_add_u32 v160, 34816, v160
    v_add_u32 v161, 34816, v161
    s_cmp_lg_u32 s68, 2
    s_cbranch_scc1 L_rw_a2_2
    s_waitcnt vmcnt(8)
L_rw_a2_2:
    s_barrier
    s_cmp_lt_u32 s68, 2
    s_cbranch_scc1 L_r2_L_kd_a2
    s_cmp_lt_u32 s6, 10
    s_cbranch_scc0 L_kd_a2_v
    s_add_u32 s64, s61, 40960
    s_add_u32 m0, s63, 34816
    s_nop 0
    buffer_load_dwordx4 v163, s[52:55], s64 offen nt lds
    s_add_u32 s64, s61, 41984
    s_add_u32 m0, s63, 35904
    s_nop 0
    buffer_load_dwordx4 v163, s[52:55], s64 offen nt lds
    s_add_u32 s64, s61, 43008
    s_add_u32 m0, s63, 36992
    s_nop 0
    buffer_load_dwordx4 v163, s[52:55], s64 offen nt lds
    s_add_u32 s64, s61, 44032
    s_add_u32 m0, s63, 38080
    s_nop 0
    buffer_load_dwordx4 v163, s[52:55], s64 offen nt lds
    s_add_u32 s64, s61, 45056
    s_add_u32 m0, s63, 39168
    s_nop 0
    buffer_load_dwordx4 v163, s[52:55], s64 offen nt lds
    s_add_u32 s64, s61, 46080
    s_add_u32 m0, s63, 40256
    s_nop 0
    buffer_load_dwordx4 v163, s[52:55], s64 offen nt lds
    s_add_u32 s64, s61, 47104
    s_add_u32 m0, s63, 41344
    s_nop 0
    buffer_load_dwordx4 v163, s[52:55], s64 offen nt lds
    s_add_u32 s64, s61, 48128
    s_add_u32 m0, s63, 42432
    s_nop 0
    buffer_load_dwordx4 v163, s[52:55], s64 offen nt lds
    s_branch L_r2_L_kd_a2
L_kd_a2_v:
    s_add_u32 s64, s61, 40960
    s_add_u32 m0, s63, 34816
    s_nop 0
    buffer_load_dwordx4 v163, s[52:55], s64 offen nt lds
    s_add_u32 s64, s61, 41216
    s_add_u32 m0, s63, 35904
    s_nop 0
    buffer_load_dwordx4 v163, s[52:55], s64 offen nt lds
    s_add_u32 s64, s61, 41472
    s_add_u32 m0, s63, 36992
    s_nop 0
    buffer_load_dwordx4 v163, s[52:55], s64 offen nt lds
    s_add_u32 s64, s61, 41728
    s_add_u32 m0, s63, 38080
    s_nop 0
    buffer_load_dwordx4 v163, s[52:55], s64 offen nt lds
    s_add_u32 s64, s61, 45056
    s_add_u32 m0, s63, 39168
    s_nop 0
    buffer_load_dwordx4 v163, s[52:55], s64 offen nt lds
    s_add_u32 s64, s61, 45312
    s_add_u32 m0, s63, 40256
    s_nop 0
    buffer_load_dwordx4 v163, s[52:55], s64 offen nt lds
    s_add_u32 s64, s61, 45568
    s_add_u32 m0, s63, 41344
    s_nop 0
    buffer_load_dwordx4 v163, s[52:55], s64 offen nt lds
    s_add_u32 s64, s61, 45824
    s_add_u32 m0, s63, 42432
    s_nop 0
    buffer_load_dwordx4 v163, s[52:55], s64 offen nt lds
L_r2_L_kd_a2:
    s_setprio 1
    s_waitcnt lgkmcnt(0)
    v_mfma_f32_32x32x16_bf16 v[96:111], v[128:131], v[64:67], v[112:127]
    v_mfma_f32_32x32x16_bf16 v[96:111], v[132:135], v[68:71], v[96:111]
    ds_read_b64_tr_b16 v[128:129], v162 offset:0
    ds_read_b64_tr_b16 v[130:131], v162 offset:512
    v_mfma_f32_32x32x16_bf16 v[96:111], v[136:139], v[72:75], v[96:111]
    ds_read_b64_tr_b16 v[132:133], v162 offset:64
    ds_read_b64_tr_b16 v[134:135], v162 offset:576
    v_mfma_f32_32x32x16_bf16 v[96:111], v[140:143], v[76:79], v[96:111]
    ds_read_b64_tr_b16 v[136:137], v162 offset:128
    ds_read_b64_tr_b16 v[138:139], v162 offset:640
    v_mfma_f32_32x32x16_bf16 v[96:111], v[144:147], v[80:83], v[96:111]
    ds_read_b64_tr_b16 v[140:141], v162 offset:192
    ds_read_b64_tr_b16 v[142:143], v162 offset:704
    v_mfma_f32_32x32x16_bf16 v[96:111], v[148:151], v[84:87], v[96:111]
    ds_read_b64_tr_b16 v[144:145], v162 offset:4352
    ds_read_b64_tr_b16 v[146:147], v162 offset:4864
    v_mfma_f32_32x32x16_bf16 v[96:111], v[152:155], v[88:91], v[96:111]
    ds_read_b64_tr_b16 v[148:149], v162 offset:4416
    ds_read_b64_tr_b16 v[150:151], v162 offset:4928
    v_mfma_f32_32x32x16_bf16 v[96:111], v[156:159], v[92:95], v[96:111]
    ds_read_b64_tr_b16 v[152:153], v162 offset:4480
    ds_read_b64_tr_b16 v[154:155], v162 offset:4992
    ds_read_b64_tr_b16 v[156:157], v162 offset:4544
    ds_read_b64_tr_b16 v[158:159], v162 offset:5056
    v_add_u32 v162, 34816, v162
    s_setprio 2
    s_nop 7
    s_nop 1
    v_max3_f32 v165, v96, v97, v98
    v_max3_f32 v166, v99, v100, v101
    v_max3_f32 v165, v165, v102, v103
    v_max3_f32 v166, v166, v104, v105
    v_max3_f32 v165, v165, v106, v107
    v_max3_f32 v166, v166, v108, v109
    v_max3_f32 v165, v165, v110, v111
    v_max_f32 v165, v165, v166
    v_cmp_lt_f32 vcc, 0x41000000, v165
    s_cbranch_vccnz L_rare_2
L_back_2:
    v_exp_f32 v96, v96
    v_exp_f32 v97, v97
    v_exp_f32 v98, v98
    v_exp_f32 v99, v99
    v_exp_f32 v100, v100
    v_exp_f32 v101, v101
    v_exp_f32 v102, v102
    v_exp_f32 v103, v103
    v_exp_f32 v104, v104
    v_exp_f32 v105, v105
    v_exp_f32 v106, v106
    v_exp_f32 v107, v107
    v_exp_f32 v108, v108
    v_exp_f32 v109, v109
    v_exp_f32 v110, v110
    v_exp_f32 v111, v111
    v_add_f32 v164, v164, v96
    v_add_f32 v164, v164, v97
    v_add_f32 v164, v164, v98
    v_add_f32 v164, v164, v99
    v_add_f32 v164, v164, v100
    v_add_f32 v164, v164, v101
    v_add_f32 v164, v164, v102
    v_add_f32 v164, v164, v103
    v_add_f32 v164, v164, v104
    v_add_f32 v164, v164, v105
    v_add_f32 v164, v164, v106
    v_add_f32 v164, v164, v107
    v_add_f32 v164, v164, v108
    v_add_f32 v164, v164, v109
    v_add_f32 v164, v164, v110
    v_add_f32 v164, v164, v111
    v_cvt_pk_bf16_f32 v96, v96, v97
    v_cvt_pk_bf16_f32 v97, v98, v99
    v_cvt_pk_bf16_f32 v98, v100, v101
    v_cvt_pk_bf16_f32 v99, v102, v103
    v_cvt_pk_bf16_f32 v104, v104, v105
    v_cvt_pk_bf16_f32 v105, v106, v107
    v_cvt_pk_bf16_f32 v106, v108, v109
    v_cvt_pk_bf16_f32 v107, v110, v111
    s_setprio 0
    s_waitcnt lgkmcnt(0)
    v_mfma_f32_32x32x16_bf16 v[0:15], v[128:131], v[96:99], v[0:15]
    v_mfma_f32_32x32x16_bf16 v[16:31], v[132:135], v[96:99], v[16:31]
    ds_read_b128 v[128:131], v160 offset:0
    v_mfma_f32_32x32x16_bf16 v[32:47], v[136:139], v[96:99], v[32:47]
    ds_read_b128 v[132:135], v161 offset:0
    v_mfma_f32_32x32x16_bf16 v[48:63], v[140:143], v[96:99], v[48:63]
    ds_read_b128 v[136:139], v160 offset:64
    v_mfma_f32_32x32x16_bf16 v[0:15], v[144:147], v[104:107], v[0:15]
    ds_read_b128 v[140:143], v161 offset:64
    v_mfma_f32_32x32x16_bf16 v[16:31], v[148:151], v[104:107], v[16:31]
    ds_read_b128 v[144:147], v160 offset:128
    v_mfma_f32_32x32x16_bf16 v[32:47], v[152:155], v[104:107], v[32:47]
    ds_read_b128 v[148:151], v161 offset:128
    v_mfma_f32_32x32x16_bf16 v[48:63], v[156:159], v[104:107], v[48:63]
    ds_read_b128 v[152:155], v160 offset:192
    ds_read_b128 v[156:159], v161 offset:192
    v_subrev_u32 v160, 104448, v160
    v_subrev_u32 v161, 104448, v161
    s_cmp_lg_u32 s68, 2
    s_cbranch_scc1 L_rw_a3_2
    s_waitcnt vmcnt(8)
L_rw_a3_2:
    s_barrier
    s_cmp_lt_u32 s68, 2
    s_cbranch_scc1 L_r2_L_kd_a3
    s_cmp_lt_u32 s6, 10
    s_cbranch_scc0 L_kd_a3_v
    s_add_u32 s64, s61, 49152
    s_add_u32 m0, s63, 69632
    s_nop 0
    buffer_load_dwordx4 v163, s[52:55], s64 offen nt lds
    s_add_u32 s64, s61, 50176
    s_add_u32 m0, s63, 70720
    s_nop 0
    buffer_load_dwordx4 v163, s[52:55], s64 offen nt lds
    s_add_u32 s64, s61, 51200
    s_add_u32 m0, s63, 71808
    s_nop 0
    buffer_load_dwordx4 v163, s[52:55], s64 offen nt lds
    s_add_u32 s64, s61, 52224
    s_add_u32 m0, s63, 72896
    s_nop 0
    buffer_load_dwordx4 v163, s[52:55], s64 offen nt lds
    s_add_u32 s64, s61, 53248
    s_add_u32 m0, s63, 73984
    s_nop 0
    buffer_load_dwordx4 v163, s[52:55], s64 offen nt lds
    s_add_u32 s64, s61, 54272
    s_add_u32 m0, s63, 75072
    s_nop 0
    buffer_load_dwordx4 v163, s[52:55], s64 offen nt lds
    s_add_u32 s64, s61, 55296
    s_add_u32 m0, s63, 76160
    s_nop 0
    buffer_load_dwordx4 v163, s[52:55], s64 offen nt lds
    s_add_u32 s64, s61, 56320
    s_add_u32 m0, s63, 77248
    s_nop 0
    buffer_load_dwordx4 v163, s[52:55], s64 offen nt lds
    s_branch L_r2_L_kd_a3
L_kd_a3_v:
    s_add_u32 s64, s61, 49152
    s_add_u32 m0, s63, 69632
    s_nop 0
    buffer_load_dwordx4 v163, s[52:55], s64 offen nt lds
    s_add_u32 s64, s61, 49408
    s_add_u32 m0, s63, 70720
    s_nop 0
    buffer_load_dwordx4 v163, s[52:55], s64 offen nt lds
    s_add_u32 s64, s61, 49664
    s_add_u32 m0, s63, 71808
    s_nop 0
    buffer_load_dwordx4 v163, s[52:55], s64 offen nt lds
    s_add_u32 s64, s61, 49920
    s_add_u32 m0, s63, 72896
    s_nop 0
    buffer_load_dwordx4 v163, s[52:55], s64 offen nt lds
    s_add_u32 s64, s61, 53248
    s_add_u32 m0, s63, 73984
    s_nop 0
    buffer_load_dwordx4 v163, s[52:55], s64 offen nt lds
    s_add_u32 s64, s61, 53504
    s_add_u32 m0, s63, 75072
    s_nop 0
    buffer_load_dwordx4 v163, s[52:55], s64 offen nt lds
    s_add_u32 s64, s61, 53760
    s_add_u32 m0, s63, 76160
    s_nop 0
    buffer_load_dwordx4 v163, s[52:55], s64 offen nt lds
    s_add_u32 s64, s61, 54016
    s_add_u32 m0, s63, 77248
    s_nop 0
    buffer_load_dwordx4 v163, s[52:55], s64 offen nt lds
L_r2_L_kd_a3:
    s_setprio 1
    s_waitcnt lgkmcnt(0)
    v_mfma_f32_32x32x16_bf16 v[96:111], v[128:131], v[64:67], v[112:127]
    v_mfma_f32_32x32x16_bf16 v[96:111], v[132:135], v[68:71], v[96:111]
    ds_read_b64_tr_b16 v[128:129], v162 offset:0
    ds_read_b64_tr_b16 v[130:131], v162 offset:512
    v_mfma_f32_32x32x16_bf16 v[96:111], v[136:139], v[72:75], v[96:111]
    ds_read_b64_tr_b16 v[132:133], v162 offset:64
    ds_read_b64_tr_b16 v[134:135], v162 offset:576
    v_mfma_f32_32x32x16_bf16 v[96:111], v[140:143], v[76:79], v[96:111]
    ds_read_b64_tr_b16 v[136:137], v162 offset:128
    ds_read_b64_tr_b16 v[138:139], v162 offset:640
    v_mfma_f32_32x32x16_bf16 v[96:111], v[144:147], v[80:83], v[96:111]
    ds_read_b64_tr_b16 v[140:141], v162 offset:192
    ds_read_b64_tr_b16 v[142:143], v162 offset:704
    v_mfma_f32_32x32x16_bf16 v[96:111], v[148:151], v[84:87], v[96:111]
    ds_read_b64_tr_b16 v[144:145], v162 offset:4352
    ds_read_b64_tr_b16 v[146:147], v162 offset:4864
    v_mfma_f32_32x32x16_bf16 v[96:111], v[152:155], v[88:91], v[96:111]
    ds_read_b64_tr_b16 v[148:149], v162 offset:4416
    ds_read_b64_tr_b16 v[150:151], v162 offset:4928
    v_mfma_f32_32x32x16_bf16 v[96:111], v[156:159], v[92:95], v[96:111]
    ds_read_b64_tr_b16 v[152:153], v162 offset:4480
    ds_read_b64_tr_b16 v[154:155], v162 offset:4992
    ds_read_b64_tr_b16 v[156:157], v162 offset:4544
    ds_read_b64_tr_b16 v[158:159], v162 offset:5056
    v_subrev_u32 v162, 104448, v162
    s_setprio 2
    s_nop 7
    s_nop 1
    v_max3_f32 v165, v96, v97, v98
    v_max3_f32 v166, v99, v100, v101
    v_max3_f32 v165, v165, v102, v103
    v_max3_f32 v166, v166, v104, v105
    v_max3_f32 v165, v165, v106, v107
    v_max3_f32 v166, v166, v108, v109
    v_max3_f32 v165, v165, v110, v111
    v_max_f32 v165, v165, v166
    v_cmp_lt_f32 vcc, 0x41000000, v165
    s_cbranch_vccnz L_rare_3
L_back_3:
    v_exp_f32 v96, v96
    v_exp_f32 v97, v97
    v_exp_f32 v98, v98
    v_exp_f32 v99, v99
    v_exp_f32 v100, v100
    v_exp_f32 v101, v101
    v_exp_f32 v102, v102
    v_exp_f32 v103, v103
    v_exp_f32 v104, v104
    v_exp_f32 v105, v105
    v_exp_f32 v106, v106
    v_exp_f32 v107, v107
    v_exp_f32 v108, v108
    v_exp_f32 v109, v109
    v_exp_f32 v110, v110
    v_exp_f32 v111, v111
    v_add_f32 v164, v164, v96
    v_add_f32 v164, v164, v97
    v_add_f32 v164, v164, v98
    v_add_f32 v164, v164, v99
    v_add_f32 v164, v164, v100
    v_add_f32 v164, v164, v101
    v_add_f32 v164, v164, v102
    v_add_f32 v164, v164, v103
    v_add_f32 v164, v164, v104
    v_add_f32 v164, v164, v105
    v_add_f32 v164, v164, v106
    v_add_f32 v164, v164, v107
    v_add_f32 v164, v164, v108
    v_add_f32 v164, v164, v109
    v_add_f32 v164, v164, v110
    v_add_f32 v164, v164, v111
    v_cvt_pk_bf16_f32 v96, v96, v97
    v_cvt_pk_bf16_f32 v97, v98, v99
    v_cvt_pk_bf16_f32 v98, v100, v101
    v_cvt_pk_bf16_f32 v99, v102, v103
    v_cvt_pk_bf16_f32 v104, v104, v105
    v_cvt_pk_bf16_f32 v105, v106, v107
    v_cvt_pk_bf16_f32 v106, v108, v109
    v_cvt_pk_bf16_f32 v107, v110, v111
    s_setprio 0
    s_waitcnt lgkmcnt(0)
    v_mfma_f32_32x32x16_bf16 v[0:15], v[128:131], v[96:99], v[0:15]
    v_mfma_f32_32x32x16_bf16 v[16:31], v[132:135], v[96:99], v[16:31]
    ds_read_b128 v[128:131], v160 offset:0
    v_mfma_f32_32x32x16_bf16 v[32:47], v[136:139], v[96:99], v[32:47]
    ds_read_b128 v[132:135], v161 offset:0
    v_mfma_f32_32x32x16_bf16 v[48:63], v[140:143], v[96:99], v[48:63]
    ds_read_b128 v[136:139], v160 offset:64
    v_mfma_f32_32x32x16_bf16 v[0:15], v[144:147], v[104:107], v[0:15]
    ds_read_b128 v[140:143], v161 offset:64
    v_mfma_f32_32x32x16_bf16 v[16:31], v[148:151], v[104:107], v[16:31]
    ds_read_b128 v[144:147], v160 offset:128
    v_mfma_f32_32x32x16_bf16 v[32:47], v[152:155], v[104:107], v[32:47]
    ds_read_b128 v[148:151], v161 offset:128
    v_mfma_f32_32x32x16_bf16 v[48:63], v[156:159], v[104:107], v[48:63]
    ds_read_b128 v[152:155], v160 offset:192
    ds_read_b128 v[156:159], v161 offset:192
    v_add_u32 v160, 34816, v160
    v_add_u32 v161, 34816, v161
    s_cmp_lg_u32 s68, 2
    s_cbranch_scc1 L_rw_a4_2
    s_waitcnt vmcnt(8)
L_rw_a4_2:
    s_barrier
    s_cmp_lt_u32 s68, 2
    s_cbranch_scc1 L_r2_L_kd_a4
    s_cmp_lt_u32 s6, 10
    s_cbranch_scc0 L_kd_a4_v
    s_add_u32 s64, s61, 57344
    s_add_u32 m0, s63, 104448
    s_nop 0
    buffer_load_dwordx4 v163, s[52:55], s64 offen nt lds
    s_add_u32 s64, s61, 58368
    s_add_u32 m0, s63, 105536
    s_nop 0
    buffer_load_dwordx4 v163, s[52:55], s64 offen nt lds
    s_add_u32 s64, s61, 59392
    s_add_u32 m0, s63, 106624
    s_nop 0
    buffer_load_dwordx4 v163, s[52:55], s64 offen nt lds
    s_add_u32 s64, s61, 60416
    s_add_u32 m0, s63, 107712
    s_nop 0
    buffer_load_dwordx4 v163, s[52:55], s64 offen nt lds
    s_add_u32 s64, s61, 61440
    s_add_u32 m0, s63, 108800
    s_nop 0
    buffer_load_dwordx4 v163, s[52:55], s64 offen nt lds
    s_add_u32 s64, s61, 62464
    s_add_u32 m0, s63, 109888
    s_nop 0
    buffer_load_dwordx4 v163, s[52:55], s64 offen nt lds
    s_add_u32 s64, s61, 63488
    s_add_u32 m0, s63, 110976
    s_nop 0
    buffer_load_dwordx4 v163, s[52:55], s64 offen nt lds
    s_add_u32 s64, s61, 64512
    s_add_u32 m0, s63, 112064
    s_nop 0
    buffer_load_dwordx4 v163, s[52:55], s64 offen nt lds
    s_branch L_r2_L_kd_a4
L_kd_a4_v:
    s_add_u32 s64, s61, 57344
    s_add_u32 m0, s63, 104448
    s_nop 0
    buffer_load_dwordx4 v163, s[52:55], s64 offen nt lds
    s_add_u32 s64, s61, 57600
    s_add_u32 m0, s63, 105536
    s_nop 0
    buffer_load_dwordx4 v163, s[52:55], s64 offen nt lds
    s_add_u32 s64, s61, 57856
    s_add_u32 m0, s63, 106624
    s_nop 0
    buffer_load_dwordx4 v163, s[52:55], s64 offen nt lds
    s_add_u32 s64, s61, 58112
    s_add_u32 m0, s63, 107712
    s_nop 0
    buffer_load_dwordx4 v163, s[52:55], s64 offen nt lds
    s_add_u32 s64, s61, 61440
    s_add_u32 m0, s63, 108800
    s_nop 0
    buffer_load_dwordx4 v163, s[52:55], s64 offen nt lds
    s_add_u32 s64, s61, 61696
    s_add_u32 m0, s63, 109888
    s_nop 0
    buffer_load_dwordx4 v163, s[52:55], s64 offen nt lds
    s_add_u32 s64, s61, 61952
    s_add_u32 m0, s63, 110976
    s_nop 0
    buffer_load_dwordx4 v163, s[52:55], s64 offen nt lds
    s_add_u32 s64, s61, 62208
    s_add_u32 m0, s63, 112064
    s_nop 0
    buffer_load_dwordx4 v163, s[52:55], s64 offen nt lds
L_r2_L_kd_a4:
    s_setprio 1
    s_waitcnt lgkmcnt(0)
    v_mfma_f32_32x32x16_bf16 v[96:111], v[128:131], v[64:67], v[112:127]
    v_mfma_f32_32x32x16_bf16 v[96:111], v[132:135], v[68:71], v[96:111]
    ds_read_b64_tr_b16 v[128:129], v162 offset:0
    ds_read_b64_tr_b16 v[130:131], v162 offset:512
    v_mfma_f32_32x32x16_bf16 v[96:111], v[136:139], v[72:75], v[96:111]
    ds_read_b64_tr_b16 v[132:133], v162 offset:64
    ds_read_b64_tr_b16 v[134:135], v162 offset:576
    v_mfma_f32_32x32x16_bf16 v[96:111], v[140:143], v[76:79], v[96:111]
    ds_read_b64_tr_b16 v[136:137], v162 offset:128
    ds_read_b64_tr_b16 v[138:139], v162 offset:640
    v_mfma_f32_32x32x16_bf16 v[96:111], v[144:147], v[80:83], v[96:111]
    ds_read_b64_tr_b16 v[140:141], v162 offset:192
    ds_read_b64_tr_b16 v[142:143], v162 offset:704
    v_mfma_f32_32x32x16_bf16 v[96:111], v[148:151], v[84:87], v[96:111]
    ds_read_b64_tr_b16 v[144:145], v162 offset:4352
    ds_read_b64_tr_b16 v[146:147], v162 offset:4864
    v_mfma_f32_32x32x16_bf16 v[96:111], v[152:155], v[88:91], v[96:111]
    ds_read_b64_tr_b16 v[148:149], v162 offset:4416
    ds_read_b64_tr_b16 v[150:151], v162 offset:4928
    v_mfma_f32_32x32x16_bf16 v[96:111], v[156:159], v[92:95], v[96:111]
    ds_read_b64_tr_b16 v[152:153], v162 offset:4480
    ds_read_b64_tr_b16 v[154:155], v162 offset:4992
    ds_read_b64_tr_b16 v[156:157], v162 offset:4544
    ds_read_b64_tr_b16 v[158:159], v162 offset:5056
    v_add_u32 v162, 34816, v162
    s_setprio 2
    s_nop 7
    s_nop 1
    v_max3_f32 v165, v96, v97, v98
    v_max3_f32 v166, v99, v100, v101
    v_max3_f32 v165, v165, v102, v103
    v_max3_f32 v166, v166, v104, v105
    v_max3_f32 v165, v165, v106, v107
    v_max3_f32 v166, v166, v108, v109
    v_max3_f32 v165, v165, v110, v111
    v_max_f32 v165, v165, v166
    v_cmp_lt_f32 vcc, 0x41000000, v165
    s_cbranch_vccnz L_rare_4
L_back_4:
    v_exp_f32 v96, v96
    v_exp_f32 v97, v97
    v_exp_f32 v98, v98
    v_exp_f32 v99, v99
    v_exp_f32 v100, v100
    v_exp_f32 v101, v101
    v_exp_f32 v102, v102
    v_exp_f32 v103, v103
    v_exp_f32 v104, v104
    v_exp_f32 v105, v105
    v_exp_f32 v106, v106
    v_exp_f32 v107, v107
    v_exp_f32 v108, v108
    v_exp_f32 v109, v109
    v_exp_f32 v110, v110
    v_exp_f32 v111, v111
    v_add_f32 v164, v164, v96
    v_add_f32 v164, v164, v97
    v_add_f32 v164, v164, v98
    v_add_f32 v164, v164, v99
    v_add_f32 v164, v164, v100
    v_add_f32 v164, v164, v101
    v_add_f32 v164, v164, v102
    v_add_f32 v164, v164, v103
    v_add_f32 v164, v164, v104
    v_add_f32 v164, v164, v105
    v_add_f32 v164, v164, v106
    v_add_f32 v164, v164, v107
    v_add_f32 v164, v164, v108
    v_add_f32 v164, v164, v109
    v_add_f32 v164, v164, v110
    v_add_f32 v164, v164, v111
    v_cvt_pk_bf16_f32 v96, v96, v97
    v_cvt_pk_bf16_f32 v97, v98, v99
    v_cvt_pk_bf16_f32 v98, v100, v101
    v_cvt_pk_bf16_f32 v99, v102, v103
    v_cvt_pk_bf16_f32 v104, v104, v105
    v_cvt_pk_bf16_f32 v105, v106, v107
    v_cvt_pk_bf16_f32 v106, v108, v109
    v_cvt_pk_bf16_f32 v107, v110, v111
    s_setprio 0
    s_waitcnt lgkmcnt(0)
    v_mfma_f32_32x32x16_bf16 v[0:15], v[128:131], v[96:99], v[0:15]
    v_mfma_f32_32x32x16_bf16 v[16:31], v[132:135], v[96:99], v[16:31]
    ds_read_b128 v[128:131], v160 offset:0
    v_mfma_f32_32x32x16_bf16 v[32:47], v[136:139], v[96:99], v[32:47]
    ds_read_b128 v[132:135], v161 offset:0
    v_mfma_f32_32x32x16_bf16 v[48:63], v[140:143], v[96:99], v[48:63]
    ds_read_b128 v[136:139], v160 offset:64
    v_mfma_f32_32x32x16_bf16 v[0:15], v[144:147], v[104:107], v[0:15]
    ds_read_b128 v[140:143], v161 offset:64
    v_mfma_f32_32x32x16_bf16 v[16:31], v[148:151], v[104:107], v[16:31]
    ds_read_b128 v[144:147], v160 offset:128
    v_mfma_f32_32x32x16_bf16 v[32:47], v[152:155], v[104:107], v[32:47]
    ds_read_b128 v[148:151], v161 offset:128
    v_mfma_f32_32x32x16_bf16 v[48:63], v[156:159], v[104:107], v[48:63]
    ds_read_b128 v[152:155], v160 offset:192
    ds_read_b128 v[156:159], v161 offset:192
    v_add_u32 v160, 34816, v160
    v_add_u32 v161, 34816, v161
    s_cmp_lg_u32 s68, 2
    s_cbranch_scc1 L_rw_a5_2
    s_waitcnt vmcnt(8)
L_rw_a5_2:
    s_barrier
    s_cmp_lt_u32 s68, 2
    s_cbranch_scc1 L_r2_L_kd_a5
    s_cmp_lt_u32 s6, 10
    s_cbranch_scc0 L_kd_a5_v
    s_add_u32 s64, s61, 65536
    s_add_u32 m0, s63, 0
    s_nop 0
    buffer_load_dwordx4 v163, s[52:55], s64 offen nt lds
    s_add_u32 s64, s61, 66560
    s_add_u32 m0, s63, 1088
    s_nop 0
    buffer_load_dwordx4 v163, s[52:55], s64 offen nt lds
    s_add_u32 s64, s61, 67584
    s_add_u32 m0, s63, 2176
    s_nop 0
    buffer_load_dwordx4 v163, s[52:55], s64 offen nt lds
    s_add_u32 s64, s61, 68608
    s_add_u32 m0, s63, 3264
    s_nop 0
    buffer_load_dwordx4 v163, s[52:55], s64 offen nt lds
    s_add_u32 s64, s61, 69632
    s_add_u32 m0, s63, 4352
    s_nop 0
    buffer_load_dwordx4 v163, s[52:55], s64 offen nt lds
    s_add_u32 s64, s61, 70656
    s_add_u32 m0, s63, 5440
    s_nop 0
    buffer_load_dwordx4 v163, s[52:55], s64 offen nt lds
    s_add_u32 s64, s61, 71680
    s_add_u32 m0, s63, 6528
    s_nop 0
    buffer_load_dwordx4 v163, s[52:55], s64 offen nt lds
    s_add_u32 s64, s61, 72704
    s_add_u32 m0, s63, 7616
    s_nop 0
    buffer_load_dwordx4 v163, s[52:55], s64 offen nt lds
    s_branch L_r2_L_kd_a5
L_kd_a5_v:
    s_add_u32 s64, s61, 65536
    s_add_u32 m0, s63, 0
    s_nop 0
    buffer_load_dwordx4 v163, s[52:55], s64 offen nt lds
    s_add_u32 s64, s61, 65792
    s_add_u32 m0, s63, 1088
    s_nop 0
    buffer_load_dwordx4 v163, s[52:55], s64 offen nt lds
    s_add_u32 s64, s61, 66048
    s_add_u32 m0, s63, 2176
    s_nop 0
    buffer_load_dwordx4 v163, s[52:55], s64 offen nt lds
    s_add_u32 s64, s61, 66304
    s_add_u32 m0, s63, 3264
    s_nop 0
    buffer_load_dwordx4 v163, s[52:55], s64 offen nt lds
    s_add_u32 s64, s61, 69632
    s_add_u32 m0, s63, 4352
    s_nop 0
    buffer_load_dwordx4 v163, s[52:55], s64 offen nt lds
    s_add_u32 s64, s61, 69888
    s_add_u32 m0, s63, 5440
    s_nop 0
    buffer_load_dwordx4 v163, s[52:55], s64 offen nt lds
    s_add_u32 s64, s61, 70144
    s_add_u32 m0, s63, 6528
    s_nop 0
    buffer_load_dwordx4 v163, s[52:55], s64 offen nt lds
    s_add_u32 s64, s61, 70400
    s_add_u32 m0, s63, 7616
    s_nop 0
    buffer_load_dwordx4 v163, s[52:55], s64 offen nt lds
L_r2_L_kd_a5:
    s_setprio 1
    s_waitcnt lgkmcnt(0)
    v_mfma_f32_32x32x16_bf16 v[96:111], v[128:131], v[64:67], v[112:127]
    v_mfma_f32_32x32x16_bf16 v[96:111], v[132:135], v[68:71], v[96:111]
    ds_read_b64_tr_b16 v[128:129], v162 offset:0
    ds_read_b64_tr_b16 v[130:131], v162 offset:512
    v_mfma_f32_32x32x16_bf16 v[96:111], v[136:139], v[72:75], v[96:111]
    ds_read_b64_tr_b16 v[132:133], v162 offset:64
    ds_read_b64_tr_b16 v[134:135], v162 offset:576
    v_mfma_f32_32x32x16_bf16 v[96:111], v[140:143], v[76:79], v[96:111]
    ds_read_b64_tr_b16 v[136:137], v162 offset:128
    ds_read_b64_tr_b16 v[138:139], v162 offset:640
    v_mfma_f32_32x32x16_bf16 v[96:111], v[144:147], v[80:83], v[96:111]
    ds_read_b64_tr_b16 v[140:141], v162 offset:192
    ds_read_b64_tr_b16 v[142:143], v162 offset:704
    v_mfma_f32_32x32x16_bf16 v[96:111], v[148:151], v[84:87], v[96:111]
    ds_read_b64_tr_b16 v[144:145], v162 offset:4352
    ds_read_b64_tr_b16 v[146:147], v162 offset:4864
    v_mfma_f32_32x32x16_bf16 v[96:111], v[152:155], v[88:91], v[96:111]
    ds_read_b64_tr_b16 v[148:149], v162 offset:4416
    ds_read_b64_tr_b16 v[150:151], v162 offset:4928
    v_mfma_f32_32x32x16_bf16 v[96:111], v[156:159], v[92:95], v[96:111]
    ds_read_b64_tr_b16 v[152:153], v162 offset:4480
    ds_read_b64_tr_b16 v[154:155], v162 offset:4992
    ds_read_b64_tr_b16 v[156:157], v162 offset:4544
    ds_read_b64_tr_b16 v[158:159], v162 offset:5056
    v_add_u32 v162, 34816, v162
    s_setprio 2
    s_nop 7
    s_nop 1
    v_max3_f32 v165, v96, v97, v98
    v_max3_f32 v166, v99, v100, v101
    v_max3_f32 v165, v165, v102, v103
    v_max3_f32 v166, v166, v104, v105
    v_max3_f32 v165, v165, v106, v107
    v_max3_f32 v166, v166, v108, v109
    v_max3_f32 v165, v165, v110, v111
    v_max_f32 v165, v165, v166
    v_cmp_lt_f32 vcc, 0x41000000, v165
    s_cbranch_vccnz L_rare_5
L_back_5:
    v_exp_f32 v96, v96
    v_exp_f32 v97, v97
    v_exp_f32 v98, v98
    v_exp_f32 v99, v99
    v_exp_f32 v100, v100
    v_exp_f32 v101, v101
    v_exp_f32 v102, v102
    v_exp_f32 v103, v103
    v_exp_f32 v104, v104
    v_exp_f32 v105, v105
    v_exp_f32 v106, v106
    v_exp_f32 v107, v107
    v_exp_f32 v108, v108
    v_exp_f32 v109, v109
    v_exp_f32 v110, v110
    v_exp_f32 v111, v111
    v_add_f32 v164, v164, v96
    v_add_f32 v164, v164, v97
    v_add_f32 v164, v164, v98
    v_add_f32 v164, v164, v99
    v_add_f32 v164, v164, v100
    v_add_f32 v164, v164, v101
    v_add_f32 v164, v164, v102
    v_add_f32 v164, v164, v103
    v_add_f32 v164, v164, v104
    v_add_f32 v164, v164, v105
    v_add_f32 v164, v164, v106
    v_add_f32 v164, v164, v107
    v_add_f32 v164, v164, v108
    v_add_f32 v164, v164, v109
    v_add_f32 v164, v164, v110
    v_add_f32 v164, v164, v111
    v_cvt_pk_bf16_f32 v96, v96, v97
    v_cvt_pk_bf16_f32 v97, v98, v99
    v_cvt_pk_bf16_f32 v98, v100, v101
    v_cvt_pk_bf16_f32 v99, v102, v103
    v_cvt_pk_bf16_f32 v104, v104, v105
    v_cvt_pk_bf16_f32 v105, v106, v107
    v_cvt_pk_bf16_f32 v106, v108, v109
    v_cvt_pk_bf16_f32 v107, v110, v111
    s_setprio 0
    s_waitcnt lgkmcnt(0)
    v_mfma_f32_32x32x16_bf16 v[0:15], v[128:131], v[96:99], v[0:15]
    v_mfma_f32_32x32x16_bf16 v[16:31], v[132:135], v[96:99], v[16:31]
    ds_read_b128 v[128:131], v160 offset:0
    v_mfma_f32_32x32x16_bf16 v[32:47], v[136:139], v[96:99], v[32:47]
    ds_read_b128 v[132:135], v161 offset:0
    v_mfma_f32_32x32x16_bf16 v[48:63], v[140:143], v[96:99], v[48:63]
    ds_read_b128 v[136:139], v160 offset:64
    v_mfma_f32_32x32x16_bf16 v[0:15], v[144:147], v[104:107], v[0:15]
    ds_read_b128 v[140:143], v161 offset:64
    v_mfma_f32_32x32x16_bf16 v[16:31], v[148:151], v[104:107], v[16:31]
    ds_read_b128 v[144:147], v160 offset:128
    v_mfma_f32_32x32x16_bf16 v[32:47], v[152:155], v[104:107], v[32:47]
    ds_read_b128 v[148:151], v161 offset:128
    v_mfma_f32_32x32x16_bf16 v[48:63], v[156:159], v[104:107], v[48:63]
    ds_read_b128 v[152:155], v160 offset:192
    ds_read_b128 v[156:159], v161 offset:192
    v_add_u32 v160, 34816, v160
    v_add_u32 v161, 34816, v161
    s_cmp_lg_u32 s68, 2
    s_cbranch_scc1 L_rw_a6_2
    s_waitcnt vmcnt(8)
L_rw_a6_2:
    s_barrier
    s_cmp_lt_u32 s68, 2
    s_cbranch_scc1 L_r2_L_kd_a6
    s_cmp_lt_u32 s6, 10
    s_cbranch_scc0 L_kd_a6_v
    s_add_u32 s64, s61, 73728
    s_add_u32 m0, s63, 34816
    s_nop 0
    buffer_load_dwordx4 v163, s[52:55], s64 offen nt lds
    s_add_u32 s64, s61, 74752
    s_add_u32 m0, s63, 35904
    s_nop 0
    buffer_load_dwordx4 v163, s[52:55], s64 offen nt lds
    s_add_u32 s64, s61, 75776
    s_add_u32 m0, s63, 36992
    s_nop 0
    buffer_load_dwordx4 v163, s[52:55], s64 offen nt lds
    s_add_u32 s64, s61, 76800
    s_add_u32 m0, s63, 38080
    s_nop 0
    buffer_load_dwordx4 v163, s[52:55], s64 offen nt lds
    s_add_u32 s64, s61, 77824
    s_add_u32 m0, s63, 39168
    s_nop 0
    buffer_load_dwordx4 v163, s[52:55], s64 offen nt lds
    s_add_u32 s64, s61, 78848
    s_add_u32 m0, s63, 40256
    s_nop 0
    buffer_load_dwordx4 v163, s[52:55], s64 offen nt lds
    s_add_u32 s64, s61, 79872
    s_add_u32 m0, s63, 41344
    s_nop 0
    buffer_load_dwordx4 v163, s[52:55], s64 offen nt lds
    s_add_u32 s64, s61, 80896
    s_add_u32 m0, s63, 42432
    s_nop 0
    buffer_load_dwordx4 v163, s[52:55], s64 offen nt lds
    s_branch L_r2_L_kd_a6
L_kd_a6_v:
    s_add_u32 s64, s61, 73728
    s_add_u32 m0, s63, 34816
    s_nop 0
    buffer_load_dwordx4 v163, s[52:55], s64 offen nt lds
    s_add_u32 s64, s61, 73984
    s_add_u32 m0, s63, 35904
    s_nop 0
    buffer_load_dwordx4 v163, s[52:55], s64 offen nt lds
    s_add_u32 s64, s61, 74240
    s_add_u32 m0, s63, 36992
    s_nop 0
    buffer_load_dwordx4 v163, s[52:55], s64 offen nt lds
    s_add_u32 s64, s61, 74496
    s_add_u32 m0, s63, 38080
    s_nop 0
    buffer_load_dwordx4 v163, s[52:55], s64 offen nt lds
    s_add_u32 s64, s61, 77824
    s_add_u32 m0, s63, 39168
    s_nop 0
    buffer_load_dwordx4 v163, s[52:55], s64 offen nt lds
    s_add_u32 s64, s61, 78080
    s_add_u32 m0, s63, 40256
    s_nop 0
    buffer_load_dwordx4 v163, s[52:55], s64 offen nt lds
    s_add_u32 s64, s61, 78336
    s_add_u32 m0, s63, 41344
    s_nop 0
    buffer_load_dwordx4 v163, s[52:55], s64 offen nt lds
    s_add_u32 s64, s61, 78592
    s_add_u32 m0, s63, 42432
    s_nop 0
    buffer_load_dwordx4 v163, s[52:55], s64 offen nt lds
L_r2_L_kd_a6:
    s_setprio 1
    s_waitcnt lgkmcnt(0)
    v_mfma_f32_32x32x16_bf16 v[96:111], v[128:131], v[64:67], v[112:127]
    v_mfma_f32_32x32x16_bf16 v[96:111], v[132:135], v[68:71], v[96:111]
    ds_read_b64_tr_b16 v[128:129], v162 offset:0
    ds_read_b64_tr_b16 v[130:131], v162 offset:512
    v_mfma_f32_32x32x16_bf16 v[96:111], v[136:139], v[72:75], v[96:111]
    ds_read_b64_tr_b16 v[132:133], v162 offset:64
    ds_read_b64_tr_b16 v[134:135], v162 offset:576
    v_mfma_f32_32x32x16_bf16 v[96:111], v[140:143], v[76:79], v[96:111]
    ds_read_b64_tr_b16 v[136:137], v162 offset:128
    ds_read_b64_tr_b16 v[138:139], v162 offset:640
    v_mfma_f32_32x32x16_bf16 v[96:111], v[144:147], v[80:83], v[96:111]
    ds_read_b64_tr_b16 v[140:141], v162 offset:192
    ds_read_b64_tr_b16 v[142:143], v162 offset:704
    v_mfma_f32_32x32x16_bf16 v[96:111], v[148:151], v[84:87], v[96:111]
    ds_read_b64_tr_b16 v[144:145], v162 offset:4352
    ds_read_b64_tr_b16 v[146:147], v162 offset:4864
    v_mfma_f32_32x32x16_bf16 v[96:111], v[152:155], v[88:91], v[96:111]
    ds_read_b64_tr_b16 v[148:149], v162 offset:4416
    ds_read_b64_tr_b16 v[150:151], v162 offset:4928
    v_mfma_f32_32x32x16_bf16 v[96:111], v[156:159], v[92:95], v[96:111]
    ds_read_b64_tr_b16 v[152:153], v162 offset:4480
    ds_read_b64_tr_b16 v[154:155], v162 offset:4992
    ds_read_b64_tr_b16 v[156:157], v162 offset:4544
    ds_read_b64_tr_b16 v[158:159], v162 offset:5056
    v_add_u32 v162, 34816, v162
    s_setprio 2
    s_nop 7
    s_nop 1
    v_max3_f32 v165, v96, v97, v98
    v_max3_f32 v166, v99, v100, v101
    v_max3_f32 v165, v165, v102, v103
    v_max3_f32 v166, v166, v104, v105
    v_max3_f32 v165, v165, v106, v107
    v_max3_f32 v166, v166, v108, v109
    v_max3_f32 v165, v165, v110, v111
    v_max_f32 v165, v165, v166
    v_cmp_lt_f32 vcc, 0x41000000, v165
    s_cbranch_vccnz L_rare_6
L_back_6:
    v_exp_f32 v96, v96
    v_exp_f32 v97, v97
    v_exp_f32 v98, v98
    v_exp_f32 v99, v99
    v_exp_f32 v100, v100
    v_exp_f32 v101, v101
    v_exp_f32 v102, v102
    v_exp_f32 v103, v103
    v_exp_f32 v104, v104
    v_exp_f32 v105, v105
    v_exp_f32 v106, v106
    v_exp_f32 v107, v107
    v_exp_f32 v108, v108
    v_exp_f32 v109, v109
    v_exp_f32 v110, v110
    v_exp_f32 v111, v111
    v_add_f32 v164, v164, v96
    v_add_f32 v164, v164, v97
    v_add_f32 v164, v164, v98
    v_add_f32 v164, v164, v99
    v_add_f32 v164, v164, v100
    v_add_f32 v164, v164, v101
    v_add_f32 v164, v164, v102
    v_add_f32 v164, v164, v103
    v_add_f32 v164, v164, v104
    v_add_f32 v164, v164, v105
    v_add_f32 v164, v164, v106
    v_add_f32 v164, v164, v107
    v_add_f32 v164, v164, v108
    v_add_f32 v164, v164, v109
    v_add_f32 v164, v164, v110
    v_add_f32 v164, v164, v111
    v_cvt_pk_bf16_f32 v96, v96, v97
    v_cvt_pk_bf16_f32 v97, v98, v99
    v_cvt_pk_bf16_f32 v98, v100, v101
    v_cvt_pk_bf16_f32 v99, v102, v103
    v_cvt_pk_bf16_f32 v104, v104, v105
    v_cvt_pk_bf16_f32 v105, v106, v107
    v_cvt_pk_bf16_f32 v106, v108, v109
    v_cvt_pk_bf16_f32 v107, v110, v111
    s_setprio 0
    s_waitcnt lgkmcnt(0)
    v_mfma_f32_32x32x16_bf16 v[0:15], v[128:131], v[96:99], v[0:15]
    v_mfma_f32_32x32x16_bf16 v[16:31], v[132:135], v[96:99], v[16:31]
    ds_read_b128 v[128:131], v160 offset:0
    v_mfma_f32_32x32x16_bf16 v[32:47], v[136:139], v[96:99], v[32:47]
    ds_read_b128 v[132:135], v161 offset:0
    v_mfma_f32_32x32x16_bf16 v[48:63], v[140:143], v[96:99], v[48:63]
    ds_read_b128 v[136:139], v160 offset:64
    v_mfma_f32_32x32x16_bf16 v[0:15], v[144:147], v[104:107], v[0:15]
    ds_read_b128 v[140:143], v161 offset:64
    v_mfma_f32_32x32x16_bf16 v[16:31], v[148:151], v[104:107], v[16:31]
    ds_read_b128 v[144:147], v160 offset:128
    v_mfma_f32_32x32x16_bf16 v[32:47], v[152:155], v[104:107], v[32:47]
    ds_read_b128 v[148:151], v161 offset:128
    v_mfma_f32_32x32x16_bf16 v[48:63], v[156:159], v[104:107], v[48:63]
    ds_read_b128 v[152:155], v160 offset:192
    ds_read_b128 v[156:159], v161 offset:192
    v_subrev_u32 v160, 104448, v160
    v_subrev_u32 v161, 104448, v161
    s_cmp_lg_u32 s68, 2
    s_cbranch_scc1 L_rw_a7_2
    s_waitcnt vmcnt(8)
L_rw_a7_2:
    s_barrier
    s_cmp_lt_u32 s68, 2
    s_cbranch_scc1 L_r2_L_kd_a7
    s_cmp_lt_u32 s6, 10
    s_cbranch_scc0 L_kd_a7_v
    s_add_u32 s64, s61, 81920
    s_add_u32 m0, s63, 69632
    s_nop 0
    buffer_load_dwordx4 v163, s[52:55], s64 offen nt lds
    s_add_u32 s64, s61, 82944
    s_add_u32 m0, s63, 70720
    s_nop 0
    buffer_load_dwordx4 v163, s[52:55], s64 offen nt lds
    s_add_u32 s64, s61, 83968
    s_add_u32 m0, s63, 71808
    s_nop 0
    buffer_load_dwordx4 v163, s[52:55], s64 offen nt lds
    s_add_u32 s64, s61, 84992
    s_add_u32 m0, s63, 72896
    s_nop 0
    buffer_load_dwordx4 v163, s[52:55], s64 offen nt lds
    s_add_u32 s64, s61, 86016
    s_add_u32 m0, s63, 73984
    s_nop 0
    buffer_load_dwordx4 v163, s[52:55], s64 offen nt lds
    s_add_u32 s64, s61, 87040
    s_add_u32 m0, s63, 75072
    s_nop 0
    buffer_load_dwordx4 v163, s[52:55], s64 offen nt lds
    s_add_u32 s64, s61, 88064
    s_add_u32 m0, s63, 76160
    s_nop 0
    buffer_load_dwordx4 v163, s[52:55], s64 offen nt lds
    s_add_u32 s64, s61, 89088
    s_add_u32 m0, s63, 77248
    s_nop 0
    buffer_load_dwordx4 v163, s[52:55], s64 offen nt lds
    s_branch L_r2_L_kd_a7
L_kd_a7_v:
    s_add_u32 s64, s61, 81920
    s_add_u32 m0, s63, 69632
    s_nop 0
    buffer_load_dwordx4 v163, s[52:55], s64 offen nt lds
    s_add_u32 s64, s61, 82176
    s_add_u32 m0, s63, 70720
    s_nop 0
    buffer_load_dwordx4 v163, s[52:55], s64 offen nt lds
    s_add_u32 s64, s61, 82432
    s_add_u32 m0, s63, 71808
    s_nop 0
    buffer_load_dwordx4 v163, s[52:55], s64 offen nt lds
    s_add_u32 s64, s61, 82688
    s_add_u32 m0, s63, 72896
    s_nop 0
    buffer_load_dwordx4 v163, s[52:55], s64 offen nt lds
    s_add_u32 s64, s61, 86016
    s_add_u32 m0, s63, 73984
    s_nop 0
    buffer_load_dwordx4 v163, s[52:55], s64 offen nt lds
    s_add_u32 s64, s61, 86272
    s_add_u32 m0, s63, 75072
    s_nop 0
    buffer_load_dwordx4 v163, s[52:55], s64 offen nt lds
    s_add_u32 s64, s61, 86528
    s_add_u32 m0, s63, 76160
    s_nop 0
    buffer_load_dwordx4 v163, s[52:55], s64 offen nt lds
    s_add_u32 s64, s61, 86784
    s_add_u32 m0, s63, 77248
    s_nop 0
    buffer_load_dwordx4 v163, s[52:55], s64 offen nt lds
L_r2_L_kd_a7:
    s_setprio 1
    s_waitcnt lgkmcnt(0)
    v_mfma_f32_32x32x16_bf16 v[96:111], v[128:131], v[64:67], v[112:127]
    v_mfma_f32_32x32x16_bf16 v[96:111], v[132:135], v[68:71], v[96:111]
    ds_read_b64_tr_b16 v[128:129], v162 offset:0
    ds_read_b64_tr_b16 v[130:131], v162 offset:512
    v_mfma_f32_32x32x16_bf16 v[96:111], v[136:139], v[72:75], v[96:111]
    ds_read_b64_tr_b16 v[132:133], v162 offset:64
    ds_read_b64_tr_b16 v[134:135], v162 offset:576
    v_mfma_f32_32x32x16_bf16 v[96:111], v[140:143], v[76:79], v[96:111]
    ds_read_b64_tr_b16 v[136:137], v162 offset:128
    ds_read_b64_tr_b16 v[138:139], v162 offset:640
    v_mfma_f32_32x32x16_bf16 v[96:111], v[144:147], v[80:83], v[96:111]
    ds_read_b64_tr_b16 v[140:141], v162 offset:192
    ds_read_b64_tr_b16 v[142:143], v162 offset:704
    v_mfma_f32_32x32x16_bf16 v[96:111], v[148:151], v[84:87], v[96:111]
    ds_read_b64_tr_b16 v[144:145], v162 offset:4352
    ds_read_b64_tr_b16 v[146:147], v162 offset:4864
    v_mfma_f32_32x32x16_bf16 v[96:111], v[152:155], v[88:91], v[96:111]
    ds_read_b64_tr_b16 v[148:149], v162 offset:4416
    ds_read_b64_tr_b16 v[150:151], v162 offset:4928
    v_mfma_f32_32x32x16_bf16 v[96:111], v[156:159], v[92:95], v[96:111]
    ds_read_b64_tr_b16 v[152:153], v162 offset:4480
    ds_read_b64_tr_b16 v[154:155], v162 offset:4992
    ds_read_b64_tr_b16 v[156:157], v162 offset:4544
    ds_read_b64_tr_b16 v[158:159], v162 offset:5056
    v_subrev_u32 v162, 104448, v162
    s_setprio 2
    s_nop 7
    s_nop 1
    v_max3_f32 v165, v96, v97, v98
    v_max3_f32 v166, v99, v100, v101
    v_max3_f32 v165, v165, v102, v103
    v_max3_f32 v166, v166, v104, v105
    v_max3_f32 v165, v165, v106, v107
    v_max3_f32 v166, v166, v108, v109
    v_max3_f32 v165, v165, v110, v111
    v_max_f32 v165, v165, v166
    v_cmp_lt_f32 vcc, 0x41000000, v165
    s_cbranch_vccnz L_rare_7
L_back_7:
    v_exp_f32 v96, v96
    v_exp_f32 v97, v97
    v_exp_f32 v98, v98
    v_exp_f32 v99, v99
    v_exp_f32 v100, v100
    v_exp_f32 v101, v101
    v_exp_f32 v102, v102
    v_exp_f32 v103, v103
    v_exp_f32 v104, v104
    v_exp_f32 v105, v105
    v_exp_f32 v106, v106
    v_exp_f32 v107, v107
    v_exp_f32 v108, v108
    v_exp_f32 v109, v109
    v_exp_f32 v110, v110
    v_exp_f32 v111, v111
    v_add_f32 v164, v164, v96
    v_add_f32 v164, v164, v97
    v_add_f32 v164, v164, v98
    v_add_f32 v164, v164, v99
    v_add_f32 v164, v164, v100
    v_add_f32 v164, v164, v101
    v_add_f32 v164, v164, v102
    v_add_f32 v164, v164, v103
    v_add_f32 v164, v164, v104
    v_add_f32 v164, v164, v105
    v_add_f32 v164, v164, v106
    v_add_f32 v164, v164, v107
    v_add_f32 v164, v164, v108
    v_add_f32 v164, v164, v109
    v_add_f32 v164, v164, v110
    v_add_f32 v164, v164, v111
    v_cvt_pk_bf16_f32 v96, v96, v97
    v_cvt_pk_bf16_f32 v97, v98, v99
    v_cvt_pk_bf16_f32 v98, v100, v101
    v_cvt_pk_bf16_f32 v99, v102, v103
    v_cvt_pk_bf16_f32 v104, v104, v105
    v_cvt_pk_bf16_f32 v105, v106, v107
    v_cvt_pk_bf16_f32 v106, v108, v109
    v_cvt_pk_bf16_f32 v107, v110, v111
    s_setprio 0
    s_waitcnt lgkmcnt(0)
    v_mfma_f32_32x32x16_bf16 v[0:15], v[128:131], v[96:99], v[0:15]
    v_mfma_f32_32x32x16_bf16 v[16:31], v[132:135], v[96:99], v[16:31]
    ds_read_b128 v[128:131], v160 offset:0
    v_mfma_f32_32x32x16_bf16 v[32:47], v[136:139], v[96:99], v[32:47]
    ds_read_b128 v[132:135], v161 offset:0
    v_mfma_f32_32x32x16_bf16 v[48:63], v[140:143], v[96:99], v[48:63]
    ds_read_b128 v[136:139], v160 offset:64
    v_mfma_f32_32x32x16_bf16 v[0:15], v[144:147], v[104:107], v[0:15]
    ds_read_b128 v[140:143], v161 offset:64
    v_mfma_f32_32x32x16_bf16 v[16:31], v[148:151], v[104:107], v[16:31]
    ds_read_b128 v[144:147], v160 offset:128
    v_mfma_f32_32x32x16_bf16 v[32:47], v[152:155], v[104:107], v[32:47]
    ds_read_b128 v[148:151], v161 offset:128
    v_mfma_f32_32x32x16_bf16 v[48:63], v[156:159], v[104:107], v[48:63]
    ds_read_b128 v[152:155], v160 offset:192
    ds_read_b128 v[156:159], v161 offset:192
    v_add_u32 v160, 34816, v160
    v_add_u32 v161, 34816, v161
    s_cmp_lg_u32 s68, 2
    s_cbranch_scc1 L_rw_a8_2
    s_waitcnt vmcnt(8)
L_rw_a8_2:
    s_barrier
    s_cmp_lt_u32 s68, 2
    s_cbranch_scc1 L_r2_L_kd_a8
    s_cmp_lt_u32 s6, 10
    s_cbranch_scc0 L_kd_a8_v
    s_add_u32 s64, s61, 90112
    s_add_u32 m0, s63, 104448
    s_nop 0
    buffer_load_dwordx4 v163, s[52:55], s64 offen nt lds
    s_add_u32 s64, s61, 91136
    s_add_u32 m0, s63, 105536
    s_nop 0
    buffer_load_dwordx4 v163, s[52:55], s64 offen nt lds
    s_add_u32 s64, s61, 92160
    s_add_u32 m0, s63, 106624
    s_nop 0
    buffer_load_dwordx4 v163, s[52:55], s64 offen nt lds
    s_add_u32 s64, s61, 93184
    s_add_u32 m0, s63, 107712
    s_nop 0
    buffer_load_dwordx4 v163, s[52:55], s64 offen nt lds
    s_add_u32 s64, s61, 94208
    s_add_u32 m0, s63, 108800
    s_nop 0
    buffer_load_dwordx4 v163, s[52:55], s64 offen nt lds
    s_add_u32 s64, s61, 95232
    s_add_u32 m0, s63, 109888
    s_nop 0
    buffer_load_dwordx4 v163, s[52:55], s64 offen nt lds
    s_add_u32 s64, s61, 96256
    s_add_u32 m0, s63, 110976
    s_nop 0
    buffer_load_dwordx4 v163, s[52:55], s64 offen nt lds
    s_add_u32 s64, s61, 97280
    s_add_u32 m0, s63, 112064
    s_nop 0
    buffer_load_dwordx4 v163, s[52:55], s64 offen nt lds
    s_branch L_r2_L_kd_a8
L_kd_a8_v:
    s_add_u32 s64, s61, 90112
    s_add_u32 m0, s63, 104448
    s_nop 0
    buffer_load_dwordx4 v163, s[52:55], s64 offen nt lds
    s_add_u32 s64, s61, 90368
    s_add_u32 m0, s63, 105536
    s_nop 0
    buffer_load_dwordx4 v163, s[52:55], s64 offen nt lds
    s_add_u32 s64, s61, 90624
    s_add_u32 m0, s63, 106624
    s_nop 0
    buffer_load_dwordx4 v163, s[52:55], s64 offen nt lds
    s_add_u32 s64, s61, 90880
    s_add_u32 m0, s63, 107712
    s_nop 0
    buffer_load_dwordx4 v163, s[52:55], s64 offen nt lds
    s_add_u32 s64, s61, 94208
    s_add_u32 m0, s63, 108800
    s_nop 0
    buffer_load_dwordx4 v163, s[52:55], s64 offen nt lds
    s_add_u32 s64, s61, 94464
    s_add_u32 m0, s63, 109888
    s_nop 0
    buffer_load_dwordx4 v163, s[52:55], s64 offen nt lds
    s_add_u32 s64, s61, 94720
    s_add_u32 m0, s63, 110976
    s_nop 0
    buffer_load_dwordx4 v163, s[52:55], s64 offen nt lds
    s_add_u32 s64, s61, 94976
    s_add_u32 m0, s63, 112064
    s_nop 0
    buffer_load_dwordx4 v163, s[52:55], s64 offen nt lds
L_r2_L_kd_a8:
    s_setprio 1
    s_waitcnt lgkmcnt(0)
    v_mfma_f32_32x32x16_bf16 v[96:111], v[128:131], v[64:67], v[112:127]
    v_mfma_f32_32x32x16_bf16 v[96:111], v[132:135], v[68:71], v[96:111]
    ds_read_b64_tr_b16 v[128:129], v162 offset:0
    ds_read_b64_tr_b16 v[130:131], v162 offset:512
    v_mfma_f32_32x32x16_bf16 v[96:111], v[136:139], v[72:75], v[96:111]
    ds_read_b64_tr_b16 v[132:133], v162 offset:64
    ds_read_b64_tr_b16 v[134:135], v162 offset:576
    v_mfma_f32_32x32x16_bf16 v[96:111], v[140:143], v[76:79], v[96:111]
    ds_read_b64_tr_b16 v[136:137], v162 offset:128
    ds_read_b64_tr_b16 v[138:139], v162 offset:640
    v_mfma_f32_32x32x16_bf16 v[96:111], v[144:147], v[80:83], v[96:111]
    ds_read_b64_tr_b16 v[140:141], v162 offset:192
    ds_read_b64_tr_b16 v[142:143], v162 offset:704
    v_mfma_f32_32x32x16_bf16 v[96:111], v[148:151], v[84:87], v[96:111]
    ds_read_b64_tr_b16 v[144:145], v162 offset:4352
    ds_read_b64_tr_b16 v[146:147], v162 offset:4864
    v_mfma_f32_32x32x16_bf16 v[96:111], v[152:155], v[88:91], v[96:111]
    ds_read_b64_tr_b16 v[148:149], v162 offset:4416
    ds_read_b64_tr_b16 v[150:151], v162 offset:4928
    v_mfma_f32_32x32x16_bf16 v[96:111], v[156:159], v[92:95], v[96:111]
    ds_read_b64_tr_b16 v[152:153], v162 offset:4480
    ds_read_b64_tr_b16 v[154:155], v162 offset:4992
    ds_read_b64_tr_b16 v[156:157], v162 offset:4544
    ds_read_b64_tr_b16 v[158:159], v162 offset:5056
    v_add_u32 v162, 34816, v162
    s_setprio 2
    s_nop 7
    s_nop 1
    v_max3_f32 v165, v96, v97, v98
    v_max3_f32 v166, v99, v100, v101
    v_max3_f32 v165, v165, v102, v103
    v_max3_f32 v166, v166, v104, v105
    v_max3_f32 v165, v165, v106, v107
    v_max3_f32 v166, v166, v108, v109
    v_max3_f32 v165, v165, v110, v111
    v_max_f32 v165, v165, v166
    v_cmp_lt_f32 vcc, 0x41000000, v165
    s_cbranch_vccnz L_rare_8
L_back_8:
    v_exp_f32 v96, v96
    v_exp_f32 v97, v97
    v_exp_f32 v98, v98
    v_exp_f32 v99, v99
    v_exp_f32 v100, v100
    v_exp_f32 v101, v101
    v_exp_f32 v102, v102
    v_exp_f32 v103, v103
    v_exp_f32 v104, v104
    v_exp_f32 v105, v105
    v_exp_f32 v106, v106
    v_exp_f32 v107, v107
    v_exp_f32 v108, v108
    v_exp_f32 v109, v109
    v_exp_f32 v110, v110
    v_exp_f32 v111, v111
    v_add_f32 v164, v164, v96
    v_add_f32 v164, v164, v97
    v_add_f32 v164, v164, v98
    v_add_f32 v164, v164, v99
    v_add_f32 v164, v164, v100
    v_add_f32 v164, v164, v101
    v_add_f32 v164, v164, v102
    v_add_f32 v164, v164, v103
    v_add_f32 v164, v164, v104
    v_add_f32 v164, v164, v105
    v_add_f32 v164, v164, v106
    v_add_f32 v164, v164, v107
    v_add_f32 v164, v164, v108
    v_add_f32 v164, v164, v109
    v_add_f32 v164, v164, v110
    v_add_f32 v164, v164, v111
    v_cvt_pk_bf16_f32 v96, v96, v97
    v_cvt_pk_bf16_f32 v97, v98, v99
    v_cvt_pk_bf16_f32 v98, v100, v101
    v_cvt_pk_bf16_f32 v99, v102, v103
    v_cvt_pk_bf16_f32 v104, v104, v105
    v_cvt_pk_bf16_f32 v105, v106, v107
    v_cvt_pk_bf16_f32 v106, v108, v109
    v_cvt_pk_bf16_f32 v107, v110, v111
    s_setprio 0
    s_waitcnt lgkmcnt(0)
    v_mfma_f32_32x32x16_bf16 v[0:15], v[128:131], v[96:99], v[0:15]
    v_mfma_f32_32x32x16_bf16 v[16:31], v[132:135], v[96:99], v[16:31]
    ds_read_b128 v[128:131], v160 offset:0
    v_mfma_f32_32x32x16_bf16 v[32:47], v[136:139], v[96:99], v[32:47]
    ds_read_b128 v[132:135], v161 offset:0
    v_mfma_f32_32x32x16_bf16 v[48:63], v[140:143], v[96:99], v[48:63]
    ds_read_b128 v[136:139], v160 offset:64
    v_mfma_f32_32x32x16_bf16 v[0:15], v[144:147], v[104:107], v[0:15]
    ds_read_b128 v[140:143], v161 offset:64
    v_mfma_f32_32x32x16_bf16 v[16:31], v[148:151], v[104:107], v[16:31]
    ds_read_b128 v[144:147], v160 offset:128
    v_mfma_f32_32x32x16_bf16 v[32:47], v[152:155], v[104:107], v[32:47]
    ds_read_b128 v[148:151], v161 offset:128
    v_mfma_f32_32x32x16_bf16 v[48:63], v[156:159], v[104:107], v[48:63]
    ds_read_b128 v[152:155], v160 offset:192
    ds_read_b128 v[156:159], v161 offset:192
    v_add_u32 v160, 34816, v160
    v_add_u32 v161, 34816, v161
    s_cmp_lg_u32 s68, 2
    s_cbranch_scc1 L_rw_a9_2
    s_waitcnt vmcnt(8)
L_rw_a9_2:
    s_barrier
    s_cmp_lt_u32 s68, 2
    s_cbranch_scc1 L_r2_L_kd_a9
    s_cmp_lt_u32 s6, 10
    s_cbranch_scc0 L_kd_a9_v
    s_add_u32 s64, s61, 98304
    s_add_u32 m0, s63, 0
    s_nop 0
    buffer_load_dwordx4 v163, s[52:55], s64 offen nt lds
    s_add_u32 s64, s61, 99328
    s_add_u32 m0, s63, 1088
    s_nop 0
    buffer_load_dwordx4 v163, s[52:55], s64 offen nt lds
    s_add_u32 s64, s61, 100352
    s_add_u32 m0, s63, 2176
    s_nop 0
    buffer_load_dwordx4 v163, s[52:55], s64 offen nt lds
    s_add_u32 s64, s61, 101376
    s_add_u32 m0, s63, 3264
    s_nop 0
    buffer_load_dwordx4 v163, s[52:55], s64 offen nt lds
    s_add_u32 s64, s61, 102400
    s_add_u32 m0, s63, 4352
    s_nop 0
    buffer_load_dwordx4 v163, s[52:55], s64 offen nt lds
    s_add_u32 s64, s61, 103424
    s_add_u32 m0, s63, 5440
    s_nop 0
    buffer_load_dwordx4 v163, s[52:55], s64 offen nt lds
    s_add_u32 s64, s61, 104448
    s_add_u32 m0, s63, 6528
    s_nop 0
    buffer_load_dwordx4 v163, s[52:55], s64 offen nt lds
    s_add_u32 s64, s61, 105472
    s_add_u32 m0, s63, 7616
    s_nop 0
    buffer_load_dwordx4 v163, s[52:55], s64 offen nt lds
    s_branch L_r2_L_kd_a9
L_kd_a9_v:
    s_add_u32 s64, s61, 98304
    s_add_u32 m0, s63, 0
    s_nop 0
    buffer_load_dwordx4 v163, s[52:55], s64 offen nt lds
    s_add_u32 s64, s61, 98560
    s_add_u32 m0, s63, 1088
    s_nop 0
    buffer_load_dwordx4 v163, s[52:55], s64 offen nt lds
    s_add_u32 s64, s61, 98816
    s_add_u32 m0, s63, 2176
    s_nop 0
    buffer_load_dwordx4 v163, s[52:55], s64 offen nt lds
    s_add_u32 s64, s61, 99072
    s_add_u32 m0, s63, 3264
    s_nop 0
    buffer_load_dwordx4 v163, s[52:55], s64 offen nt lds
    s_add_u32 s64, s61, 102400
    s_add_u32 m0, s63, 4352
    s_nop 0
    buffer_load_dwordx4 v163, s[52:55], s64 offen nt lds
    s_add_u32 s64, s61, 102656
    s_add_u32 m0, s63, 5440
    s_nop 0
    buffer_load_dwordx4 v163, s[52:55], s64 offen nt lds
    s_add_u32 s64, s61, 102912
    s_add_u32 m0, s63, 6528
    s_nop 0
    buffer_load_dwordx4 v163, s[52:55], s64 offen nt lds
    s_add_u32 s64, s61, 103168
    s_add_u32 m0, s63, 7616
    s_nop 0
    buffer_load_dwordx4 v163, s[52:55], s64 offen nt lds
L_r2_L_kd_a9:
    s_setprio 1
    s_waitcnt lgkmcnt(0)
    v_mfma_f32_32x32x16_bf16 v[96:111], v[128:131], v[64:67], v[112:127]
    v_mfma_f32_32x32x16_bf16 v[96:111], v[132:135], v[68:71], v[96:111]
    ds_read_b64_tr_b16 v[128:129], v162 offset:0
    ds_read_b64_tr_b16 v[130:131], v162 offset:512
    v_mfma_f32_32x32x16_bf16 v[96:111], v[136:139], v[72:75], v[96:111]
    ds_read_b64_tr_b16 v[132:133], v162 offset:64
    ds_read_b64_tr_b16 v[134:135], v162 offset:576
    v_mfma_f32_32x32x16_bf16 v[96:111], v[140:143], v[76:79], v[96:111]
    ds_read_b64_tr_b16 v[136:137], v162 offset:128
    ds_read_b64_tr_b16 v[138:139], v162 offset:640
    v_mfma_f32_32x32x16_bf16 v[96:111], v[144:147], v[80:83], v[96:111]
    ds_read_b64_tr_b16 v[140:141], v162 offset:192
    ds_read_b64_tr_b16 v[142:143], v162 offset:704
    v_mfma_f32_32x32x16_bf16 v[96:111], v[148:151], v[84:87], v[96:111]
    ds_read_b64_tr_b16 v[144:145], v162 offset:4352
    ds_read_b64_tr_b16 v[146:147], v162 offset:4864
    v_mfma_f32_32x32x16_bf16 v[96:111], v[152:155], v[88:91], v[96:111]
    ds_read_b64_tr_b16 v[148:149], v162 offset:4416
    ds_read_b64_tr_b16 v[150:151], v162 offset:4928
    v_mfma_f32_32x32x16_bf16 v[96:111], v[156:159], v[92:95], v[96:111]
    ds_read_b64_tr_b16 v[152:153], v162 offset:4480
    ds_read_b64_tr_b16 v[154:155], v162 offset:4992
    ds_read_b64_tr_b16 v[156:157], v162 offset:4544
    ds_read_b64_tr_b16 v[158:159], v162 offset:5056
    v_add_u32 v162, 34816, v162
    s_setprio 2
    s_nop 7
    s_nop 1
    v_max3_f32 v165, v96, v97, v98
    v_max3_f32 v166, v99, v100, v101
    v_max3_f32 v165, v165, v102, v103
    v_max3_f32 v166, v166, v104, v105
    v_max3_f32 v165, v165, v106, v107
    v_max3_f32 v166, v166, v108, v109
    v_max3_f32 v165, v165, v110, v111
    v_max_f32 v165, v165, v166
    v_cmp_lt_f32 vcc, 0x41000000, v165
    s_cbranch_vccnz L_rare_9
L_back_9:
    v_exp_f32 v96, v96
    v_exp_f32 v97, v97
    v_exp_f32 v98, v98
    v_exp_f32 v99, v99
    v_exp_f32 v100, v100
    v_exp_f32 v101, v101
    v_exp_f32 v102, v102
    v_exp_f32 v103, v103
    v_exp_f32 v104, v104
    v_exp_f32 v105, v105
    v_exp_f32 v106, v106
    v_exp_f32 v107, v107
    v_exp_f32 v108, v108
    v_exp_f32 v109, v109
    v_exp_f32 v110, v110
    v_exp_f32 v111, v111
    v_add_f32 v164, v164, v96
    v_add_f32 v164, v164, v97
    v_add_f32 v164, v164, v98
    v_add_f32 v164, v164, v99
    v_add_f32 v164, v164, v100
    v_add_f32 v164, v164, v101
    v_add_f32 v164, v164, v102
    v_add_f32 v164, v164, v103
    v_add_f32 v164, v164, v104
    v_add_f32 v164, v164, v105
    v_add_f32 v164, v164, v106
    v_add_f32 v164, v164, v107
    v_add_f32 v164, v164, v108
    v_add_f32 v164, v164, v109
    v_add_f32 v164, v164, v110
    v_add_f32 v164, v164, v111
    v_cvt_pk_bf16_f32 v96, v96, v97
    v_cvt_pk_bf16_f32 v97, v98, v99
    v_cvt_pk_bf16_f32 v98, v100, v101
    v_cvt_pk_bf16_f32 v99, v102, v103
    v_cvt_pk_bf16_f32 v104, v104, v105
    v_cvt_pk_bf16_f32 v105, v106, v107
    v_cvt_pk_bf16_f32 v106, v108, v109
    v_cvt_pk_bf16_f32 v107, v110, v111
    s_setprio 0
    s_waitcnt lgkmcnt(0)
    v_mfma_f32_32x32x16_bf16 v[0:15], v[128:131], v[96:99], v[0:15]
    v_mfma_f32_32x32x16_bf16 v[16:31], v[132:135], v[96:99], v[16:31]
    ds_read_b128 v[128:131], v160 offset:0
    v_mfma_f32_32x32x16_bf16 v[32:47], v[136:139], v[96:99], v[32:47]
    ds_read_b128 v[132:135], v161 offset:0
    v_mfma_f32_32x32x16_bf16 v[48:63], v[140:143], v[96:99], v[48:63]
    ds_read_b128 v[136:139], v160 offset:64
    v_mfma_f32_32x32x16_bf16 v[0:15], v[144:147], v[104:107], v[0:15]
    ds_read_b128 v[140:143], v161 offset:64
    v_mfma_f32_32x32x16_bf16 v[16:31], v[148:151], v[104:107], v[16:31]
    ds_read_b128 v[144:147], v160 offset:128
    v_mfma_f32_32x32x16_bf16 v[32:47], v[152:155], v[104:107], v[32:47]
    ds_read_b128 v[148:151], v161 offset:128
    v_mfma_f32_32x32x16_bf16 v[48:63], v[156:159], v[104:107], v[48:63]
    ds_read_b128 v[152:155], v160 offset:192
    ds_read_b128 v[156:159], v161 offset:192
    v_add_u32 v160, 34816, v160
    v_add_u32 v161, 34816, v161
    s_cmp_lg_u32 s68, 2
    s_cbranch_scc1 L_rw_a10_2
    s_waitcnt vmcnt(8)
L_rw_a10_2:
    s_barrier
    s_cmp_lt_u32 s68, 2
    s_cbranch_scc1 L_r2_L_kd_a10
    s_cmp_lt_u32 s6, 10
    s_cbranch_scc0 L_kd_a10_v
    s_add_u32 s64, s61, 106496
    s_add_u32 m0, s63, 34816
    s_nop 0
    buffer_load_dwordx4 v163, s[52:55], s64 offen nt lds
    s_add_u32 s64, s61, 107520
    s_add_u32 m0, s63, 35904
    s_nop 0
    buffer_load_dwordx4 v163, s[52:55], s64 offen nt lds
    s_add_u32 s64, s61, 108544
    s_add_u32 m0, s63, 36992
    s_nop 0
    buffer_load_dwordx4 v163, s[52:55], s64 offen nt lds
    s_add_u32 s64, s61, 109568
    s_add_u32 m0, s63, 38080
    s_nop 0
    buffer_load_dwordx4 v163, s[52:55], s64 offen nt lds
    s_add_u32 s64, s61, 110592
    s_add_u32 m0, s63, 39168
    s_nop 0
    buffer_load_dwordx4 v163, s[52:55], s64 offen nt lds
    s_add_u32 s64, s61, 111616
    s_add_u32 m0, s63, 40256
    s_nop 0
    buffer_load_dwordx4 v163, s[52:55], s64 offen nt lds
    s_add_u32 s64, s61, 112640
    s_add_u32 m0, s63, 41344
    s_nop 0
    buffer_load_dwordx4 v163, s[52:55], s64 offen nt lds
    s_add_u32 s64, s61, 113664
    s_add_u32 m0, s63, 42432
    s_nop 0
    buffer_load_dwordx4 v163, s[52:55], s64 offen nt lds
    s_branch L_r2_L_kd_a10
L_kd_a10_v:
    s_add_u32 s64, s61, 106496
    s_add_u32 m0, s63, 34816
    s_nop 0
    buffer_load_dwordx4 v163, s[52:55], s64 offen nt lds
    s_add_u32 s64, s61, 106752
    s_add_u32 m0, s63, 35904
    s_nop 0
    buffer_load_dwordx4 v163, s[52:55], s64 offen nt lds
    s_add_u32 s64, s61, 107008
    s_add_u32 m0, s63, 36992
    s_nop 0
    buffer_load_dwordx4 v163, s[52:55], s64 offen nt lds
    s_add_u32 s64, s61, 107264
    s_add_u32 m0, s63, 38080
    s_nop 0
    buffer_load_dwordx4 v163, s[52:55], s64 offen nt lds
    s_add_u32 s64, s61, 110592
    s_add_u32 m0, s63, 39168
    s_nop 0
    buffer_load_dwordx4 v163, s[52:55], s64 offen nt lds
    s_add_u32 s64, s61, 110848
    s_add_u32 m0, s63, 40256
    s_nop 0
    buffer_load_dwordx4 v163, s[52:55], s64 offen nt lds
    s_add_u32 s64, s61, 111104
    s_add_u32 m0, s63, 41344
    s_nop 0
    buffer_load_dwordx4 v163, s[52:55], s64 offen nt lds
    s_add_u32 s64, s61, 111360
    s_add_u32 m0, s63, 42432
    s_nop 0
    buffer_load_dwordx4 v163, s[52:55], s64 offen nt lds
L_r2_L_kd_a10:
    s_setprio 1
    s_waitcnt lgkmcnt(0)
    v_mfma_f32_32x32x16_bf16 v[96:111], v[128:131], v[64:67], v[112:127]
    v_mfma_f32_32x32x16_bf16 v[96:111], v[132:135], v[68:71], v[96:111]
    ds_read_b64_tr_b16 v[128:129], v162 offset:0
    ds_read_b64_tr_b16 v[130:131], v162 offset:512
    v_mfma_f32_32x32x16_bf16 v[96:111], v[136:139], v[72:75], v[96:111]
    ds_read_b64_tr_b16 v[132:133], v162 offset:64
    ds_read_b64_tr_b16 v[134:135], v162 offset:576
    v_mfma_f32_32x32x16_bf16 v[96:111], v[140:143], v[76:79], v[96:111]
    ds_read_b64_tr_b16 v[136:137], v162 offset:128
    ds_read_b64_tr_b16 v[138:139], v162 offset:640
    v_mfma_f32_32x32x16_bf16 v[96:111], v[144:147], v[80:83], v[96:111]
    ds_read_b64_tr_b16 v[140:141], v162 offset:192
    ds_read_b64_tr_b16 v[142:143], v162 offset:704
    v_mfma_f32_32x32x16_bf16 v[96:111], v[148:151], v[84:87], v[96:111]
    ds_read_b64_tr_b16 v[144:145], v162 offset:4352
    ds_read_b64_tr_b16 v[146:147], v162 offset:4864
    v_mfma_f32_32x32x16_bf16 v[96:111], v[152:155], v[88:91], v[96:111]
    ds_read_b64_tr_b16 v[148:149], v162 offset:4416
    ds_read_b64_tr_b16 v[150:151], v162 offset:4928
    v_mfma_f32_32x32x16_bf16 v[96:111], v[156:159], v[92:95], v[96:111]
    ds_read_b64_tr_b16 v[152:153], v162 offset:4480
    ds_read_b64_tr_b16 v[154:155], v162 offset:4992
    ds_read_b64_tr_b16 v[156:157], v162 offset:4544
    ds_read_b64_tr_b16 v[158:159], v162 offset:5056
    v_add_u32 v162, 34816, v162
    s_setprio 2
    s_nop 7
    s_nop 1
    v_max3_f32 v165, v96, v97, v98
    v_max3_f32 v166, v99, v100, v101
    v_max3_f32 v165, v165, v102, v103
    v_max3_f32 v166, v166, v104, v105
    v_max3_f32 v165, v165, v106, v107
    v_max3_f32 v166, v166, v108, v109
    v_max3_f32 v165, v165, v110, v111
    v_max_f32 v165, v165, v166
    v_cmp_lt_f32 vcc, 0x41000000, v165
    s_cbranch_vccnz L_rare_10
L_back_10:
    v_exp_f32 v96, v96
    v_exp_f32 v97, v97
    v_exp_f32 v98, v98
    v_exp_f32 v99, v99
    v_exp_f32 v100, v100
    v_exp_f32 v101, v101
    v_exp_f32 v102, v102
    v_exp_f32 v103, v103
    v_exp_f32 v104, v104
    v_exp_f32 v105, v105
    v_exp_f32 v106, v106
    v_exp_f32 v107, v107
    v_exp_f32 v108, v108
    v_exp_f32 v109, v109
    v_exp_f32 v110, v110
    v_exp_f32 v111, v111
    v_add_f32 v164, v164, v96
    v_add_f32 v164, v164, v97
    v_add_f32 v164, v164, v98
    v_add_f32 v164, v164, v99
    v_add_f32 v164, v164, v100
    v_add_f32 v164, v164, v101
    v_add_f32 v164, v164, v102
    v_add_f32 v164, v164, v103
    v_add_f32 v164, v164, v104
    v_add_f32 v164, v164, v105
    v_add_f32 v164, v164, v106
    v_add_f32 v164, v164, v107
    v_add_f32 v164, v164, v108
    v_add_f32 v164, v164, v109
    v_add_f32 v164, v164, v110
    v_add_f32 v164, v164, v111
    v_cvt_pk_bf16_f32 v96, v96, v97
    v_cvt_pk_bf16_f32 v97, v98, v99
    v_cvt_pk_bf16_f32 v98, v100, v101
    v_cvt_pk_bf16_f32 v99, v102, v103
    v_cvt_pk_bf16_f32 v104, v104, v105
    v_cvt_pk_bf16_f32 v105, v106, v107
    v_cvt_pk_bf16_f32 v106, v108, v109
    v_cvt_pk_bf16_f32 v107, v110, v111
    s_setprio 0
    s_waitcnt lgkmcnt(0)
    v_mfma_f32_32x32x16_bf16 v[0:15], v[128:131], v[96:99], v[0:15]
    v_mfma_f32_32x32x16_bf16 v[16:31], v[132:135], v[96:99], v[16:31]
    ds_read_b128 v[128:131], v160 offset:0
    v_mfma_f32_32x32x16_bf16 v[32:47], v[136:139], v[96:99], v[32:47]
    ds_read_b128 v[132:135], v161 offset:0
    v_mfma_f32_32x32x16_bf16 v[48:63], v[140:143], v[96:99], v[48:63]
    ds_read_b128 v[136:139], v160 offset:64
    v_mfma_f32_32x32x16_bf16 v[0:15], v[144:147], v[104:107], v[0:15]
    ds_read_b128 v[140:143], v161 offset:64
    v_mfma_f32_32x32x16_bf16 v[16:31], v[148:151], v[104:107], v[16:31]
    ds_read_b128 v[144:147], v160 offset:128
    v_mfma_f32_32x32x16_bf16 v[32:47], v[152:155], v[104:107], v[32:47]
    ds_read_b128 v[148:151], v161 offset:128
    v_mfma_f32_32x32x16_bf16 v[48:63], v[156:159], v[104:107], v[48:63]
    ds_read_b128 v[152:155], v160 offset:192
    ds_read_b128 v[156:159], v161 offset:192
    v_subrev_u32 v160, 104448, v160
    v_subrev_u32 v161, 104448, v161
    s_cmp_lg_u32 s68, 2
    s_cbranch_scc1 L_rw_a11_2
    s_waitcnt vmcnt(8)
L_rw_a11_2:
    s_barrier
    s_cmp_lt_u32 s68, 2
    s_cbranch_scc1 L_r2_L_kd_a11
    s_cmp_lt_u32 s6, 10
    s_cbranch_scc0 L_kd_a11_v
    s_add_u32 s64, s61, 114688
    s_add_u32 m0, s63, 69632
    s_nop 0
    buffer_load_dwordx4 v163, s[52:55], s64 offen nt lds
    s_add_u32 s64, s61, 115712
    s_add_u32 m0, s63, 70720
    s_nop 0
    buffer_load_dwordx4 v163, s[52:55], s64 offen nt lds
    s_add_u32 s64, s61, 116736
    s_add_u32 m0, s63, 71808
    s_nop 0
    buffer_load_dwordx4 v163, s[52:55], s64 offen nt lds
    s_add_u32 s64, s61, 117760
    s_add_u32 m0, s63, 72896
    s_nop 0
    buffer_load_dwordx4 v163, s[52:55], s64 offen nt lds
    s_add_u32 s64, s61, 118784
    s_add_u32 m0, s63, 73984
    s_nop 0
    buffer_load_dwordx4 v163, s[52:55], s64 offen nt lds
    s_add_u32 s64, s61, 119808
    s_add_u32 m0, s63, 75072
    s_nop 0
    buffer_load_dwordx4 v163, s[52:55], s64 offen nt lds
    s_add_u32 s64, s61, 120832
    s_add_u32 m0, s63, 76160
    s_nop 0
    buffer_load_dwordx4 v163, s[52:55], s64 offen nt lds
    s_add_u32 s64, s61, 121856
    s_add_u32 m0, s63, 77248
    s_nop 0
    buffer_load_dwordx4 v163, s[52:55], s64 offen nt lds
    s_branch L_r2_L_kd_a11
L_kd_a11_v:
    s_add_u32 s64, s61, 114688
    s_add_u32 m0, s63, 69632
    s_nop 0
    buffer_load_dwordx4 v163, s[52:55], s64 offen nt lds
    s_add_u32 s64, s61, 114944
    s_add_u32 m0, s63, 70720
    s_nop 0
    buffer_load_dwordx4 v163, s[52:55], s64 offen nt lds
    s_add_u32 s64, s61, 115200
    s_add_u32 m0, s63, 71808
    s_nop 0
    buffer_load_dwordx4 v163, s[52:55], s64 offen nt lds
    s_add_u32 s64, s61, 115456
    s_add_u32 m0, s63, 72896
    s_nop 0
    buffer_load_dwordx4 v163, s[52:55], s64 offen nt lds
    s_add_u32 s64, s61, 118784
    s_add_u32 m0, s63, 73984
    s_nop 0
    buffer_load_dwordx4 v163, s[52:55], s64 offen nt lds
    s_add_u32 s64, s61, 119040
    s_add_u32 m0, s63, 75072
    s_nop 0
    buffer_load_dwordx4 v163, s[52:55], s64 offen nt lds
    s_add_u32 s64, s61, 119296
    s_add_u32 m0, s63, 76160
    s_nop 0
    buffer_load_dwordx4 v163, s[52:55], s64 offen nt lds
    s_add_u32 s64, s61, 119552
    s_add_u32 m0, s63, 77248
    s_nop 0
    buffer_load_dwordx4 v163, s[52:55], s64 offen nt lds
L_r2_L_kd_a11:
    s_setprio 1
    s_waitcnt lgkmcnt(0)
    v_mfma_f32_32x32x16_bf16 v[96:111], v[128:131], v[64:67], v[112:127]
    v_mfma_f32_32x32x16_bf16 v[96:111], v[132:135], v[68:71], v[96:111]
    ds_read_b64_tr_b16 v[128:129], v162 offset:0
    ds_read_b64_tr_b16 v[130:131], v162 offset:512
    v_mfma_f32_32x32x16_bf16 v[96:111], v[136:139], v[72:75], v[96:111]
    ds_read_b64_tr_b16 v[132:133], v162 offset:64
    ds_read_b64_tr_b16 v[134:135], v162 offset:576
    v_mfma_f32_32x32x16_bf16 v[96:111], v[140:143], v[76:79], v[96:111]
    ds_read_b64_tr_b16 v[136:137], v162 offset:128
    ds_read_b64_tr_b16 v[138:139], v162 offset:640
    v_mfma_f32_32x32x16_bf16 v[96:111], v[144:147], v[80:83], v[96:111]
    ds_read_b64_tr_b16 v[140:141], v162 offset:192
    ds_read_b64_tr_b16 v[142:143], v162 offset:704
    v_mfma_f32_32x32x16_bf16 v[96:111], v[148:151], v[84:87], v[96:111]
    ds_read_b64_tr_b16 v[144:145], v162 offset:4352
    ds_read_b64_tr_b16 v[146:147], v162 offset:4864
    v_mfma_f32_32x32x16_bf16 v[96:111], v[152:155], v[88:91], v[96:111]
    ds_read_b64_tr_b16 v[148:149], v162 offset:4416
    ds_read_b64_tr_b16 v[150:151], v162 offset:4928
    v_mfma_f32_32x32x16_bf16 v[96:111], v[156:159], v[92:95], v[96:111]
    ds_read_b64_tr_b16 v[152:153], v162 offset:4480
    ds_read_b64_tr_b16 v[154:155], v162 offset:4992
    ds_read_b64_tr_b16 v[156:157], v162 offset:4544
    ds_read_b64_tr_b16 v[158:159], v162 offset:5056
    v_subrev_u32 v162, 104448, v162
    s_setprio 2
    s_nop 7
    s_nop 1
    v_max3_f32 v165, v96, v97, v98
    v_max3_f32 v166, v99, v100, v101
    v_max3_f32 v165, v165, v102, v103
    v_max3_f32 v166, v166, v104, v105
    v_max3_f32 v165, v165, v106, v107
    v_max3_f32 v166, v166, v108, v109
    v_max3_f32 v165, v165, v110, v111
    v_max_f32 v165, v165, v166
    v_cmp_lt_f32 vcc, 0x41000000, v165
    s_cbranch_vccnz L_rare_11
L_back_11:
    v_exp_f32 v96, v96
    v_exp_f32 v97, v97
    v_exp_f32 v98, v98
    v_exp_f32 v99, v99
    v_exp_f32 v100, v100
    v_exp_f32 v101, v101
    v_exp_f32 v102, v102
    v_exp_f32 v103, v103
    v_exp_f32 v104, v104
    v_exp_f32 v105, v105
    v_exp_f32 v106, v106
    v_exp_f32 v107, v107
    v_exp_f32 v108, v108
    v_exp_f32 v109, v109
    v_exp_f32 v110, v110
    v_exp_f32 v111, v111
    v_add_f32 v164, v164, v96
    v_add_f32 v164, v164, v97
    v_add_f32 v164, v164, v98
    v_add_f32 v164, v164, v99
    v_add_f32 v164, v164, v100
    v_add_f32 v164, v164, v101
    v_add_f32 v164, v164, v102
    v_add_f32 v164, v164, v103
    v_add_f32 v164, v164, v104
    v_add_f32 v164, v164, v105
    v_add_f32 v164, v164, v106
    v_add_f32 v164, v164, v107
    v_add_f32 v164, v164, v108
    v_add_f32 v164, v164, v109
    v_add_f32 v164, v164, v110
    v_add_f32 v164, v164, v111
    v_cvt_pk_bf16_f32 v96, v96, v97
    v_cvt_pk_bf16_f32 v97, v98, v99
    v_cvt_pk_bf16_f32 v98, v100, v101
    v_cvt_pk_bf16_f32 v99, v102, v103
    v_cvt_pk_bf16_f32 v104, v104, v105
    v_cvt_pk_bf16_f32 v105, v106, v107
    v_cvt_pk_bf16_f32 v106, v108, v109
    v_cvt_pk_bf16_f32 v107, v110, v111
    s_setprio 0
    s_waitcnt lgkmcnt(0)
    v_mfma_f32_32x32x16_bf16 v[0:15], v[128:131], v[96:99], v[0:15]
    v_mfma_f32_32x32x16_bf16 v[16:31], v[132:135], v[96:99], v[16:31]
    ds_read_b128 v[128:131], v160 offset:0
    v_mfma_f32_32x32x16_bf16 v[32:47], v[136:139], v[96:99], v[32:47]
    ds_read_b128 v[132:135], v161 offset:0
    v_mfma_f32_32x32x16_bf16 v[48:63], v[140:143], v[96:99], v[48:63]
    ds_read_b128 v[136:139], v160 offset:64
    v_mfma_f32_32x32x16_bf16 v[0:15], v[144:147], v[104:107], v[0:15]
    ds_read_b128 v[140:143], v161 offset:64
    v_mfma_f32_32x32x16_bf16 v[16:31], v[148:151], v[104:107], v[16:31]
    ds_read_b128 v[144:147], v160 offset:128
    v_mfma_f32_32x32x16_bf16 v[32:47], v[152:155], v[104:107], v[32:47]
    ds_read_b128 v[148:151], v161 offset:128
    v_mfma_f32_32x32x16_bf16 v[48:63], v[156:159], v[104:107], v[48:63]
    ds_read_b128 v[152:155], v160 offset:192
    ds_read_b128 v[156:159], v161 offset:192
    v_add_u32 v160, 34816, v160
    v_add_u32 v161, 34816, v161
    s_cmp_lg_u32 s68, 2
    s_cbranch_scc1 L_rw_a12_2
    s_waitcnt vmcnt(8)
L_rw_a12_2:
    s_barrier
    s_cmp_lt_u32 s68, 2
    s_cbranch_scc1 L_r2_L_kd_a12
    s_cmp_lt_u32 s6, 10
    s_cbranch_scc0 L_kd_a12_v
    s_add_u32 s64, s61, 122880
    s_add_u32 m0, s63, 104448
    s_nop 0
    buffer_load_dwordx4 v163, s[52:55], s64 offen nt lds
    s_add_u32 s64, s61, 123904
    s_add_u32 m0, s63, 105536
    s_nop 0
    buffer_load_dwordx4 v163, s[52:55], s64 offen nt lds
    s_add_u32 s64, s61, 124928
    s_add_u32 m0, s63, 106624
    s_nop 0
    buffer_load_dwordx4 v163, s[52:55], s64 offen nt lds
    s_add_u32 s64, s61, 125952
    s_add_u32 m0, s63, 107712
    s_nop 0
    buffer_load_dwordx4 v163, s[52:55], s64 offen nt lds
    s_add_u32 s64, s61, 126976
    s_add_u32 m0, s63, 108800
    s_nop 0
    buffer_load_dwordx4 v163, s[52:55], s64 offen nt lds
    s_add_u32 s64, s61, 128000
    s_add_u32 m0, s63, 109888
    s_nop 0
    buffer_load_dwordx4 v163, s[52:55], s64 offen nt lds
    s_add_u32 s64, s61, 129024
    s_add_u32 m0, s63, 110976
    s_nop 0
    buffer_load_dwordx4 v163, s[52:55], s64 offen nt lds
    s_add_u32 s64, s61, 130048
    s_add_u32 m0, s63, 112064
    s_nop 0
    buffer_load_dwordx4 v163, s[52:55], s64 offen nt lds
    s_branch L_r2_L_kd_a12
L_kd_a12_v:
    s_add_u32 s64, s61, 122880
    s_add_u32 m0, s63, 104448
    s_nop 0
    buffer_load_dwordx4 v163, s[52:55], s64 offen nt lds
    s_add_u32 s64, s61, 123136
    s_add_u32 m0, s63, 105536
    s_nop 0
    buffer_load_dwordx4 v163, s[52:55], s64 offen nt lds
    s_add_u32 s64, s61, 123392
    s_add_u32 m0, s63, 106624
    s_nop 0
    buffer_load_dwordx4 v163, s[52:55], s64 offen nt lds
    s_add_u32 s64, s61, 123648
    s_add_u32 m0, s63, 107712
    s_nop 0
    buffer_load_dwordx4 v163, s[52:55], s64 offen nt lds
    s_add_u32 s64, s61, 126976
    s_add_u32 m0, s63, 108800
    s_nop 0
    buffer_load_dwordx4 v163, s[52:55], s64 offen nt lds
    s_add_u32 s64, s61, 127232
    s_add_u32 m0, s63, 109888
    s_nop 0
    buffer_load_dwordx4 v163, s[52:55], s64 offen nt lds
    s_add_u32 s64, s61, 127488
    s_add_u32 m0, s63, 110976
    s_nop 0
    buffer_load_dwordx4 v163, s[52:55], s64 offen nt lds
    s_add_u32 s64, s61, 127744
    s_add_u32 m0, s63, 112064
    s_nop 0
    buffer_load_dwordx4 v163, s[52:55], s64 offen nt lds
L_r2_L_kd_a12:
    s_setprio 1
    s_waitcnt lgkmcnt(0)
    v_mfma_f32_32x32x16_bf16 v[96:111], v[128:131], v[64:67], v[112:127]
    v_mfma_f32_32x32x16_bf16 v[96:111], v[132:135], v[68:71], v[96:111]
    ds_read_b64_tr_b16 v[128:129], v162 offset:0
    ds_read_b64_tr_b16 v[130:131], v162 offset:512
    v_mfma_f32_32x32x16_bf16 v[96:111], v[136:139], v[72:75], v[96:111]
    ds_read_b64_tr_b16 v[132:133], v162 offset:64
    ds_read_b64_tr_b16 v[134:135], v162 offset:576
    v_mfma_f32_32x32x16_bf16 v[96:111], v[140:143], v[76:79], v[96:111]
    ds_read_b64_tr_b16 v[136:137], v162 offset:128
    ds_read_b64_tr_b16 v[138:139], v162 offset:640
    v_mfma_f32_32x32x16_bf16 v[96:111], v[144:147], v[80:83], v[96:111]
    ds_read_b64_tr_b16 v[140:141], v162 offset:192
    ds_read_b64_tr_b16 v[142:143], v162 offset:704
    v_mfma_f32_32x32x16_bf16 v[96:111], v[148:151], v[84:87], v[96:111]
    ds_read_b64_tr_b16 v[144:145], v162 offset:4352
    ds_read_b64_tr_b16 v[146:147], v162 offset:4864
    v_mfma_f32_32x32x16_bf16 v[96:111], v[152:155], v[88:91], v[96:111]
    ds_read_b64_tr_b16 v[148:149], v162 offset:4416
    ds_read_b64_tr_b16 v[150:151], v162 offset:4928
    v_mfma_f32_32x32x16_bf16 v[96:111], v[156:159], v[92:95], v[96:111]
    ds_read_b64_tr_b16 v[152:153], v162 offset:4480
    ds_read_b64_tr_b16 v[154:155], v162 offset:4992
    ds_read_b64_tr_b16 v[156:157], v162 offset:4544
    ds_read_b64_tr_b16 v[158:159], v162 offset:5056
    v_add_u32 v162, 34816, v162
    s_setprio 2
    s_nop 7
    s_nop 1
    v_max3_f32 v165, v96, v97, v98
    v_max3_f32 v166, v99, v100, v101
    v_max3_f32 v165, v165, v102, v103
    v_max3_f32 v166, v166, v104, v105
    v_max3_f32 v165, v165, v106, v107
    v_max3_f32 v166, v166, v108, v109
    v_max3_f32 v165, v165, v110, v111
    v_max_f32 v165, v165, v166
    v_cmp_lt_f32 vcc, 0x41000000, v165
    s_cbranch_vccnz L_rare_12
L_back_12:
    v_exp_f32 v96, v96
    v_exp_f32 v97, v97
    v_exp_f32 v98, v98
    v_exp_f32 v99, v99
    v_exp_f32 v100, v100
    v_exp_f32 v101, v101
    v_exp_f32 v102, v102
    v_exp_f32 v103, v103
    v_exp_f32 v104, v104
    v_exp_f32 v105, v105
    v_exp_f32 v106, v106
    v_exp_f32 v107, v107
    v_exp_f32 v108, v108
    v_exp_f32 v109, v109
    v_exp_f32 v110, v110
    v_exp_f32 v111, v111
    v_add_f32 v164, v164, v96
    v_add_f32 v164, v164, v97
    v_add_f32 v164, v164, v98
    v_add_f32 v164, v164, v99
    v_add_f32 v164, v164, v100
    v_add_f32 v164, v164, v101
    v_add_f32 v164, v164, v102
    v_add_f32 v164, v164, v103
    v_add_f32 v164, v164, v104
    v_add_f32 v164, v164, v105
    v_add_f32 v164, v164, v106
    v_add_f32 v164, v164, v107
    v_add_f32 v164, v164, v108
    v_add_f32 v164, v164, v109
    v_add_f32 v164, v164, v110
    v_add_f32 v164, v164, v111
    v_cvt_pk_bf16_f32 v96, v96, v97
    v_cvt_pk_bf16_f32 v97, v98, v99
    v_cvt_pk_bf16_f32 v98, v100, v101
    v_cvt_pk_bf16_f32 v99, v102, v103
    v_cvt_pk_bf16_f32 v104, v104, v105
    v_cvt_pk_bf16_f32 v105, v106, v107
    v_cvt_pk_bf16_f32 v106, v108, v109
    v_cvt_pk_bf16_f32 v107, v110, v111
    s_setprio 0
    s_waitcnt lgkmcnt(0)
    v_mfma_f32_32x32x16_bf16 v[0:15], v[128:131], v[96:99], v[0:15]
    v_mfma_f32_32x32x16_bf16 v[16:31], v[132:135], v[96:99], v[16:31]
    ds_read_b128 v[128:131], v160 offset:0
    v_mfma_f32_32x32x16_bf16 v[32:47], v[136:139], v[96:99], v[32:47]
    ds_read_b128 v[132:135], v161 offset:0
    v_mfma_f32_32x32x16_bf16 v[48:63], v[140:143], v[96:99], v[48:63]
    ds_read_b128 v[136:139], v160 offset:64
    v_mfma_f32_32x32x16_bf16 v[0:15], v[144:147], v[104:107], v[0:15]
    ds_read_b128 v[140:143], v161 offset:64
    v_mfma_f32_32x32x16_bf16 v[16:31], v[148:151], v[104:107], v[16:31]
    ds_read_b128 v[144:147], v160 offset:128
    v_mfma_f32_32x32x16_bf16 v[32:47], v[152:155], v[104:107], v[32:47]
    ds_read_b128 v[148:151], v161 offset:128
    v_mfma_f32_32x32x16_bf16 v[48:63], v[156:159], v[104:107], v[48:63]
    ds_read_b128 v[152:155], v160 offset:192
    ds_read_b128 v[156:159], v161 offset:192
    v_add_u32 v160, 34816, v160
    v_add_u32 v161, 34816, v161
    s_cmp_lg_u32 s68, 2
    s_cbranch_scc1 L_rw_a13_2
    s_waitcnt vmcnt(8)
L_rw_a13_2:
    s_barrier
    v_lshrrev_b32 v165, 4, v167
    v_and_b32 v166, 15, v167
    v_mul_u32_u24 v165, 5120, v165
    v_lshl_add_u32 v165, v166, 4, v165
    s_cmp_lt_u32 s68, 2
    s_cbranch_scc1 L_r2_wo
    s_cmp_lg_u32 s6, 8
    s_cbranch_scc1 L_wo4_skip
    s_add_u32 s64, s47, 1024
    s_mov_b32 m0, 139264
    s_nop 0
    buffer_load_dwordx4 v165, s[36:39], s64 offen lds
    s_add_u32 s64, s47, 2304
    s_mov_b32 m0, 140352
    s_nop 0
    buffer_load_dwordx4 v165, s[36:39], s64 offen lds
    s_add_u32 s64, s47, 3584
    s_mov_b32 m0, 141440
    s_nop 0
    buffer_load_dwordx4 v165, s[36:39], s64 offen lds
    s_add_u32 s64, s47, 4864
    s_mov_b32 m0, 142528
    s_nop 0
    buffer_load_dwordx4 v165, s[36:39], s64 offen lds
    s_add_u32 s64, s47, 21504
    s_mov_b32 m0, 143616
    s_nop 0
    buffer_load_dwordx4 v165, s[36:39], s64 offen lds
    s_add_u32 s64, s47, 22784
    s_mov_b32 m0, 144704
    s_nop 0
    buffer_load_dwordx4 v165, s[36:39], s64 offen lds
    s_add_u32 s64, s47, 24064
    s_mov_b32 m0, 145792
    s_nop 0
    buffer_load_dwordx4 v165, s[36:39], s64 offen lds
    s_add_u32 s64, s47, 25344
    s_mov_b32 m0, 146880
    s_nop 0
    buffer_load_dwordx4 v165, s[36:39], s64 offen lds
L_wo4_skip:
    s_add_u32 s64, s47, 0
    s_add_u32 m0, s63, 0
    s_nop 0
    buffer_load_dwordx4 v165, s[36:39], s64 offen lds
    s_add_u32 s64, s47, 1280
    s_add_u32 m0, s63, 1088
    s_nop 0
    buffer_load_dwordx4 v165, s[36:39], s64 offen lds
    s_add_u32 s64, s47, 2560
    s_add_u32 m0, s63, 2176
    s_nop 0
    buffer_load_dwordx4 v165, s[36:39], s64 offen lds
    s_add_u32 s64, s47, 3840
    s_add_u32 m0, s63, 3264
    s_nop 0
    buffer_load_dwordx4 v165, s[36:39], s64 offen lds
    s_add_u32 s64, s47, 20480
    s_add_u32 m0, s63, 4352
    s_nop 0
    buffer_load_dwordx4 v165, s[36:39], s64 offen lds
    s_add_u32 s64, s47, 21760
    s_add_u32 m0, s63, 5440
    s_nop 0
    buffer_load_dwordx4 v165, s[36:39], s64 offen lds
    s_add_u32 s64, s47, 23040
    s_add_u32 m0, s63, 6528
    s_nop 0
    buffer_load_dwordx4 v165, s[36:39], s64 offen lds
    s_add_u32 s64, s47, 24320
    s_add_u32 m0, s63, 7616
    s_nop 0
    buffer_load_dwordx4 v165, s[36:39], s64 offen lds
L_r2_wo:
    s_setprio 1
    s_waitcnt lgkmcnt(0)
    v_mfma_f32_32x32x16_bf16 v[96:111], v[128:131], v[64:67], v[112:127]
    v_mfma_f32_32x32x16_bf16 v[96:111], v[132:135], v[68:71], v[96:111]
    ds_read_b64_tr_b16 v[128:129], v162 offset:0
    ds_read_b64_tr_b16 v[130:131], v162 offset:512
    v_mfma_f32_32x32x16_bf16 v[96:111], v[136:139], v[72:75], v[96:111]
    ds_read_b64_tr_b16 v[132:133], v162 offset:64
    ds_read_b64_tr_b16 v[134:135], v162 offset:576
    v_mfma_f32_32x32x16_bf16 v[96:111], v[140:143], v[76:79], v[96:111]
    ds_read_b64_tr_b16 v[136:137], v162 offset:128
    ds_read_b64_tr_b16 v[138:139], v162 offset:640
    v_mfma_f32_32x32x16_bf16 v[96:111], v[144:147], v[80:83], v[96:111]
    ds_read_b64_tr_b16 v[140:141], v162 offset:192
    ds_read_b64_tr_b16 v[142:143], v162 offset:704
    v_mfma_f32_32x32x16_bf16 v[96:111], v[148:151], v[84:87], v[96:111]
    ds_read_b64_tr_b16 v[144:145], v162 offset:4352
    ds_read_b64_tr_b16 v[146:147], v162 offset:4864
    v_mfma_f32_32x32x16_bf16 v[96:111], v[152:155], v[88:91], v[96:111]
    ds_read_b64_tr_b16 v[148:149], v162 offset:4416
    ds_read_b64_tr_b16 v[150:151], v162 offset:4928
    v_mfma_f32_32x32x16_bf16 v[96:111], v[156:159], v[92:95], v[96:111]
    ds_read_b64_tr_b16 v[152:153], v162 offset:4480
    ds_read_b64_tr_b16 v[154:155], v162 offset:4992
    ds_read_b64_tr_b16 v[156:157], v162 offset:4544
    ds_read_b64_tr_b16 v[158:159], v162 offset:5056
    v_add_u32 v162, 34816, v162
    s_setprio 2
    s_nop 7
    s_nop 1
    v_max3_f32 v165, v96, v97, v98
    v_max3_f32 v166, v99, v100, v101
    v_max3_f32 v165, v165, v102, v103
    v_max3_f32 v166, v166, v104, v105
    v_max3_f32 v165, v165, v106, v107
    v_max3_f32 v166, v166, v108, v109
    v_max3_f32 v165, v165, v110, v111
    v_max_f32 v165, v165, v166
    v_cmp_lt_f32 vcc, 0x41000000, v165
    s_cbranch_vccnz L_rare_13
L_back_13:
    v_exp_f32 v96, v96
    v_exp_f32 v97, v97
    v_exp_f32 v98, v98
    v_exp_f32 v99, v99
    v_exp_f32 v100, v100
    v_exp_f32 v101, v101
    v_exp_f32 v102, v102
    v_exp_f32 v103, v103
    v_exp_f32 v104, v104
    v_exp_f32 v105, v105
    v_exp_f32 v106, v106
    v_exp_f32 v107, v107
    v_exp_f32 v108, v108
    v_exp_f32 v109, v109
    v_exp_f32 v110, v110
    v_exp_f32 v111, v111
    v_add_f32 v164, v164, v96
    v_add_f32 v164, v164, v97
    v_add_f32 v164, v164, v98
    v_add_f32 v164, v164, v99
    v_add_f32 v164, v164, v100
    v_add_f32 v164, v164, v101
    v_add_f32 v164, v164, v102
    v_add_f32 v164, v164, v103
    v_add_f32 v164, v164, v104
    v_add_f32 v164, v164, v105
    v_add_f32 v164, v164, v106
    v_add_f32 v164, v164, v107
    v_add_f32 v164, v164, v108
    v_add_f32 v164, v164, v109
    v_add_f32 v164, v164, v110
    v_add_f32 v164, v164, v111
    v_cvt_pk_bf16_f32 v96, v96, v97
    v_cvt_pk_bf16_f32 v97, v98, v99
    v_cvt_pk_bf16_f32 v98, v100, v101
    v_cvt_pk_bf16_f32 v99, v102, v103
    v_cvt_pk_bf16_f32 v104, v104, v105
    v_cvt_pk_bf16_f32 v105, v106, v107
    v_cvt_pk_bf16_f32 v106, v108, v109
    v_cvt_pk_bf16_f32 v107, v110, v111
    s_setprio 0
    s_waitcnt lgkmcnt(0)
    v_mfma_f32_32x32x16_bf16 v[0:15], v[128:131], v[96:99], v[0:15]
    v_mfma_f32_32x32x16_bf16 v[16:31], v[132:135], v[96:99], v[16:31]
    ds_read_b128 v[128:131], v160 offset:0
    v_mfma_f32_32x32x16_bf16 v[32:47], v[136:139], v[96:99], v[32:47]
    ds_read_b128 v[132:135], v161 offset:0
    v_mfma_f32_32x32x16_bf16 v[48:63], v[140:143], v[96:99], v[48:63]
    ds_read_b128 v[136:139], v160 offset:64
    v_mfma_f32_32x32x16_bf16 v[0:15], v[144:147], v[104:107], v[0:15]
    ds_read_b128 v[140:143], v161 offset:64
    v_mfma_f32_32x32x16_bf16 v[16:31], v[148:151], v[104:107], v[16:31]
    ds_read_b128 v[144:147], v160 offset:128
    v_mfma_f32_32x32x16_bf16 v[32:47], v[152:155], v[104:107], v[32:47]
    ds_read_b128 v[148:151], v161 offset:128
    v_mfma_f32_32x32x16_bf16 v[48:63], v[156:159], v[104:107], v[48:63]
    ds_read_b128 v[152:155], v160 offset:192
    ds_read_b128 v[156:159], v161 offset:192
    v_add_u32 v160, 34816, v160
    v_add_u32 v161, 34816, v161
    s_cmp_lg_u32 s68, 2
    s_cbranch_scc1 L_rw_a14_2
    s_waitcnt vmcnt(8)
L_rw_a14_2:
    s_barrier
    s_setprio 1
    s_waitcnt lgkmcnt(0)
    v_mfma_f32_32x32x16_bf16 v[96:111], v[128:131], v[64:67], v[112:127]
    v_mfma_f32_32x32x16_bf16 v[96:111], v[132:135], v[68:71], v[96:111]
    ds_read_b64_tr_b16 v[128:129], v162 offset:0
    ds_read_b64_tr_b16 v[130:131], v162 offset:512
    v_mfma_f32_32x32x16_bf16 v[96:111], v[136:139], v[72:75], v[96:111]
    ds_read_b64_tr_b16 v[132:133], v162 offset:64
    ds_read_b64_tr_b16 v[134:135], v162 offset:576
    v_mfma_f32_32x32x16_bf16 v[96:111], v[140:143], v[76:79], v[96:111]
    ds_read_b64_tr_b16 v[136:137], v162 offset:128
    ds_read_b64_tr_b16 v[138:139], v162 offset:640
    v_mfma_f32_32x32x16_bf16 v[96:111], v[144:147], v[80:83], v[96:111]
    ds_read_b64_tr_b16 v[140:141], v162 offset:192
    ds_read_b64_tr_b16 v[142:143], v162 offset:704
    v_mfma_f32_32x32x16_bf16 v[96:111], v[148:151], v[84:87], v[96:111]
    ds_read_b64_tr_b16 v[144:145], v162 offset:4352
    ds_read_b64_tr_b16 v[146:147], v162 offset:4864
    v_mfma_f32_32x32x16_bf16 v[96:111], v[152:155], v[88:91], v[96:111]
    ds_read_b64_tr_b16 v[148:149], v162 offset:4416
    ds_read_b64_tr_b16 v[150:151], v162 offset:4928
    v_mfma_f32_32x32x16_bf16 v[96:111], v[156:159], v[92:95], v[96:111]
    ds_read_b64_tr_b16 v[152:153], v162 offset:4480
    ds_read_b64_tr_b16 v[154:155], v162 offset:4992
    ds_read_b64_tr_b16 v[156:157], v162 offset:4544
    ds_read_b64_tr_b16 v[158:159], v162 offset:5056
    v_add_u32 v162, 34816, v162
    s_setprio 2
    s_nop 7
    s_nop 1
    v_max3_f32 v165, v96, v97, v98
    v_max3_f32 v166, v99, v100, v101
    v_max3_f32 v165, v165, v102, v103
    v_max3_f32 v166, v166, v104, v105
    v_max3_f32 v165, v165, v106, v107
    v_max3_f32 v166, v166, v108, v109
    v_max3_f32 v165, v165, v110, v111
    v_max_f32 v165, v165, v166
    v_cmp_lt_f32 vcc, 0x41000000, v165
    s_cbranch_vccnz L_rare_14
L_back_14:
    v_exp_f32 v96, v96
    v_exp_f32 v97, v97
    v_exp_f32 v98, v98
    v_exp_f32 v99, v99
    v_exp_f32 v100, v100
    v_exp_f32 v101, v101
    v_exp_f32 v102, v102
    v_exp_f32 v103, v103
    v_exp_f32 v104, v104
    v_exp_f32 v105, v105
    v_exp_f32 v106, v106
    v_exp_f32 v107, v107
    v_exp_f32 v108, v108
    v_exp_f32 v109, v109
    v_exp_f32 v110, v110
    v_exp_f32 v111, v111
    v_add_f32 v164, v164, v96
    v_add_f32 v164, v164, v97
    v_add_f32 v164, v164, v98
    v_add_f32 v164, v164, v99
    v_add_f32 v164, v164, v100
    v_add_f32 v164, v164, v101
    v_add_f32 v164, v164, v102
    v_add_f32 v164, v164, v103
    v_add_f32 v164, v164, v104
    v_add_f32 v164, v164, v105
    v_add_f32 v164, v164, v106
    v_add_f32 v164, v164, v107
    v_add_f32 v164, v164, v108
    v_add_f32 v164, v164, v109
    v_add_f32 v164, v164, v110
    v_add_f32 v164, v164, v111
    v_cvt_pk_bf16_f32 v96, v96, v97
    v_cvt_pk_bf16_f32 v97, v98, v99
    v_cvt_pk_bf16_f32 v98, v100, v101
    v_cvt_pk_bf16_f32 v99, v102, v103
    v_cvt_pk_bf16_f32 v104, v104, v105
    v_cvt_pk_bf16_f32 v105, v106, v107
    v_cvt_pk_bf16_f32 v106, v108, v109
    v_cvt_pk_bf16_f32 v107, v110, v111
    s_setprio 0
    s_waitcnt lgkmcnt(0)
    v_mfma_f32_32x32x16_bf16 v[0:15], v[128:131], v[96:99], v[0:15]
    v_mfma_f32_32x32x16_bf16 v[16:31], v[132:135], v[96:99], v[16:31]
    ds_read_b128 v[128:131], v160 offset:0
    v_mfma_f32_32x32x16_bf16 v[32:47], v[136:139], v[96:99], v[32:47]
    ds_read_b128 v[132:135], v161 offset:0
    v_mfma_f32_32x32x16_bf16 v[48:63], v[140:143], v[96:99], v[48:63]
    ds_read_b128 v[136:139], v160 offset:64
    v_mfma_f32_32x32x16_bf16 v[0:15], v[144:147], v[104:107], v[0:15]
    ds_read_b128 v[140:143], v161 offset:64
    v_mfma_f32_32x32x16_bf16 v[16:31], v[148:151], v[104:107], v[16:31]
    ds_read_b128 v[144:147], v160 offset:128
    v_mfma_f32_32x32x16_bf16 v[32:47], v[152:155], v[104:107], v[32:47]
    ds_read_b128 v[148:151], v161 offset:128
    v_mfma_f32_32x32x16_bf16 v[48:63], v[156:159], v[104:107], v[48:63]
    ds_read_b128 v[152:155], v160 offset:192
    ds_read_b128 v[156:159], v161 offset:192
    v_subrev_u32 v160, 104448, v160
    v_subrev_u32 v161, 104448, v161
    s_barrier
    s_setprio 1
    s_waitcnt lgkmcnt(0)
    v_mfma_f32_32x32x16_bf16 v[96:111], v[128:131], v[64:67], v[112:127]
    v_mfma_f32_32x32x16_bf16 v[96:111], v[132:135], v[68:71], v[96:111]
    ds_read_b64_tr_b16 v[128:129], v162 offset:0
    ds_read_b64_tr_b16 v[130:131], v162 offset:512
    v_mfma_f32_32x32x16_bf16 v[96:111], v[136:139], v[72:75], v[96:111]
    ds_read_b64_tr_b16 v[132:133], v162 offset:64
    ds_read_b64_tr_b16 v[134:135], v162 offset:576
    v_mfma_f32_32x32x16_bf16 v[96:111], v[140:143], v[76:79], v[96:111]
    ds_read_b64_tr_b16 v[136:137], v162 offset:128
    ds_read_b64_tr_b16 v[138:139], v162 offset:640
    v_mfma_f32_32x32x16_bf16 v[96:111], v[144:147], v[80:83], v[96:111]
    ds_read_b64_tr_b16 v[140:141], v162 offset:192
    ds_read_b64_tr_b16 v[142:143], v162 offset:704
    v_mfma_f32_32x32x16_bf16 v[96:111], v[148:151], v[84:87], v[96:111]
    ds_read_b64_tr_b16 v[144:145], v162 offset:4352
    ds_read_b64_tr_b16 v[146:147], v162 offset:4864
    v_mfma_f32_32x32x16_bf16 v[96:111], v[152:155], v[88:91], v[96:111]
    ds_read_b64_tr_b16 v[148:149], v162 offset:4416
    ds_read_b64_tr_b16 v[150:151], v162 offset:4928
    v_mfma_f32_32x32x16_bf16 v[96:111], v[156:159], v[92:95], v[96:111]
    ds_read_b64_tr_b16 v[152:153], v162 offset:4480
    ds_read_b64_tr_b16 v[154:155], v162 offset:4992
    ds_read_b64_tr_b16 v[156:157], v162 offset:4544
    ds_read_b64_tr_b16 v[158:159], v162 offset:5056
    v_subrev_u32 v162, 104448, v162
    s_setprio 2
    s_nop 7
    s_nop 1
    v_max3_f32 v165, v96, v97, v98
    v_max3_f32 v166, v99, v100, v101
    v_max3_f32 v165, v165, v102, v103
    v_max3_f32 v166, v166, v104, v105
    v_max3_f32 v165, v165, v106, v107
    v_max3_f32 v166, v166, v108, v109
    v_max3_f32 v165, v165, v110, v111
    v_max_f32 v165, v165, v166
    v_cmp_lt_f32 vcc, 0x41000000, v165
    s_cbranch_vccnz L_rare_15
L_back_15:
    v_exp_f32 v96, v96
    v_exp_f32 v97, v97
    v_exp_f32 v98, v98
    v_exp_f32 v99, v99
    v_exp_f32 v100, v100
    v_exp_f32 v101, v101
    v_exp_f32 v102, v102
    v_exp_f32 v103, v103
    v_exp_f32 v104, v104
    v_exp_f32 v105, v105
    v_exp_f32 v106, v106
    v_exp_f32 v107, v107
    v_exp_f32 v108, v108
    v_exp_f32 v109, v109
    v_exp_f32 v110, v110
    v_exp_f32 v111, v111
    v_add_f32 v164, v164, v96
    v_add_f32 v164, v164, v97
    v_add_f32 v164, v164, v98
    v_add_f32 v164, v164, v99
    v_add_f32 v164, v164, v100
    v_add_f32 v164, v164, v101
    v_add_f32 v164, v164, v102
    v_add_f32 v164, v164, v103
    v_add_f32 v164, v164, v104
    v_add_f32 v164, v164, v105
    v_add_f32 v164, v164, v106
    v_add_f32 v164, v164, v107
    v_add_f32 v164, v164, v108
    v_add_f32 v164, v164, v109
    v_add_f32 v164, v164, v110
    v_add_f32 v164, v164, v111
    v_cvt_pk_bf16_f32 v96, v96, v97
    v_cvt_pk_bf16_f32 v97, v98, v99
    v_cvt_pk_bf16_f32 v98, v100, v101
    v_cvt_pk_bf16_f32 v99, v102, v103
    v_cvt_pk_bf16_f32 v104, v104, v105
    v_cvt_pk_bf16_f32 v105, v106, v107
    v_cvt_pk_bf16_f32 v106, v108, v109
    v_cvt_pk_bf16_f32 v107, v110, v111
    s_setprio 0
    s_waitcnt lgkmcnt(0)
    v_mfma_f32_32x32x16_bf16 v[0:15], v[128:131], v[96:99], v[0:15]
    v_mfma_f32_32x32x16_bf16 v[16:31], v[132:135], v[96:99], v[16:31]
    v_mfma_f32_32x32x16_bf16 v[32:47], v[136:139], v[96:99], v[32:47]
    v_mfma_f32_32x32x16_bf16 v[48:63], v[140:143], v[96:99], v[48:63]
    v_mfma_f32_32x32x16_bf16 v[0:15], v[144:147], v[104:107], v[0:15]
    v_mfma_f32_32x32x16_bf16 v[16:31], v[148:151], v[104:107], v[16:31]
    v_mfma_f32_32x32x16_bf16 v[32:47], v[152:155], v[104:107], v[32:47]
    v_mfma_f32_32x32x16_bf16 v[48:63], v[156:159], v[104:107], v[48:63]
    v_mov_b32 v166, v164
    s_nop 1
    v_permlane32_swap_b32 v164, v166
    s_nop 1
    v_add_f32 v164, v164, v166
    v_rcp_f32 v164, v164
    s_lshl_b32 s64, s3, 4
    s_lshl_b32 s65, s4, 1
    s_add_u32 s64, s64, s65
    s_cmp_ge_u32 s44, 3
    s_cselect_b32 s65, 1, 0
    s_add_u32 s64, s64, s65
    s_mul_i32 s65, s65, 3
    s_sub_u32 s66, s44, s65
    s_lshl_b32 s64, s64, 7
    s_lshl_b32 s65, s5, 1
    s_add_u32 s65, s65, s7
    s_lshl_b32 s65, s65, 2
    s_add_u32 s64, s64, s65
    s_mul_i32 s64, s64, 6144
    s_lshl_b32 s66, s66, 11
    s_add_u32 s64, s64, s66
    v_and_b32 v165, 15, v167
    v_bfe_u32 v166, v167, 4, 1
    v_lshlrev_b32 v166, 10, v166
    v_lshl_add_u32 v165, v165, 4, v166
    v_lshrrev_b32 v166, 5, v167
    v_lshl_add_u32 v165, v166, 8, v165
    s_nop 7
    v_mul_f32 v0, v0, v164
    v_mul_f32 v1, v1, v164
    v_cvt_pk_bf16_f32 v64, v0, v1
    v_mul_f32 v2, v2, v164
    v_mul_f32 v3, v3, v164
    v_cvt_pk_bf16_f32 v65, v2, v3
    v_mul_f32 v4, v4, v164
    v_mul_f32 v5, v5, v164
    v_cvt_pk_bf16_f32 v66, v4, v5
    v_mul_f32 v6, v6, v164
    v_mul_f32 v7, v7, v164
    v_cvt_pk_bf16_f32 v67, v6, v7
    buffer_store_dwordx4 v[64:67], v165, s[40:43], s64 offen offset:0
    v_mul_f32 v8, v8, v164
    v_mul_f32 v9, v9, v164
    v_cvt_pk_bf16_f32 v68, v8, v9
    v_mul_f32 v10, v10, v164
    v_mul_f32 v11, v11, v164
    v_cvt_pk_bf16_f32 v69, v10, v11
    v_mul_f32 v12, v12, v164
    v_mul_f32 v13, v13, v164
    v_cvt_pk_bf16_f32 v70, v12, v13
    v_mul_f32 v14, v14, v164
    v_mul_f32 v15, v15, v164
    v_cvt_pk_bf16_f32 v71, v14, v15
    buffer_store_dwordx4 v[68:71], v165, s[40:43], s64 offen offset:512
    s_add_u32 s64, s64, 6144
    v_mul_f32 v16, v16, v164
    v_mul_f32 v17, v17, v164
    v_cvt_pk_bf16_f32 v72, v16, v17
    v_mul_f32 v18, v18, v164
    v_mul_f32 v19, v19, v164
    v_cvt_pk_bf16_f32 v73, v18, v19
    v_mul_f32 v20, v20, v164
    v_mul_f32 v21, v21, v164
    v_cvt_pk_bf16_f32 v74, v20, v21
    v_mul_f32 v22, v22, v164
    v_mul_f32 v23, v23, v164
    v_cvt_pk_bf16_f32 v75, v22, v23
    buffer_store_dwordx4 v[72:75], v165, s[40:43], s64 offen offset:0
    v_mul_f32 v24, v24, v164
    v_mul_f32 v25, v25, v164
    v_cvt_pk_bf16_f32 v76, v24, v25
    v_mul_f32 v26, v26, v164
    v_mul_f32 v27, v27, v164
    v_cvt_pk_bf16_f32 v77, v26, v27
    v_mul_f32 v28, v28, v164
    v_mul_f32 v29, v29, v164
    v_cvt_pk_bf16_f32 v78, v28, v29
    v_mul_f32 v30, v30, v164
    v_mul_f32 v31, v31, v164
    v_cvt_pk_bf16_f32 v79, v30, v31
    buffer_store_dwordx4 v[76:79], v165, s[40:43], s64 offen offset:512
    s_add_u32 s64, s64, 6144
    v_mul_f32 v32, v32, v164
    v_mul_f32 v33, v33, v164
    v_cvt_pk_bf16_f32 v80, v32, v33
    v_mul_f32 v34, v34, v164
    v_mul_f32 v35, v35, v164
    v_cvt_pk_bf16_f32 v81, v34, v35
    v_mul_f32 v36, v36, v164
    v_mul_f32 v37, v37, v164
    v_cvt_pk_bf16_f32 v82, v36, v37
    v_mul_f32 v38, v38, v164
    v_mul_f32 v39, v39, v164
    v_cvt_pk_bf16_f32 v83, v38, v39
    buffer_store_dwordx4 v[80:83], v165, s[40:43], s64 offen offset:0
    v_mul_f32 v40, v40, v164
    v_mul_f32 v41, v41, v164
    v_cvt_pk_bf16_f32 v84, v40, v41
    v_mul_f32 v42, v42, v164
    v_mul_f32 v43, v43, v164
    v_cvt_pk_bf16_f32 v85, v42, v43
    v_mul_f32 v44, v44, v164
    v_mul_f32 v45, v45, v164
    v_cvt_pk_bf16_f32 v86, v44, v45
    v_mul_f32 v46, v46, v164
    v_mul_f32 v47, v47, v164
    v_cvt_pk_bf16_f32 v87, v46, v47
    buffer_store_dwordx4 v[84:87], v165, s[40:43], s64 offen offset:512
    s_add_u32 s64, s64, 6144
    v_mul_f32 v48, v48, v164
    v_mul_f32 v49, v49, v164
    v_cvt_pk_bf16_f32 v88, v48, v49
    v_mul_f32 v50, v50, v164
    v_mul_f32 v51, v51, v164
    v_cvt_pk_bf16_f32 v89, v50, v51
    v_mul_f32 v52, v52, v164
    v_mul_f32 v53, v53, v164
    v_cvt_pk_bf16_f32 v90, v52, v53
    v_mul_f32 v54, v54, v164
    v_mul_f32 v55, v55, v164
    v_cvt_pk_bf16_f32 v91, v54, v55
    buffer_store_dwordx4 v[88:91], v165, s[40:43], s64 offen offset:0
    v_mul_f32 v56, v56, v164
    v_mul_f32 v57, v57, v164
    v_cvt_pk_bf16_f32 v92, v56, v57
    v_mul_f32 v58, v58, v164
    v_mul_f32 v59, v59, v164
    v_cvt_pk_bf16_f32 v93, v58, v59
    v_mul_f32 v60, v60, v164
    v_mul_f32 v61, v61, v164
    v_cvt_pk_bf16_f32 v94, v60, v61
    v_mul_f32 v62, v62, v164
    v_mul_f32 v63, v63, v164
    v_cvt_pk_bf16_f32 v95, v62, v63
    buffer_store_dwordx4 v[92:95], v165, s[40:43], s64 offen offset:512
    s_add_u32 s64, s64, 6144
    s_cmp_lt_u32 s68, 2
    s_cbranch_scc1 L_r2_wofin
    v_lshrrev_b32 v1, 5, v167
    v_bfe_u32 v2, v167, 4, 1
    v_bfe_u32 v3, v167, 2, 2
    v_and_b32 v4, 3, v167
    v_lshl_add_u32 v1, v1, 2, v3
    v_mul_u32_u24 v1, 1088, v1
    v_lshl_add_u32 v1, v2, 8, v1
    v_lshl_add_u32 v1, v4, 3, v1
    v_add_u32 v2, s63, v1
    v_add_u32 v3, 139264, v1
    v_lshlrev_b32 v4, 4, v167
    s_waitcnt vmcnt(8)
    ds_read_b64_tr_b16 v[8:9], v2 offset:0
    ds_read_b64_tr_b16 v[10:11], v2 offset:512
    ds_read_b64_tr_b16 v[12:13], v2 offset:32
    ds_read_b64_tr_b16 v[14:15], v2 offset:544
    ds_read_b64_tr_b16 v[16:17], v2 offset:64
    ds_read_b64_tr_b16 v[18:19], v2 offset:576
    ds_read_b64_tr_b16 v[20:21], v2 offset:96
    ds_read_b64_tr_b16 v[22:23], v2 offset:608
    ds_read_b64_tr_b16 v[24:25], v2 offset:128
    ds_read_b64_tr_b16 v[26:27], v2 offset:640
    ds_read_b64_tr_b16 v[28:29], v2 offset:160
    ds_read_b64_tr_b16 v[30:31], v2 offset:672
    ds_read_b64_tr_b16 v[32:33], v2 offset:192
    ds_read_b64_tr_b16 v[34:35], v2 offset:704
    ds_read_b64_tr_b16 v[36:37], v2 offset:224
    ds_read_b64_tr_b16 v[38:39], v2 offset:736
    s_waitcnt lgkmcnt(0)
    s_add_u32 s65, s45, 0
    s_mul_i32 s66, s65, 52
    s_lshr_b32 s66, s66, 8
    s_mul_i32 s67, s66, 5
    s_sub_u32 s65, s65, s67
    s_mul_i32 s66, s66, 655360
    s_lshl_b32 s65, s65, 10
    s_add_u32 s64, s46, s66
    s_add_u32 s64, s64, s65
    buffer_store_dwordx4 v[8:11], v4, s[40:43], s64 offen
    s_add_u32 s65, s45, 1
    s_mul_i32 s66, s65, 52
    s_lshr_b32 s66, s66, 8
    s_mul_i32 s67, s66, 5
    s_sub_u32 s65, s65, s67
    s_mul_i32 s66, s66, 655360
    s_lshl_b32 s65, s65, 10
    s_add_u32 s64, s46, s66
    s_add_u32 s64, s64, s65
    buffer_store_dwordx4 v[12:15], v4, s[40:43], s64 offen
    s_add_u32 s65, s45, 2
    s_mul_i32 s66, s65, 52
    s_lshr_b32 s66, s66, 8
    s_mul_i32 s67, s66, 5
    s_sub_u32 s65, s65, s67
    s_mul_i32 s66, s66, 655360
    s_lshl_b32 s65, s65, 10
    s_add_u32 s64, s46, s66
    s_add_u32 s64, s64, s65
    buffer_store_dwordx4 v[16:19], v4, s[40:43], s64 offen
    s_add_u32 s65, s45, 3
    s_mul_i32 s66, s65, 52
    s_lshr_b32 s66, s66, 8
    s_mul_i32 s67, s66, 5
    s_sub_u32 s65, s65, s67
    s_mul_i32 s66, s66, 655360
    s_lshl_b32 s65, s65, 10
    s_add_u32 s64, s46, s66
    s_add_u32 s64, s64, s65
    buffer_store_dwordx4 v[20:23], v4, s[40:43], s64 offen
    s_add_u32 s65, s45, 4
    s_mul_i32 s66, s65, 52
    s_lshr_b32 s66, s66, 8
    s_mul_i32 s67, s66, 5
    s_sub_u32 s65, s65, s67
    s_mul_i32 s66, s66, 655360
    s_lshl_b32 s65, s65, 10
    s_add_u32 s64, s46, s66
    s_add_u32 s64, s64, s65
    buffer_store_dwordx4 v[24:27], v4, s[40:43], s64 offen
    s_add_u32 s65, s45, 5
    s_mul_i32 s66, s65, 52
    s_lshr_b32 s66, s66, 8
    s_mul_i32 s67, s66, 5
    s_sub_u32 s65, s65, s67
    s_mul_i32 s66, s66, 655360
    s_lshl_b32 s65, s65, 10
    s_add_u32 s64, s46, s66
    s_add_u32 s64, s64, s65
    buffer_store_dwordx4 v[28:31], v4, s[40:43], s64 offen
    s_add_u32 s65, s45, 6
    s_mul_i32 s66, s65, 52
    s_lshr_b32 s66, s66, 8
    s_mul_i32 s67, s66, 5
    s_sub_u32 s65, s65, s67
    s_mul_i32 s66, s66, 655360
    s_lshl_b32 s65, s65, 10
    s_add_u32 s64, s46, s66
    s_add_u32 s64, s64, s65
    buffer_store_dwordx4 v[32:35], v4, s[40:43], s64 offen
    s_add_u32 s65, s45, 7
    s_mul_i32 s66, s65, 52
    s_lshr_b32 s66, s66, 8
    s_mul_i32 s67, s66, 5
    s_sub_u32 s65, s65, s67
    s_mul_i32 s66, s66, 655360
    s_lshl_b32 s65, s65, 10
    s_add_u32 s64, s46, s66
    s_add_u32 s64, s64, s65
    buffer_store_dwordx4 v[36:39], v4, s[40:43], s64 offen
    s_nop 1
    s_cmp_lg_u32 s6, 8
    s_cbranch_scc1 L_r2_wofin
    ds_read_b64_tr_b16 v[8:9], v3 offset:0
    ds_read_b64_tr_b16 v[10:11], v3 offset:512
    ds_read_b64_tr_b16 v[12:13], v3 offset:32
    ds_read_b64_tr_b16 v[14:15], v3 offset:544
    ds_read_b64_tr_b16 v[16:17], v3 offset:64
    ds_read_b64_tr_b16 v[18:19], v3 offset:576
    ds_read_b64_tr_b16 v[20:21], v3 offset:96
    ds_read_b64_tr_b16 v[22:23], v3 offset:608
    ds_read_b64_tr_b16 v[24:25], v3 offset:128
    ds_read_b64_tr_b16 v[26:27], v3 offset:640
    ds_read_b64_tr_b16 v[28:29], v3 offset:160
    ds_read_b64_tr_b16 v[30:31], v3 offset:672
    ds_read_b64_tr_b16 v[32:33], v3 offset:192
    ds_read_b64_tr_b16 v[34:35], v3 offset:704
    ds_read_b64_tr_b16 v[36:37], v3 offset:224
    ds_read_b64_tr_b16 v[38:39], v3 offset:736
    s_waitcnt lgkmcnt(0)
    s_add_u32 s64, s46, 3934208
    buffer_store_dwordx4 v[8:11], v4, s[40:43], s64 offen
    s_add_u32 s64, s46, 3935232
    buffer_store_dwordx4 v[12:15], v4, s[40:43], s64 offen
    s_add_u32 s64, s46, 3936256
    buffer_store_dwordx4 v[16:19], v4, s[40:43], s64 offen
    s_add_u32 s64, s46, 4587520
    buffer_store_dwordx4 v[20:23], v4, s[40:43], s64 offen
    s_add_u32 s64, s46, 4588544
    buffer_store_dwordx4 v[24:27], v4, s[40:43], s64 offen
    s_add_u32 s64, s46, 4589568
    buffer_store_dwordx4 v[28:31], v4, s[40:43], s64 offen
    s_add_u32 s64, s46, 4590592
    buffer_store_dwordx4 v[32:35], v4, s[40:43], s64 offen
    s_add_u32 s64, s46, 4591616
    buffer_store_dwordx4 v[36:39], v4, s[40:43], s64 offen
    s_nop 1
L_r2_wofin:
L_k1_end:
    s_endpgm
L_rare_1:
    v_mov_b32 v166, v165
    s_nop 1
    v_permlane32_swap_b32 v165, v166
    s_nop 1
    v_max_f32 v165, v165, v166
    v_max_f32 v165, 0, v165
    v_exp_f32 v166, -v165
    v_sub_f32 v96, v96, v165
    v_sub_f32 v97, v97, v165
    v_sub_f32 v98, v98, v165
    v_sub_f32 v99, v99, v165
    v_sub_f32 v100, v100, v165
    v_sub_f32 v101, v101, v165
    v_sub_f32 v102, v102, v165
    v_sub_f32 v103, v103, v165
    v_sub_f32 v104, v104, v165
    v_sub_f32 v105, v105, v165
    v_sub_f32 v106, v106, v165
    v_sub_f32 v107, v107, v165
    v_sub_f32 v108, v108, v165
    v_sub_f32 v109, v109, v165
    v_sub_f32 v110, v110, v165
    v_sub_f32 v111, v111, v165
    v_sub_f32 v112, v112, v165
    v_sub_f32 v113, v113, v165
    v_sub_f32 v114, v114, v165
    v_sub_f32 v115, v115, v165
    v_sub_f32 v116, v116, v165
    v_sub_f32 v117, v117, v165
    v_sub_f32 v118, v118, v165
    v_sub_f32 v119, v119, v165
    v_sub_f32 v120, v120, v165
    v_sub_f32 v121, v121, v165
    v_sub_f32 v122, v122, v165
    v_sub_f32 v123, v123, v165
    v_sub_f32 v124, v124, v165
    v_sub_f32 v125, v125, v165
    v_sub_f32 v126, v126, v165
    v_sub_f32 v127, v127, v165
    v_mul_f32 v0, v0, v166
    v_mul_f32 v1, v1, v166
    v_mul_f32 v2, v2, v166
    v_mul_f32 v3, v3, v166
    v_mul_f32 v4, v4, v166
    v_mul_f32 v5, v5, v166
    v_mul_f32 v6, v6, v166
    v_mul_f32 v7, v7, v166
    v_mul_f32 v8, v8, v166
    v_mul_f32 v9, v9, v166
    v_mul_f32 v10, v10, v166
    v_mul_f32 v11, v11, v166
    v_mul_f32 v12, v12, v166
    v_mul_f32 v13, v13, v166
    v_mul_f32 v14, v14, v166
    v_mul_f32 v15, v15, v166
    v_mul_f32 v16, v16, v166
    v_mul_f32 v17, v17, v166
    v_mul_f32 v18, v18, v166
    v_mul_f32 v19, v19, v166
    v_mul_f32 v20, v20, v166
    v_mul_f32 v21, v21, v166
    v_mul_f32 v22, v22, v166
    v_mul_f32 v23, v23, v166
    v_mul_f32 v24, v24, v166
    v_mul_f32 v25, v25, v166
    v_mul_f32 v26, v26, v166
    v_mul_f32 v27, v27, v166
    v_mul_f32 v28, v28, v166
    v_mul_f32 v29, v29, v166
    v_mul_f32 v30, v30, v166
    v_mul_f32 v31, v31, v166
    v_mul_f32 v32, v32, v166
    v_mul_f32 v33, v33, v166
    v_mul_f32 v34, v34, v166
    v_mul_f32 v35, v35, v166
    v_mul_f32 v36, v36, v166
    v_mul_f32 v37, v37, v166
    v_mul_f32 v38, v38, v166
    v_mul_f32 v39, v39, v166
    v_mul_f32 v40, v40, v166
    v_mul_f32 v41, v41, v166
    v_mul_f32 v42, v42, v166
    v_mul_f32 v43, v43, v166
    v_mul_f32 v44, v44, v166
    v_mul_f32 v45, v45, v166
    v_mul_f32 v46, v46, v166
    v_mul_f32 v47, v47, v166
    v_mul_f32 v48, v48, v166
    v_mul_f32 v49, v49, v166
    v_mul_f32 v50, v50, v166
    v_mul_f32 v51, v51, v166
    v_mul_f32 v52, v52, v166
    v_mul_f32 v53, v53, v166
    v_mul_f32 v54, v54, v166
    v_mul_f32 v55, v55, v166
    v_mul_f32 v56, v56, v166
    v_mul_f32 v57, v57, v166
    v_mul_f32 v58, v58, v166
    v_mul_f32 v59, v59, v166
    v_mul_f32 v60, v60, v166
    v_mul_f32 v61, v61, v166
    v_mul_f32 v62, v62, v166
    v_mul_f32 v63, v63, v166
    v_mul_f32 v164, v164, v166
    s_nop 1
    s_branch L_back_1
L_rare_2:
    v_mov_b32 v166, v165
    s_nop 1
    v_permlane32_swap_b32 v165, v166
    s_nop 1
    v_max_f32 v165, v165, v166
    v_max_f32 v165, 0, v165
    v_exp_f32 v166, -v165
    v_sub_f32 v96, v96, v165
    v_sub_f32 v97, v97, v165
    v_sub_f32 v98, v98, v165
    v_sub_f32 v99, v99, v165
    v_sub_f32 v100, v100, v165
    v_sub_f32 v101, v101, v165
    v_sub_f32 v102, v102, v165
    v_sub_f32 v103, v103, v165
    v_sub_f32 v104, v104, v165
    v_sub_f32 v105, v105, v165
    v_sub_f32 v106, v106, v165
    v_sub_f32 v107, v107, v165
    v_sub_f32 v108, v108, v165
    v_sub_f32 v109, v109, v165
    v_sub_f32 v110, v110, v165
    v_sub_f32 v111, v111, v165
    v_sub_f32 v112, v112, v165
    v_sub_f32 v113, v113, v165
    v_sub_f32 v114, v114, v165
    v_sub_f32 v115, v115, v165
    v_sub_f32 v116, v116, v165
    v_sub_f32 v117, v117, v165
    v_sub_f32 v118, v118, v165
    v_sub_f32 v119, v119, v165
    v_sub_f32 v120, v120, v165
    v_sub_f32 v121, v121, v165
    v_sub_f32 v122, v122, v165
    v_sub_f32 v123, v123, v165
    v_sub_f32 v124, v124, v165
    v_sub_f32 v125, v125, v165
    v_sub_f32 v126, v126, v165
    v_sub_f32 v127, v127, v165
    v_mul_f32 v0, v0, v166
    v_mul_f32 v1, v1, v166
    v_mul_f32 v2, v2, v166
    v_mul_f32 v3, v3, v166
    v_mul_f32 v4, v4, v166
    v_mul_f32 v5, v5, v166
    v_mul_f32 v6, v6, v166
    v_mul_f32 v7, v7, v166
    v_mul_f32 v8, v8, v166
    v_mul_f32 v9, v9, v166
    v_mul_f32 v10, v10, v166
    v_mul_f32 v11, v11, v166
    v_mul_f32 v12, v12, v166
    v_mul_f32 v13, v13, v166
    v_mul_f32 v14, v14, v166
    v_mul_f32 v15, v15, v166
    v_mul_f32 v16, v16, v166
    v_mul_f32 v17, v17, v166
    v_mul_f32 v18, v18, v166
    v_mul_f32 v19, v19, v166
    v_mul_f32 v20, v20, v166
    v_mul_f32 v21, v21, v166
    v_mul_f32 v22, v22, v166
    v_mul_f32 v23, v23, v166
    v_mul_f32 v24, v24, v166
    v_mul_f32 v25, v25, v166
    v_mul_f32 v26, v26, v166
    v_mul_f32 v27, v27, v166
    v_mul_f32 v28, v28, v166
    v_mul_f32 v29, v29, v166
    v_mul_f32 v30, v30, v166
    v_mul_f32 v31, v31, v166
    v_mul_f32 v32, v32, v166
    v_mul_f32 v33, v33, v166
    v_mul_f32 v34, v34, v166
    v_mul_f32 v35, v35, v166
    v_mul_f32 v36, v36, v166
    v_mul_f32 v37, v37, v166
    v_mul_f32 v38, v38, v166
    v_mul_f32 v39, v39, v166
    v_mul_f32 v40, v40, v166
    v_mul_f32 v41, v41, v166
    v_mul_f32 v42, v42, v166
    v_mul_f32 v43, v43, v166
    v_mul_f32 v44, v44, v166
    v_mul_f32 v45, v45, v166
    v_mul_f32 v46, v46, v166
    v_mul_f32 v47, v47, v166
    v_mul_f32 v48, v48, v166
    v_mul_f32 v49, v49, v166
    v_mul_f32 v50, v50, v166
    v_mul_f32 v51, v51, v166
    v_mul_f32 v52, v52, v166
    v_mul_f32 v53, v53, v166
    v_mul_f32 v54, v54, v166
    v_mul_f32 v55, v55, v166
    v_mul_f32 v56, v56, v166
    v_mul_f32 v57, v57, v166
    v_mul_f32 v58, v58, v166
    v_mul_f32 v59, v59, v166
    v_mul_f32 v60, v60, v166
    v_mul_f32 v61, v61, v166
    v_mul_f32 v62, v62, v166
    v_mul_f32 v63, v63, v166
    v_mul_f32 v164, v164, v166
    s_nop 1
    s_branch L_back_2
L_rare_3:
    v_mov_b32 v166, v165
    s_nop 1
    v_permlane32_swap_b32 v165, v166
    s_nop 1
    v_max_f32 v165, v165, v166
    v_max_f32 v165, 0, v165
    v_exp_f32 v166, -v165
    v_sub_f32 v96, v96, v165
    v_sub_f32 v97, v97, v165
    v_sub_f32 v98, v98, v165
    v_sub_f32 v99, v99, v165
    v_sub_f32 v100, v100, v165
    v_sub_f32 v101, v101, v165
    v_sub_f32 v102, v102, v165
    v_sub_f32 v103, v103, v165
    v_sub_f32 v104, v104, v165
    v_sub_f32 v105, v105, v165
    v_sub_f32 v106, v106, v165
    v_sub_f32 v107, v107, v165
    v_sub_f32 v108, v108, v165
    v_sub_f32 v109, v109, v165
    v_sub_f32 v110, v110, v165
    v_sub_f32 v111, v111, v165
    v_sub_f32 v112, v112, v165
    v_sub_f32 v113, v113, v165
    v_sub_f32 v114, v114, v165
    v_sub_f32 v115, v115, v165
    v_sub_f32 v116, v116, v165
    v_sub_f32 v117, v117, v165
    v_sub_f32 v118, v118, v165
    v_sub_f32 v119, v119, v165
    v_sub_f32 v120, v120, v165
    v_sub_f32 v121, v121, v165
    v_sub_f32 v122, v122, v165
    v_sub_f32 v123, v123, v165
    v_sub_f32 v124, v124, v165
    v_sub_f32 v125, v125, v165
    v_sub_f32 v126, v126, v165
    v_sub_f32 v127, v127, v165
    v_mul_f32 v0, v0, v166
    v_mul_f32 v1, v1, v166
    v_mul_f32 v2, v2, v166
    v_mul_f32 v3, v3, v166
    v_mul_f32 v4, v4, v166
    v_mul_f32 v5, v5, v166
    v_mul_f32 v6, v6, v166
    v_mul_f32 v7, v7, v166
    v_mul_f32 v8, v8, v166
    v_mul_f32 v9, v9, v166
    v_mul_f32 v10, v10, v166
    v_mul_f32 v11, v11, v166
    v_mul_f32 v12, v12, v166
    v_mul_f32 v13, v13, v166
    v_mul_f32 v14, v14, v166
    v_mul_f32 v15, v15, v166
    v_mul_f32 v16, v16, v166
    v_mul_f32 v17, v17, v166
    v_mul_f32 v18, v18, v166
    v_mul_f32 v19, v19, v166
    v_mul_f32 v20, v20, v166
    v_mul_f32 v21, v21, v166
    v_mul_f32 v22, v22, v166
    v_mul_f32 v23, v23, v166
    v_mul_f32 v24, v24, v166
    v_mul_f32 v25, v25, v166
    v_mul_f32 v26, v26, v166
    v_mul_f32 v27, v27, v166
    v_mul_f32 v28, v28, v166
    v_mul_f32 v29, v29, v166
    v_mul_f32 v30, v30, v166
    v_mul_f32 v31, v31, v166
    v_mul_f32 v32, v32, v166
    v_mul_f32 v33, v33, v166
    v_mul_f32 v34, v34, v166
    v_mul_f32 v35, v35, v166
    v_mul_f32 v36, v36, v166
    v_mul_f32 v37, v37, v166
    v_mul_f32 v38, v38, v166
    v_mul_f32 v39, v39, v166
    v_mul_f32 v40, v40, v166
    v_mul_f32 v41, v41, v166
    v_mul_f32 v42, v42, v166
    v_mul_f32 v43, v43, v166
    v_mul_f32 v44, v44, v166
    v_mul_f32 v45, v45, v166
    v_mul_f32 v46, v46, v166
    v_mul_f32 v47, v47, v166
    v_mul_f32 v48, v48, v166
    v_mul_f32 v49, v49, v166
    v_mul_f32 v50, v50, v166
    v_mul_f32 v51, v51, v166
    v_mul_f32 v52, v52, v166
    v_mul_f32 v53, v53, v166
    v_mul_f32 v54, v54, v166
    v_mul_f32 v55, v55, v166
    v_mul_f32 v56, v56, v166
    v_mul_f32 v57, v57, v166
    v_mul_f32 v58, v58, v166
    v_mul_f32 v59, v59, v166
    v_mul_f32 v60, v60, v166
    v_mul_f32 v61, v61, v166
    v_mul_f32 v62, v62, v166
    v_mul_f32 v63, v63, v166
    v_mul_f32 v164, v164, v166
    s_nop 1
    s_branch L_back_3
L_rare_4:
    v_mov_b32 v166, v165
    s_nop 1
    v_permlane32_swap_b32 v165, v166
    s_nop 1
    v_max_f32 v165, v165, v166
    v_max_f32 v165, 0, v165
    v_exp_f32 v166, -v165
    v_sub_f32 v96, v96, v165
    v_sub_f32 v97, v97, v165
    v_sub_f32 v98, v98, v165
    v_sub_f32 v99, v99, v165
    v_sub_f32 v100, v100, v165
    v_sub_f32 v101, v101, v165
    v_sub_f32 v102, v102, v165
    v_sub_f32 v103, v103, v165
    v_sub_f32 v104, v104, v165
    v_sub_f32 v105, v105, v165
    v_sub_f32 v106, v106, v165
    v_sub_f32 v107, v107, v165
    v_sub_f32 v108, v108, v165
    v_sub_f32 v109, v109, v165
    v_sub_f32 v110, v110, v165
    v_sub_f32 v111, v111, v165
    v_sub_f32 v112, v112, v165
    v_sub_f32 v113, v113, v165
    v_sub_f32 v114, v114, v165
    v_sub_f32 v115, v115, v165
    v_sub_f32 v116, v116, v165
    v_sub_f32 v117, v117, v165
    v_sub_f32 v118, v118, v165
    v_sub_f32 v119, v119, v165
    v_sub_f32 v120, v120, v165
    v_sub_f32 v121, v121, v165
    v_sub_f32 v122, v122, v165
    v_sub_f32 v123, v123, v165
    v_sub_f32 v124, v124, v165
    v_sub_f32 v125, v125, v165
    v_sub_f32 v126, v126, v165
    v_sub_f32 v127, v127, v165
    v_mul_f32 v0, v0, v166
    v_mul_f32 v1, v1, v166
    v_mul_f32 v2, v2, v166
    v_mul_f32 v3, v3, v166
    v_mul_f32 v4, v4, v166
    v_mul_f32 v5, v5, v166
    v_mul_f32 v6, v6, v166
    v_mul_f32 v7, v7, v166
    v_mul_f32 v8, v8, v166
    v_mul_f32 v9, v9, v166
    v_mul_f32 v10, v10, v166
    v_mul_f32 v11, v11, v166
    v_mul_f32 v12, v12, v166
    v_mul_f32 v13, v13, v166
    v_mul_f32 v14, v14, v166
    v_mul_f32 v15, v15, v166
    v_mul_f32 v16, v16, v166
    v_mul_f32 v17, v17, v166
    v_mul_f32 v18, v18, v166
    v_mul_f32 v19, v19, v166
    v_mul_f32 v20, v20, v166
    v_mul_f32 v21, v21, v166
    v_mul_f32 v22, v22, v166
    v_mul_f32 v23, v23, v166
    v_mul_f32 v24, v24, v166
    v_mul_f32 v25, v25, v166
    v_mul_f32 v26, v26, v166
    v_mul_f32 v27, v27, v166
    v_mul_f32 v28, v28, v166
    v_mul_f32 v29, v29, v166
    v_mul_f32 v30, v30, v166
    v_mul_f32 v31, v31, v166
    v_mul_f32 v32, v32, v166
    v_mul_f32 v33, v33, v166
    v_mul_f32 v34, v34, v166
    v_mul_f32 v35, v35, v166
    v_mul_f32 v36, v36, v166
    v_mul_f32 v37, v37, v166
    v_mul_f32 v38, v38, v166
    v_mul_f32 v39, v39, v166
    v_mul_f32 v40, v40, v166
    v_mul_f32 v41, v41, v166
    v_mul_f32 v42, v42, v166
    v_mul_f32 v43, v43, v166
    v_mul_f32 v44, v44, v166
    v_mul_f32 v45, v45, v166
    v_mul_f32 v46, v46, v166
    v_mul_f32 v47, v47, v166
    v_mul_f32 v48, v48, v166
    v_mul_f32 v49, v49, v166
    v_mul_f32 v50, v50, v166
    v_mul_f32 v51, v51, v166
    v_mul_f32 v52, v52, v166
    v_mul_f32 v53, v53, v166
    v_mul_f32 v54, v54, v166
    v_mul_f32 v55, v55, v166
    v_mul_f32 v56, v56, v166
    v_mul_f32 v57, v57, v166
    v_mul_f32 v58, v58, v166
    v_mul_f32 v59, v59, v166
    v_mul_f32 v60, v60, v166
    v_mul_f32 v61, v61, v166
    v_mul_f32 v62, v62, v166
    v_mul_f32 v63, v63, v166
    v_mul_f32 v164, v164, v166
    s_nop 1
    s_branch L_back_4
L_rare_5:
    v_mov_b32 v166, v165
    s_nop 1
    v_permlane32_swap_b32 v165, v166
    s_nop 1
    v_max_f32 v165, v165, v166
    v_max_f32 v165, 0, v165
    v_exp_f32 v166, -v165
    v_sub_f32 v96, v96, v165
    v_sub_f32 v97, v97, v165
    v_sub_f32 v98, v98, v165
    v_sub_f32 v99, v99, v165
    v_sub_f32 v100, v100, v165
    v_sub_f32 v101, v101, v165
    v_sub_f32 v102, v102, v165
    v_sub_f32 v103, v103, v165
    v_sub_f32 v104, v104, v165
    v_sub_f32 v105, v105, v165
    v_sub_f32 v106, v106, v165
    v_sub_f32 v107, v107, v165
    v_sub_f32 v108, v108, v165
    v_sub_f32 v109, v109, v165
    v_sub_f32 v110, v110, v165
    v_sub_f32 v111, v111, v165
    v_sub_f32 v112, v112, v165
    v_sub_f32 v113, v113, v165
    v_sub_f32 v114, v114, v165
    v_sub_f32 v115, v115, v165
    v_sub_f32 v116, v116, v165
    v_sub_f32 v117, v117, v165
    v_sub_f32 v118, v118, v165
    v_sub_f32 v119, v119, v165
    v_sub_f32 v120, v120, v165
    v_sub_f32 v121, v121, v165
    v_sub_f32 v122, v122, v165
    v_sub_f32 v123, v123, v165
    v_sub_f32 v124, v124, v165
    v_sub_f32 v125, v125, v165
    v_sub_f32 v126, v126, v165
    v_sub_f32 v127, v127, v165
    v_mul_f32 v0, v0, v166
    v_mul_f32 v1, v1, v166
    v_mul_f32 v2, v2, v166
    v_mul_f32 v3, v3, v166
    v_mul_f32 v4, v4, v166
    v_mul_f32 v5, v5, v166
    v_mul_f32 v6, v6, v166
    v_mul_f32 v7, v7, v166
    v_mul_f32 v8, v8, v166
    v_mul_f32 v9, v9, v166
    v_mul_f32 v10, v10, v166
    v_mul_f32 v11, v11, v166
    v_mul_f32 v12, v12, v166
    v_mul_f32 v13, v13, v166
    v_mul_f32 v14, v14, v166
    v_mul_f32 v15, v15, v166
    v_mul_f32 v16, v16, v166
    v_mul_f32 v17, v17, v166
    v_mul_f32 v18, v18, v166
    v_mul_f32 v19, v19, v166
    v_mul_f32 v20, v20, v166
    v_mul_f32 v21, v21, v166
    v_mul_f32 v22, v22, v166
    v_mul_f32 v23, v23, v166
    v_mul_f32 v24, v24, v166
    v_mul_f32 v25, v25, v166
    v_mul_f32 v26, v26, v166
    v_mul_f32 v27, v27, v166
    v_mul_f32 v28, v28, v166
    v_mul_f32 v29, v29, v166
    v_mul_f32 v30, v30, v166
    v_mul_f32 v31, v31, v166
    v_mul_f32 v32, v32, v166
    v_mul_f32 v33, v33, v166
    v_mul_f32 v34, v34, v166
    v_mul_f32 v35, v35, v166
    v_mul_f32 v36, v36, v166
    v_mul_f32 v37, v37, v166
    v_mul_f32 v38, v38, v166
    v_mul_f32 v39, v39, v166
    v_mul_f32 v40, v40, v166
    v_mul_f32 v41, v41, v166
    v_mul_f32 v42, v42, v166
    v_mul_f32 v43, v43, v166
    v_mul_f32 v44, v44, v166
    v_mul_f32 v45, v45, v166
    v_mul_f32 v46, v46, v166
    v_mul_f32 v47, v47, v166
    v_mul_f32 v48, v48, v166
    v_mul_f32 v49, v49, v166
    v_mul_f32 v50, v50, v166
    v_mul_f32 v51, v51, v166
    v_mul_f32 v52, v52, v166
    v_mul_f32 v53, v53, v166
    v_mul_f32 v54, v54, v166
    v_mul_f32 v55, v55, v166
    v_mul_f32 v56, v56, v166
    v_mul_f32 v57, v57, v166
    v_mul_f32 v58, v58, v166
    v_mul_f32 v59, v59, v166
    v_mul_f32 v60, v60, v166
    v_mul_f32 v61, v61, v166
    v_mul_f32 v62, v62, v166
    v_mul_f32 v63, v63, v166
    v_mul_f32 v164, v164, v166
    s_nop 1
    s_branch L_back_5
L_rare_6:
    v_mov_b32 v166, v165
    s_nop 1
    v_permlane32_swap_b32 v165, v166
    s_nop 1
    v_max_f32 v165, v165, v166
    v_max_f32 v165, 0, v165
    v_exp_f32 v166, -v165
    v_sub_f32 v96, v96, v165
    v_sub_f32 v97, v97, v165
    v_sub_f32 v98, v98, v165
    v_sub_f32 v99, v99, v165
    v_sub_f32 v100, v100, v165
    v_sub_f32 v101, v101, v165
    v_sub_f32 v102, v102, v165
    v_sub_f32 v103, v103, v165
    v_sub_f32 v104, v104, v165
    v_sub_f32 v105, v105, v165
    v_sub_f32 v106, v106, v165
    v_sub_f32 v107, v107, v165
    v_sub_f32 v108, v108, v165
    v_sub_f32 v109, v109, v165
    v_sub_f32 v110, v110, v165
    v_sub_f32 v111, v111, v165
    v_sub_f32 v112, v112, v165
    v_sub_f32 v113, v113, v165
    v_sub_f32 v114, v114, v165
    v_sub_f32 v115, v115, v165
    v_sub_f32 v116, v116, v165
    v_sub_f32 v117, v117, v165
    v_sub_f32 v118, v118, v165
    v_sub_f32 v119, v119, v165
    v_sub_f32 v120, v120, v165
    v_sub_f32 v121, v121, v165
    v_sub_f32 v122, v122, v165
    v_sub_f32 v123, v123, v165
    v_sub_f32 v124, v124, v165
    v_sub_f32 v125, v125, v165
    v_sub_f32 v126, v126, v165
    v_sub_f32 v127, v127, v165
    v_mul_f32 v0, v0, v166
    v_mul_f32 v1, v1, v166
    v_mul_f32 v2, v2, v166
    v_mul_f32 v3, v3, v166
    v_mul_f32 v4, v4, v166
    v_mul_f32 v5, v5, v166
    v_mul_f32 v6, v6, v166
    v_mul_f32 v7, v7, v166
    v_mul_f32 v8, v8, v166
    v_mul_f32 v9, v9, v166
    v_mul_f32 v10, v10, v166
    v_mul_f32 v11, v11, v166
    v_mul_f32 v12, v12, v166
    v_mul_f32 v13, v13, v166
    v_mul_f32 v14, v14, v166
    v_mul_f32 v15, v15, v166
    v_mul_f32 v16, v16, v166
    v_mul_f32 v17, v17, v166
    v_mul_f32 v18, v18, v166
    v_mul_f32 v19, v19, v166
    v_mul_f32 v20, v20, v166
    v_mul_f32 v21, v21, v166
    v_mul_f32 v22, v22, v166
    v_mul_f32 v23, v23, v166
    v_mul_f32 v24, v24, v166
    v_mul_f32 v25, v25, v166
    v_mul_f32 v26, v26, v166
    v_mul_f32 v27, v27, v166
    v_mul_f32 v28, v28, v166
    v_mul_f32 v29, v29, v166
    v_mul_f32 v30, v30, v166
    v_mul_f32 v31, v31, v166
    v_mul_f32 v32, v32, v166
    v_mul_f32 v33, v33, v166
    v_mul_f32 v34, v34, v166
    v_mul_f32 v35, v35, v166
    v_mul_f32 v36, v36, v166
    v_mul_f32 v37, v37, v166
    v_mul_f32 v38, v38, v166
    v_mul_f32 v39, v39, v166
    v_mul_f32 v40, v40, v166
    v_mul_f32 v41, v41, v166
    v_mul_f32 v42, v42, v166
    v_mul_f32 v43, v43, v166
    v_mul_f32 v44, v44, v166
    v_mul_f32 v45, v45, v166
    v_mul_f32 v46, v46, v166
    v_mul_f32 v47, v47, v166
    v_mul_f32 v48, v48, v166
    v_mul_f32 v49, v49, v166
    v_mul_f32 v50, v50, v166
    v_mul_f32 v51, v51, v166
    v_mul_f32 v52, v52, v166
    v_mul_f32 v53, v53, v166
    v_mul_f32 v54, v54, v166
    v_mul_f32 v55, v55, v166
    v_mul_f32 v56, v56, v166
    v_mul_f32 v57, v57, v166
    v_mul_f32 v58, v58, v166
    v_mul_f32 v59, v59, v166
    v_mul_f32 v60, v60, v166
    v_mul_f32 v61, v61, v166
    v_mul_f32 v62, v62, v166
    v_mul_f32 v63, v63, v166
    v_mul_f32 v164, v164, v166
    s_nop 1
    s_branch L_back_6
L_rare_7:
    v_mov_b32 v166, v165
    s_nop 1
    v_permlane32_swap_b32 v165, v166
    s_nop 1
    v_max_f32 v165, v165, v166
    v_max_f32 v165, 0, v165
    v_exp_f32 v166, -v165
    v_sub_f32 v96, v96, v165
    v_sub_f32 v97, v97, v165
    v_sub_f32 v98, v98, v165
    v_sub_f32 v99, v99, v165
    v_sub_f32 v100, v100, v165
    v_sub_f32 v101, v101, v165
    v_sub_f32 v102, v102, v165
    v_sub_f32 v103, v103, v165
    v_sub_f32 v104, v104, v165
    v_sub_f32 v105, v105, v165
    v_sub_f32 v106, v106, v165
    v_sub_f32 v107, v107, v165
    v_sub_f32 v108, v108, v165
    v_sub_f32 v109, v109, v165
    v_sub_f32 v110, v110, v165
    v_sub_f32 v111, v111, v165
    v_sub_f32 v112, v112, v165
    v_sub_f32 v113, v113, v165
    v_sub_f32 v114, v114, v165
    v_sub_f32 v115, v115, v165
    v_sub_f32 v116, v116, v165
    v_sub_f32 v117, v117, v165
    v_sub_f32 v118, v118, v165
    v_sub_f32 v119, v119, v165
    v_sub_f32 v120, v120, v165
    v_sub_f32 v121, v121, v165
    v_sub_f32 v122, v122, v165
    v_sub_f32 v123, v123, v165
    v_sub_f32 v124, v124, v165
    v_sub_f32 v125, v125, v165
    v_sub_f32 v126, v126, v165
    v_sub_f32 v127, v127, v165
    v_mul_f32 v0, v0, v166
    v_mul_f32 v1, v1, v166
    v_mul_f32 v2, v2, v166
    v_mul_f32 v3, v3, v166
    v_mul_f32 v4, v4, v166
    v_mul_f32 v5, v5, v166
    v_mul_f32 v6, v6, v166
    v_mul_f32 v7, v7, v166
    v_mul_f32 v8, v8, v166
    v_mul_f32 v9, v9, v166
    v_mul_f32 v10, v10, v166
    v_mul_f32 v11, v11, v166
    v_mul_f32 v12, v12, v166
    v_mul_f32 v13, v13, v166
    v_mul_f32 v14, v14, v166
    v_mul_f32 v15, v15, v166
    v_mul_f32 v16, v16, v166
    v_mul_f32 v17, v17, v166
    v_mul_f32 v18, v18, v166
    v_mul_f32 v19, v19, v166
    v_mul_f32 v20, v20, v166
    v_mul_f32 v21, v21, v166
    v_mul_f32 v22, v22, v166
    v_mul_f32 v23, v23, v166
    v_mul_f32 v24, v24, v166
    v_mul_f32 v25, v25, v166
    v_mul_f32 v26, v26, v166
    v_mul_f32 v27, v27, v166
    v_mul_f32 v28, v28, v166
    v_mul_f32 v29, v29, v166
    v_mul_f32 v30, v30, v166
    v_mul_f32 v31, v31, v166
    v_mul_f32 v32, v32, v166
    v_mul_f32 v33, v33, v166
    v_mul_f32 v34, v34, v166
    v_mul_f32 v35, v35, v166
    v_mul_f32 v36, v36, v166
    v_mul_f32 v37, v37, v166
    v_mul_f32 v38, v38, v166
    v_mul_f32 v39, v39, v166
    v_mul_f32 v40, v40, v166
    v_mul_f32 v41, v41, v166
    v_mul_f32 v42, v42, v166
    v_mul_f32 v43, v43, v166
    v_mul_f32 v44, v44, v166
    v_mul_f32 v45, v45, v166
    v_mul_f32 v46, v46, v166
    v_mul_f32 v47, v47, v166
    v_mul_f32 v48, v48, v166
    v_mul_f32 v49, v49, v166
    v_mul_f32 v50, v50, v166
    v_mul_f32 v51, v51, v166
    v_mul_f32 v52, v52, v166
    v_mul_f32 v53, v53, v166
    v_mul_f32 v54, v54, v166
    v_mul_f32 v55, v55, v166
    v_mul_f32 v56, v56, v166
    v_mul_f32 v57, v57, v166
    v_mul_f32 v58, v58, v166
    v_mul_f32 v59, v59, v166
    v_mul_f32 v60, v60, v166
    v_mul_f32 v61, v61, v166
    v_mul_f32 v62, v62, v166
    v_mul_f32 v63, v63, v166
    v_mul_f32 v164, v164, v166
    s_nop 1
    s_branch L_back_7
L_rare_8:
    v_mov_b32 v166, v165
    s_nop 1
    v_permlane32_swap_b32 v165, v166
    s_nop 1
    v_max_f32 v165, v165, v166
    v_max_f32 v165, 0, v165
    v_exp_f32 v166, -v165
    v_sub_f32 v96, v96, v165
    v_sub_f32 v97, v97, v165
    v_sub_f32 v98, v98, v165
    v_sub_f32 v99, v99, v165
    v_sub_f32 v100, v100, v165
    v_sub_f32 v101, v101, v165
    v_sub_f32 v102, v102, v165
    v_sub_f32 v103, v103, v165
    v_sub_f32 v104, v104, v165
    v_sub_f32 v105, v105, v165
    v_sub_f32 v106, v106, v165
    v_sub_f32 v107, v107, v165
    v_sub_f32 v108, v108, v165
    v_sub_f32 v109, v109, v165
    v_sub_f32 v110, v110, v165
    v_sub_f32 v111, v111, v165
    v_sub_f32 v112, v112, v165
    v_sub_f32 v113, v113, v165
    v_sub_f32 v114, v114, v165
    v_sub_f32 v115, v115, v165
    v_sub_f32 v116, v116, v165
    v_sub_f32 v117, v117, v165
    v_sub_f32 v118, v118, v165
    v_sub_f32 v119, v119, v165
    v_sub_f32 v120, v120, v165
    v_sub_f32 v121, v121, v165
    v_sub_f32 v122, v122, v165
    v_sub_f32 v123, v123, v165
    v_sub_f32 v124, v124, v165
    v_sub_f32 v125, v125, v165
    v_sub_f32 v126, v126, v165
    v_sub_f32 v127, v127, v165
    v_mul_f32 v0, v0, v166
    v_mul_f32 v1, v1, v166
    v_mul_f32 v2, v2, v166
    v_mul_f32 v3, v3, v166
    v_mul_f32 v4, v4, v166
    v_mul_f32 v5, v5, v166
    v_mul_f32 v6, v6, v166
    v_mul_f32 v7, v7, v166
    v_mul_f32 v8, v8, v166
    v_mul_f32 v9, v9, v166
    v_mul_f32 v10, v10, v166
    v_mul_f32 v11, v11, v166
    v_mul_f32 v12, v12, v166
    v_mul_f32 v13, v13, v166
    v_mul_f32 v14, v14, v166
    v_mul_f32 v15, v15, v166
    v_mul_f32 v16, v16, v166
    v_mul_f32 v17, v17, v166
    v_mul_f32 v18, v18, v166
    v_mul_f32 v19, v19, v166
    v_mul_f32 v20, v20, v166
    v_mul_f32 v21, v21, v166
    v_mul_f32 v22, v22, v166
    v_mul_f32 v23, v23, v166
    v_mul_f32 v24, v24, v166
    v_mul_f32 v25, v25, v166
    v_mul_f32 v26, v26, v166
    v_mul_f32 v27, v27, v166
    v_mul_f32 v28, v28, v166
    v_mul_f32 v29, v29, v166
    v_mul_f32 v30, v30, v166
    v_mul_f32 v31, v31, v166
    v_mul_f32 v32, v32, v166
    v_mul_f32 v33, v33, v166
    v_mul_f32 v34, v34, v166
    v_mul_f32 v35, v35, v166
    v_mul_f32 v36, v36, v166
    v_mul_f32 v37, v37, v166
    v_mul_f32 v38, v38, v166
    v_mul_f32 v39, v39, v166
    v_mul_f32 v40, v40, v166
    v_mul_f32 v41, v41, v166
    v_mul_f32 v42, v42, v166
    v_mul_f32 v43, v43, v166
    v_mul_f32 v44, v44, v166
    v_mul_f32 v45, v45, v166
    v_mul_f32 v46, v46, v166
    v_mul_f32 v47, v47, v166
    v_mul_f32 v48, v48, v166
    v_mul_f32 v49, v49, v166
    v_mul_f32 v50, v50, v166
    v_mul_f32 v51, v51, v166
    v_mul_f32 v52, v52, v166
    v_mul_f32 v53, v53, v166
    v_mul_f32 v54, v54, v166
    v_mul_f32 v55, v55, v166
    v_mul_f32 v56, v56, v166
    v_mul_f32 v57, v57, v166
    v_mul_f32 v58, v58, v166
    v_mul_f32 v59, v59, v166
    v_mul_f32 v60, v60, v166
    v_mul_f32 v61, v61, v166
    v_mul_f32 v62, v62, v166
    v_mul_f32 v63, v63, v166
    v_mul_f32 v164, v164, v166
    s_nop 1
    s_branch L_back_8
L_rare_9:
    v_mov_b32 v166, v165
    s_nop 1
    v_permlane32_swap_b32 v165, v166
    s_nop 1
    v_max_f32 v165, v165, v166
    v_max_f32 v165, 0, v165
    v_exp_f32 v166, -v165
    v_sub_f32 v96, v96, v165
    v_sub_f32 v97, v97, v165
    v_sub_f32 v98, v98, v165
    v_sub_f32 v99, v99, v165
    v_sub_f32 v100, v100, v165
    v_sub_f32 v101, v101, v165
    v_sub_f32 v102, v102, v165
    v_sub_f32 v103, v103, v165
    v_sub_f32 v104, v104, v165
    v_sub_f32 v105, v105, v165
    v_sub_f32 v106, v106, v165
    v_sub_f32 v107, v107, v165
    v_sub_f32 v108, v108, v165
    v_sub_f32 v109, v109, v165
    v_sub_f32 v110, v110, v165
    v_sub_f32 v111, v111, v165
    v_sub_f32 v112, v112, v165
    v_sub_f32 v113, v113, v165
    v_sub_f32 v114, v114, v165
    v_sub_f32 v115, v115, v165
    v_sub_f32 v116, v116, v165
    v_sub_f32 v117, v117, v165
    v_sub_f32 v118, v118, v165
    v_sub_f32 v119, v119, v165
    v_sub_f32 v120, v120, v165
    v_sub_f32 v121, v121, v165
    v_sub_f32 v122, v122, v165
    v_sub_f32 v123, v123, v165
    v_sub_f32 v124, v124, v165
    v_sub_f32 v125, v125, v165
    v_sub_f32 v126, v126, v165
    v_sub_f32 v127, v127, v165
    v_mul_f32 v0, v0, v166
    v_mul_f32 v1, v1, v166
    v_mul_f32 v2, v2, v166
    v_mul_f32 v3, v3, v166
    v_mul_f32 v4, v4, v166
    v_mul_f32 v5, v5, v166
    v_mul_f32 v6, v6, v166
    v_mul_f32 v7, v7, v166
    v_mul_f32 v8, v8, v166
    v_mul_f32 v9, v9, v166
    v_mul_f32 v10, v10, v166
    v_mul_f32 v11, v11, v166
    v_mul_f32 v12, v12, v166
    v_mul_f32 v13, v13, v166
    v_mul_f32 v14, v14, v166
    v_mul_f32 v15, v15, v166
    v_mul_f32 v16, v16, v166
    v_mul_f32 v17, v17, v166
    v_mul_f32 v18, v18, v166
    v_mul_f32 v19, v19, v166
    v_mul_f32 v20, v20, v166
    v_mul_f32 v21, v21, v166
    v_mul_f32 v22, v22, v166
    v_mul_f32 v23, v23, v166
    v_mul_f32 v24, v24, v166
    v_mul_f32 v25, v25, v166
    v_mul_f32 v26, v26, v166
    v_mul_f32 v27, v27, v166
    v_mul_f32 v28, v28, v166
    v_mul_f32 v29, v29, v166
    v_mul_f32 v30, v30, v166
    v_mul_f32 v31, v31, v166
    v_mul_f32 v32, v32, v166
    v_mul_f32 v33, v33, v166
    v_mul_f32 v34, v34, v166
    v_mul_f32 v35, v35, v166
    v_mul_f32 v36, v36, v166
    v_mul_f32 v37, v37, v166
    v_mul_f32 v38, v38, v166
    v_mul_f32 v39, v39, v166
    v_mul_f32 v40, v40, v166
    v_mul_f32 v41, v41, v166
    v_mul_f32 v42, v42, v166
    v_mul_f32 v43, v43, v166
    v_mul_f32 v44, v44, v166
    v_mul_f32 v45, v45, v166
    v_mul_f32 v46, v46, v166
    v_mul_f32 v47, v47, v166
    v_mul_f32 v48, v48, v166
    v_mul_f32 v49, v49, v166
    v_mul_f32 v50, v50, v166
    v_mul_f32 v51, v51, v166
    v_mul_f32 v52, v52, v166
    v_mul_f32 v53, v53, v166
    v_mul_f32 v54, v54, v166
    v_mul_f32 v55, v55, v166
    v_mul_f32 v56, v56, v166
    v_mul_f32 v57, v57, v166
    v_mul_f32 v58, v58, v166
    v_mul_f32 v59, v59, v166
    v_mul_f32 v60, v60, v166
    v_mul_f32 v61, v61, v166
    v_mul_f32 v62, v62, v166
    v_mul_f32 v63, v63, v166
    v_mul_f32 v164, v164, v166
    s_nop 1
    s_branch L_back_9
L_rare_10:
    v_mov_b32 v166, v165
    s_nop 1
    v_permlane32_swap_b32 v165, v166
    s_nop 1
    v_max_f32 v165, v165, v166
    v_max_f32 v165, 0, v165
    v_exp_f32 v166, -v165
    v_sub_f32 v96, v96, v165
    v_sub_f32 v97, v97, v165
    v_sub_f32 v98, v98, v165
    v_sub_f32 v99, v99, v165
    v_sub_f32 v100, v100, v165
    v_sub_f32 v101, v101, v165
    v_sub_f32 v102, v102, v165
    v_sub_f32 v103, v103, v165
    v_sub_f32 v104, v104, v165
    v_sub_f32 v105, v105, v165
    v_sub_f32 v106, v106, v165
    v_sub_f32 v107, v107, v165
    v_sub_f32 v108, v108, v165
    v_sub_f32 v109, v109, v165
    v_sub_f32 v110, v110, v165
    v_sub_f32 v111, v111, v165
    v_sub_f32 v112, v112, v165
    v_sub_f32 v113, v113, v165
    v_sub_f32 v114, v114, v165
    v_sub_f32 v115, v115, v165
    v_sub_f32 v116, v116, v165
    v_sub_f32 v117, v117, v165
    v_sub_f32 v118, v118, v165
    v_sub_f32 v119, v119, v165
    v_sub_f32 v120, v120, v165
    v_sub_f32 v121, v121, v165
    v_sub_f32 v122, v122, v165
    v_sub_f32 v123, v123, v165
    v_sub_f32 v124, v124, v165
    v_sub_f32 v125, v125, v165
    v_sub_f32 v126, v126, v165
    v_sub_f32 v127, v127, v165
    v_mul_f32 v0, v0, v166
    v_mul_f32 v1, v1, v166
    v_mul_f32 v2, v2, v166
    v_mul_f32 v3, v3, v166
    v_mul_f32 v4, v4, v166
    v_mul_f32 v5, v5, v166
    v_mul_f32 v6, v6, v166
    v_mul_f32 v7, v7, v166
    v_mul_f32 v8, v8, v166
    v_mul_f32 v9, v9, v166
    v_mul_f32 v10, v10, v166
    v_mul_f32 v11, v11, v166
    v_mul_f32 v12, v12, v166
    v_mul_f32 v13, v13, v166
    v_mul_f32 v14, v14, v166
    v_mul_f32 v15, v15, v166
    v_mul_f32 v16, v16, v166
    v_mul_f32 v17, v17, v166
    v_mul_f32 v18, v18, v166
    v_mul_f32 v19, v19, v166
    v_mul_f32 v20, v20, v166
    v_mul_f32 v21, v21, v166
    v_mul_f32 v22, v22, v166
    v_mul_f32 v23, v23, v166
    v_mul_f32 v24, v24, v166
    v_mul_f32 v25, v25, v166
    v_mul_f32 v26, v26, v166
    v_mul_f32 v27, v27, v166
    v_mul_f32 v28, v28, v166
    v_mul_f32 v29, v29, v166
    v_mul_f32 v30, v30, v166
    v_mul_f32 v31, v31, v166
    v_mul_f32 v32, v32, v166
    v_mul_f32 v33, v33, v166
    v_mul_f32 v34, v34, v166
    v_mul_f32 v35, v35, v166
    v_mul_f32 v36, v36, v166
    v_mul_f32 v37, v37, v166
    v_mul_f32 v38, v38, v166
    v_mul_f32 v39, v39, v166
    v_mul_f32 v40, v40, v166
    v_mul_f32 v41, v41, v166
    v_mul_f32 v42, v42, v166
    v_mul_f32 v43, v43, v166
    v_mul_f32 v44, v44, v166
    v_mul_f32 v45, v45, v166
    v_mul_f32 v46, v46, v166
    v_mul_f32 v47, v47, v166
    v_mul_f32 v48, v48, v166
    v_mul_f32 v49, v49, v166
    v_mul_f32 v50, v50, v166
    v_mul_f32 v51, v51, v166
    v_mul_f32 v52, v52, v166
    v_mul_f32 v53, v53, v166
    v_mul_f32 v54, v54, v166
    v_mul_f32 v55, v55, v166
    v_mul_f32 v56, v56, v166
    v_mul_f32 v57, v57, v166
    v_mul_f32 v58, v58, v166
    v_mul_f32 v59, v59, v166
    v_mul_f32 v60, v60, v166
    v_mul_f32 v61, v61, v166
    v_mul_f32 v62, v62, v166
    v_mul_f32 v63, v63, v166
    v_mul_f32 v164, v164, v166
    s_nop 1
    s_branch L_back_10
L_rare_11:
    v_mov_b32 v166, v165
    s_nop 1
    v_permlane32_swap_b32 v165, v166
    s_nop 1
    v_max_f32 v165, v165, v166
    v_max_f32 v165, 0, v165
    v_exp_f32 v166, -v165
    v_sub_f32 v96, v96, v165
    v_sub_f32 v97, v97, v165
    v_sub_f32 v98, v98, v165
    v_sub_f32 v99, v99, v165
    v_sub_f32 v100, v100, v165
    v_sub_f32 v101, v101, v165
    v_sub_f32 v102, v102, v165
    v_sub_f32 v103, v103, v165
    v_sub_f32 v104, v104, v165
    v_sub_f32 v105, v105, v165
    v_sub_f32 v106, v106, v165
    v_sub_f32 v107, v107, v165
    v_sub_f32 v108, v108, v165
    v_sub_f32 v109, v109, v165
    v_sub_f32 v110, v110, v165
    v_sub_f32 v111, v111, v165
    v_sub_f32 v112, v112, v165
    v_sub_f32 v113, v113, v165
    v_sub_f32 v114, v114, v165
    v_sub_f32 v115, v115, v165
    v_sub_f32 v116, v116, v165
    v_sub_f32 v117, v117, v165
    v_sub_f32 v118, v118, v165
    v_sub_f32 v119, v119, v165
    v_sub_f32 v120, v120, v165
    v_sub_f32 v121, v121, v165
    v_sub_f32 v122, v122, v165
    v_sub_f32 v123, v123, v165
    v_sub_f32 v124, v124, v165
    v_sub_f32 v125, v125, v165
    v_sub_f32 v126, v126, v165
    v_sub_f32 v127, v127, v165
    v_mul_f32 v0, v0, v166
    v_mul_f32 v1, v1, v166
    v_mul_f32 v2, v2, v166
    v_mul_f32 v3, v3, v166
    v_mul_f32 v4, v4, v166
    v_mul_f32 v5, v5, v166
    v_mul_f32 v6, v6, v166
    v_mul_f32 v7, v7, v166
    v_mul_f32 v8, v8, v166
    v_mul_f32 v9, v9, v166
    v_mul_f32 v10, v10, v166
    v_mul_f32 v11, v11, v166
    v_mul_f32 v12, v12, v166
    v_mul_f32 v13, v13, v166
    v_mul_f32 v14, v14, v166
    v_mul_f32 v15, v15, v166
    v_mul_f32 v16, v16, v166
    v_mul_f32 v17, v17, v166
    v_mul_f32 v18, v18, v166
    v_mul_f32 v19, v19, v166
    v_mul_f32 v20, v20, v166
    v_mul_f32 v21, v21, v166
    v_mul_f32 v22, v22, v166
    v_mul_f32 v23, v23, v166
    v_mul_f32 v24, v24, v166
    v_mul_f32 v25, v25, v166
    v_mul_f32 v26, v26, v166
    v_mul_f32 v27, v27, v166
    v_mul_f32 v28, v28, v166
    v_mul_f32 v29, v29, v166
    v_mul_f32 v30, v30, v166
    v_mul_f32 v31, v31, v166
    v_mul_f32 v32, v32, v166
    v_mul_f32 v33, v33, v166
    v_mul_f32 v34, v34, v166
    v_mul_f32 v35, v35, v166
    v_mul_f32 v36, v36, v166
    v_mul_f32 v37, v37, v166
    v_mul_f32 v38, v38, v166
    v_mul_f32 v39, v39, v166
    v_mul_f32 v40, v40, v166
    v_mul_f32 v41, v41, v166
    v_mul_f32 v42, v42, v166
    v_mul_f32 v43, v43, v166
    v_mul_f32 v44, v44, v166
    v_mul_f32 v45, v45, v166
    v_mul_f32 v46, v46, v166
    v_mul_f32 v47, v47, v166
    v_mul_f32 v48, v48, v166
    v_mul_f32 v49, v49, v166
    v_mul_f32 v50, v50, v166
    v_mul_f32 v51, v51, v166
    v_mul_f32 v52, v52, v166
    v_mul_f32 v53, v53, v166
    v_mul_f32 v54, v54, v166
    v_mul_f32 v55, v55, v166
    v_mul_f32 v56, v56, v166
    v_mul_f32 v57, v57, v166
    v_mul_f32 v58, v58, v166
    v_mul_f32 v59, v59, v166
    v_mul_f32 v60, v60, v166
    v_mul_f32 v61, v61, v166
    v_mul_f32 v62, v62, v166
    v_mul_f32 v63, v63, v166
    v_mul_f32 v164, v164, v166
    s_nop 1
    s_branch L_back_11
L_rare_12:
    v_mov_b32 v166, v165
    s_nop 1
    v_permlane32_swap_b32 v165, v166
    s_nop 1
    v_max_f32 v165, v165, v166
    v_max_f32 v165, 0, v165
    v_exp_f32 v166, -v165
    v_sub_f32 v96, v96, v165
    v_sub_f32 v97, v97, v165
    v_sub_f32 v98, v98, v165
    v_sub_f32 v99, v99, v165
    v_sub_f32 v100, v100, v165
    v_sub_f32 v101, v101, v165
    v_sub_f32 v102, v102, v165
    v_sub_f32 v103, v103, v165
    v_sub_f32 v104, v104, v165
    v_sub_f32 v105, v105, v165
    v_sub_f32 v106, v106, v165
    v_sub_f32 v107, v107, v165
    v_sub_f32 v108, v108, v165
    v_sub_f32 v109, v109, v165
    v_sub_f32 v110, v110, v165
    v_sub_f32 v111, v111, v165
    v_sub_f32 v112, v112, v165
    v_sub_f32 v113, v113, v165
    v_sub_f32 v114, v114, v165
    v_sub_f32 v115, v115, v165
    v_sub_f32 v116, v116, v165
    v_sub_f32 v117, v117, v165
    v_sub_f32 v118, v118, v165
    v_sub_f32 v119, v119, v165
    v_sub_f32 v120, v120, v165
    v_sub_f32 v121, v121, v165
    v_sub_f32 v122, v122, v165
    v_sub_f32 v123, v123, v165
    v_sub_f32 v124, v124, v165
    v_sub_f32 v125, v125, v165
    v_sub_f32 v126, v126, v165
    v_sub_f32 v127, v127, v165
    v_mul_f32 v0, v0, v166
    v_mul_f32 v1, v1, v166
    v_mul_f32 v2, v2, v166
    v_mul_f32 v3, v3, v166
    v_mul_f32 v4, v4, v166
    v_mul_f32 v5, v5, v166
    v_mul_f32 v6, v6, v166
    v_mul_f32 v7, v7, v166
    v_mul_f32 v8, v8, v166
    v_mul_f32 v9, v9, v166
    v_mul_f32 v10, v10, v166
    v_mul_f32 v11, v11, v166
    v_mul_f32 v12, v12, v166
    v_mul_f32 v13, v13, v166
    v_mul_f32 v14, v14, v166
    v_mul_f32 v15, v15, v166
    v_mul_f32 v16, v16, v166
    v_mul_f32 v17, v17, v166
    v_mul_f32 v18, v18, v166
    v_mul_f32 v19, v19, v166
    v_mul_f32 v20, v20, v166
    v_mul_f32 v21, v21, v166
    v_mul_f32 v22, v22, v166
    v_mul_f32 v23, v23, v166
    v_mul_f32 v24, v24, v166
    v_mul_f32 v25, v25, v166
    v_mul_f32 v26, v26, v166
    v_mul_f32 v27, v27, v166
    v_mul_f32 v28, v28, v166
    v_mul_f32 v29, v29, v166
    v_mul_f32 v30, v30, v166
    v_mul_f32 v31, v31, v166
    v_mul_f32 v32, v32, v166
    v_mul_f32 v33, v33, v166
    v_mul_f32 v34, v34, v166
    v_mul_f32 v35, v35, v166
    v_mul_f32 v36, v36, v166
    v_mul_f32 v37, v37, v166
    v_mul_f32 v38, v38, v166
    v_mul_f32 v39, v39, v166
    v_mul_f32 v40, v40, v166
    v_mul_f32 v41, v41, v166
    v_mul_f32 v42, v42, v166
    v_mul_f32 v43, v43, v166
    v_mul_f32 v44, v44, v166
    v_mul_f32 v45, v45, v166
    v_mul_f32 v46, v46, v166
    v_mul_f32 v47, v47, v166
    v_mul_f32 v48, v48, v166
    v_mul_f32 v49, v49, v166
    v_mul_f32 v50, v50, v166
    v_mul_f32 v51, v51, v166
    v_mul_f32 v52, v52, v166
    v_mul_f32 v53, v53, v166
    v_mul_f32 v54, v54, v166
    v_mul_f32 v55, v55, v166
    v_mul_f32 v56, v56, v166
    v_mul_f32 v57, v57, v166
    v_mul_f32 v58, v58, v166
    v_mul_f32 v59, v59, v166
    v_mul_f32 v60, v60, v166
    v_mul_f32 v61, v61, v166
    v_mul_f32 v62, v62, v166
    v_mul_f32 v63, v63, v166
    v_mul_f32 v164, v164, v166
    s_nop 1
    s_branch L_back_12
L_rare_13:
    v_mov_b32 v166, v165
    s_nop 1
    v_permlane32_swap_b32 v165, v166
    s_nop 1
    v_max_f32 v165, v165, v166
    v_max_f32 v165, 0, v165
    v_exp_f32 v166, -v165
    v_sub_f32 v96, v96, v165
    v_sub_f32 v97, v97, v165
    v_sub_f32 v98, v98, v165
    v_sub_f32 v99, v99, v165
    v_sub_f32 v100, v100, v165
    v_sub_f32 v101, v101, v165
    v_sub_f32 v102, v102, v165
    v_sub_f32 v103, v103, v165
    v_sub_f32 v104, v104, v165
    v_sub_f32 v105, v105, v165
    v_sub_f32 v106, v106, v165
    v_sub_f32 v107, v107, v165
    v_sub_f32 v108, v108, v165
    v_sub_f32 v109, v109, v165
    v_sub_f32 v110, v110, v165
    v_sub_f32 v111, v111, v165
    v_sub_f32 v112, v112, v165
    v_sub_f32 v113, v113, v165
    v_sub_f32 v114, v114, v165
    v_sub_f32 v115, v115, v165
    v_sub_f32 v116, v116, v165
    v_sub_f32 v117, v117, v165
    v_sub_f32 v118, v118, v165
    v_sub_f32 v119, v119, v165
    v_sub_f32 v120, v120, v165
    v_sub_f32 v121, v121, v165
    v_sub_f32 v122, v122, v165
    v_sub_f32 v123, v123, v165
    v_sub_f32 v124, v124, v165
    v_sub_f32 v125, v125, v165
    v_sub_f32 v126, v126, v165
    v_sub_f32 v127, v127, v165
    v_mul_f32 v0, v0, v166
    v_mul_f32 v1, v1, v166
    v_mul_f32 v2, v2, v166
    v_mul_f32 v3, v3, v166
    v_mul_f32 v4, v4, v166
    v_mul_f32 v5, v5, v166
    v_mul_f32 v6, v6, v166
    v_mul_f32 v7, v7, v166
    v_mul_f32 v8, v8, v166
    v_mul_f32 v9, v9, v166
    v_mul_f32 v10, v10, v166
    v_mul_f32 v11, v11, v166
    v_mul_f32 v12, v12, v166
    v_mul_f32 v13, v13, v166
    v_mul_f32 v14, v14, v166
    v_mul_f32 v15, v15, v166
    v_mul_f32 v16, v16, v166
    v_mul_f32 v17, v17, v166
    v_mul_f32 v18, v18, v166
    v_mul_f32 v19, v19, v166
    v_mul_f32 v20, v20, v166
    v_mul_f32 v21, v21, v166
    v_mul_f32 v22, v22, v166
    v_mul_f32 v23, v23, v166
    v_mul_f32 v24, v24, v166
    v_mul_f32 v25, v25, v166
    v_mul_f32 v26, v26, v166
    v_mul_f32 v27, v27, v166
    v_mul_f32 v28, v28, v166
    v_mul_f32 v29, v29, v166
    v_mul_f32 v30, v30, v166
    v_mul_f32 v31, v31, v166
    v_mul_f32 v32, v32, v166
    v_mul_f32 v33, v33, v166
    v_mul_f32 v34, v34, v166
    v_mul_f32 v35, v35, v166
    v_mul_f32 v36, v36, v166
    v_mul_f32 v37, v37, v166
    v_mul_f32 v38, v38, v166
    v_mul_f32 v39, v39, v166
    v_mul_f32 v40, v40, v166
    v_mul_f32 v41, v41, v166
    v_mul_f32 v42, v42, v166
    v_mul_f32 v43, v43, v166
    v_mul_f32 v44, v44, v166
    v_mul_f32 v45, v45, v166
    v_mul_f32 v46, v46, v166
    v_mul_f32 v47, v47, v166
    v_mul_f32 v48, v48, v166
    v_mul_f32 v49, v49, v166
    v_mul_f32 v50, v50, v166
    v_mul_f32 v51, v51, v166
    v_mul_f32 v52, v52, v166
    v_mul_f32 v53, v53, v166
    v_mul_f32 v54, v54, v166
    v_mul_f32 v55, v55, v166
    v_mul_f32 v56, v56, v166
    v_mul_f32 v57, v57, v166
    v_mul_f32 v58, v58, v166
    v_mul_f32 v59, v59, v166
    v_mul_f32 v60, v60, v166
    v_mul_f32 v61, v61, v166
    v_mul_f32 v62, v62, v166
    v_mul_f32 v63, v63, v166
    v_mul_f32 v164, v164, v166
    s_nop 1
    s_branch L_back_13
L_rare_14:
    v_mov_b32 v166, v165
    s_nop 1
    v_permlane32_swap_b32 v165, v166
    s_nop 1
    v_max_f32 v165, v165, v166
    v_max_f32 v165, 0, v165
    v_exp_f32 v166, -v165
    v_sub_f32 v96, v96, v165
    v_sub_f32 v97, v97, v165
    v_sub_f32 v98, v98, v165
    v_sub_f32 v99, v99, v165
    v_sub_f32 v100, v100, v165
    v_sub_f32 v101, v101, v165
    v_sub_f32 v102, v102, v165
    v_sub_f32 v103, v103, v165
    v_sub_f32 v104, v104, v165
    v_sub_f32 v105, v105, v165
    v_sub_f32 v106, v106, v165
    v_sub_f32 v107, v107, v165
    v_sub_f32 v108, v108, v165
    v_sub_f32 v109, v109, v165
    v_sub_f32 v110, v110, v165
    v_sub_f32 v111, v111, v165
    v_sub_f32 v112, v112, v165
    v_sub_f32 v113, v113, v165
    v_sub_f32 v114, v114, v165
    v_sub_f32 v115, v115, v165
    v_sub_f32 v116, v116, v165
    v_sub_f32 v117, v117, v165
    v_sub_f32 v118, v118, v165
    v_sub_f32 v119, v119, v165
    v_sub_f32 v120, v120, v165
    v_sub_f32 v121, v121, v165
    v_sub_f32 v122, v122, v165
    v_sub_f32 v123, v123, v165
    v_sub_f32 v124, v124, v165
    v_sub_f32 v125, v125, v165
    v_sub_f32 v126, v126, v165
    v_sub_f32 v127, v127, v165
    v_mul_f32 v0, v0, v166
    v_mul_f32 v1, v1, v166
    v_mul_f32 v2, v2, v166
    v_mul_f32 v3, v3, v166
    v_mul_f32 v4, v4, v166
    v_mul_f32 v5, v5, v166
    v_mul_f32 v6, v6, v166
    v_mul_f32 v7, v7, v166
    v_mul_f32 v8, v8, v166
    v_mul_f32 v9, v9, v166
    v_mul_f32 v10, v10, v166
    v_mul_f32 v11, v11, v166
    v_mul_f32 v12, v12, v166
    v_mul_f32 v13, v13, v166
    v_mul_f32 v14, v14, v166
    v_mul_f32 v15, v15, v166
    v_mul_f32 v16, v16, v166
    v_mul_f32 v17, v17, v166
    v_mul_f32 v18, v18, v166
    v_mul_f32 v19, v19, v166
    v_mul_f32 v20, v20, v166
    v_mul_f32 v21, v21, v166
    v_mul_f32 v22, v22, v166
    v_mul_f32 v23, v23, v166
    v_mul_f32 v24, v24, v166
    v_mul_f32 v25, v25, v166
    v_mul_f32 v26, v26, v166
    v_mul_f32 v27, v27, v166
    v_mul_f32 v28, v28, v166
    v_mul_f32 v29, v29, v166
    v_mul_f32 v30, v30, v166
    v_mul_f32 v31, v31, v166
    v_mul_f32 v32, v32, v166
    v_mul_f32 v33, v33, v166
    v_mul_f32 v34, v34, v166
    v_mul_f32 v35, v35, v166
    v_mul_f32 v36, v36, v166
    v_mul_f32 v37, v37, v166
    v_mul_f32 v38, v38, v166
    v_mul_f32 v39, v39, v166
    v_mul_f32 v40, v40, v166
    v_mul_f32 v41, v41, v166
    v_mul_f32 v42, v42, v166
    v_mul_f32 v43, v43, v166
    v_mul_f32 v44, v44, v166
    v_mul_f32 v45, v45, v166
    v_mul_f32 v46, v46, v166
    v_mul_f32 v47, v47, v166
    v_mul_f32 v48, v48, v166
    v_mul_f32 v49, v49, v166
    v_mul_f32 v50, v50, v166
    v_mul_f32 v51, v51, v166
    v_mul_f32 v52, v52, v166
    v_mul_f32 v53, v53, v166
    v_mul_f32 v54, v54, v166
    v_mul_f32 v55, v55, v166
    v_mul_f32 v56, v56, v166
    v_mul_f32 v57, v57, v166
    v_mul_f32 v58, v58, v166
    v_mul_f32 v59, v59, v166
    v_mul_f32 v60, v60, v166
    v_mul_f32 v61, v61, v166
    v_mul_f32 v62, v62, v166
    v_mul_f32 v63, v63, v166
    v_mul_f32 v164, v164, v166
    s_nop 1
    s_branch L_back_14
L_rare_15:
    v_mov_b32 v166, v165
    s_nop 1
    v_permlane32_swap_b32 v165, v166
    s_nop 1
    v_max_f32 v165, v165, v166
    v_max_f32 v165, 0, v165
    v_exp_f32 v166, -v165
    v_sub_f32 v96, v96, v165
    v_sub_f32 v97, v97, v165
    v_sub_f32 v98, v98, v165
    v_sub_f32 v99, v99, v165
    v_sub_f32 v100, v100, v165
    v_sub_f32 v101, v101, v165
    v_sub_f32 v102, v102, v165
    v_sub_f32 v103, v103, v165
    v_sub_f32 v104, v104, v165
    v_sub_f32 v105, v105, v165
    v_sub_f32 v106, v106, v165
    v_sub_f32 v107, v107, v165
    v_sub_f32 v108, v108, v165
    v_sub_f32 v109, v109, v165
    v_sub_f32 v110, v110, v165
    v_sub_f32 v111, v111, v165
    v_sub_f32 v112, v112, v165
    v_sub_f32 v113, v113, v165
    v_sub_f32 v114, v114, v165
    v_sub_f32 v115, v115, v165
    v_sub_f32 v116, v116, v165
    v_sub_f32 v117, v117, v165
    v_sub_f32 v118, v118, v165
    v_sub_f32 v119, v119, v165
    v_sub_f32 v120, v120, v165
    v_sub_f32 v121, v121, v165
    v_sub_f32 v122, v122, v165
    v_sub_f32 v123, v123, v165
    v_sub_f32 v124, v124, v165
    v_sub_f32 v125, v125, v165
    v_sub_f32 v126, v126, v165
    v_sub_f32 v127, v127, v165
    v_mul_f32 v0, v0, v166
    v_mul_f32 v1, v1, v166
    v_mul_f32 v2, v2, v166
    v_mul_f32 v3, v3, v166
    v_mul_f32 v4, v4, v166
    v_mul_f32 v5, v5, v166
    v_mul_f32 v6, v6, v166
    v_mul_f32 v7, v7, v166
    v_mul_f32 v8, v8, v166
    v_mul_f32 v9, v9, v166
    v_mul_f32 v10, v10, v166
    v_mul_f32 v11, v11, v166
    v_mul_f32 v12, v12, v166
    v_mul_f32 v13, v13, v166
    v_mul_f32 v14, v14, v166
    v_mul_f32 v15, v15, v166
    v_mul_f32 v16, v16, v166
    v_mul_f32 v17, v17, v166
    v_mul_f32 v18, v18, v166
    v_mul_f32 v19, v19, v166
    v_mul_f32 v20, v20, v166
    v_mul_f32 v21, v21, v166
    v_mul_f32 v22, v22, v166
    v_mul_f32 v23, v23, v166
    v_mul_f32 v24, v24, v166
    v_mul_f32 v25, v25, v166
    v_mul_f32 v26, v26, v166
    v_mul_f32 v27, v27, v166
    v_mul_f32 v28, v28, v166
    v_mul_f32 v29, v29, v166
    v_mul_f32 v30, v30, v166
    v_mul_f32 v31, v31, v166
    v_mul_f32 v32, v32, v166
    v_mul_f32 v33, v33, v166
    v_mul_f32 v34, v34, v166
    v_mul_f32 v35, v35, v166
    v_mul_f32 v36, v36, v166
    v_mul_f32 v37, v37, v166
    v_mul_f32 v38, v38, v166
    v_mul_f32 v39, v39, v166
    v_mul_f32 v40, v40, v166
    v_mul_f32 v41, v41, v166
    v_mul_f32 v42, v42, v166
    v_mul_f32 v43, v43, v166
    v_mul_f32 v44, v44, v166
    v_mul_f32 v45, v45, v166
    v_mul_f32 v46, v46, v166
    v_mul_f32 v47, v47, v166
    v_mul_f32 v48, v48, v166
    v_mul_f32 v49, v49, v166
    v_mul_f32 v50, v50, v166
    v_mul_f32 v51, v51, v166
    v_mul_f32 v52, v52, v166
    v_mul_f32 v53, v53, v166
    v_mul_f32 v54, v54, v166
    v_mul_f32 v55, v55, v166
    v_mul_f32 v56, v56, v166
    v_mul_f32 v57, v57, v166
    v_mul_f32 v58, v58, v166
    v_mul_f32 v59, v59, v166
    v_mul_f32 v60, v60, v166
    v_mul_f32 v61, v61, v166
    v_mul_f32 v62, v62, v166
    v_mul_f32 v63, v63, v166
    v_mul_f32 v164, v164, v166
    s_nop 1
    s_branch L_back_15
.globl oproj_kernel
.p2align 8
.type oproj_kernel,@function
oproj_kernel:
    s_cmp_ge_u32 s2, 256
    s_cbranch_scc1 L_k2_end
    s_load_dwordx2 s[8:9], s[0:1], 80
    s_load_dwordx2 s[10:11], s[0:1], 96
    s_and_b32 s3, s2, 7
    s_lshr_b32 s4, s2, 3
    s_and_b32 s5, s4, 7
    s_lshr_b32 s4, s4, 3
    s_lshl_b32 s3, s3, 2
    s_add_u32 s4, s4, s3
    s_lshr_b32 s3, s4, 4
    s_and_b32 s4, s4, 15
    v_lshrrev_b32 v1, 6, v0
    v_and_b32 v0, 63, v0
    s_nop 0
    v_readfirstlane_b32 s6, v1
    s_waitcnt lgkmcnt(0)
    s_mov_b32 s12, s8
    s_and_b32 s13, s9, 0xffff
    s_mov_b32 s14, 0x3c0000
    s_mov_b32 s15, 0x00020000
    s_mov_b32 s16, s10
    s_and_b32 s17, s11, 0xffff
    s_mov_b32 s18, 0x10000000
    s_mov_b32 s19, 0x00020000
    v_lshlrev_b32 v1, 4, v0
    s_lshl_b32 s20, s3, 4
    s_add_u32 s20, s20, s4
    s_lshl_b32 s20, s20, 7
    s_lshl_b32 s21, s6, 5
    s_add_u32 s20, s20, s21
    s_mul_i32 s24, s20, 6144
    s_add_u32 s25, s24, 4096
    s_lshl_b32 s22, s3, 3
    s_add_u32 s22, s22, s5
    s_lshl_b32 s22, s22, 7
    s_add_u32 s22, s22, s21
    s_mul_i32 s26, s22, 5120
    s_add_u32 s26, s26, 0x1800000
    s_add_u32 s27, s26, 4096
    buffer_load_dwordx4 v[8:11], v1, s[16:19], s24 offen offset:0
    buffer_load_dwordx4 v[12:15], v1, s[16:19], s24 offen offset:1024
    buffer_load_dwordx4 v[16:19], v1, s[16:19], s24 offen offset:2048
    buffer_load_dwordx4 v[20:23], v1, s[16:19], s24 offen offset:3072
    buffer_load_dwordx4 v[24:27], v1, s[16:19], s25 offen offset:0
    buffer_load_dwordx4 v[28:31], v1, s[16:19], s25 offen offset:1024
    buffer_load_dwordx4 v[32:35], v1, s[16:19], s26 offen offset:0
    buffer_load_dwordx4 v[36:39], v1, s[16:19], s26 offen offset:1024
    buffer_load_dwordx4 v[40:43], v1, s[16:19], s26 offen offset:2048
    buffer_load_dwordx4 v[44:47], v1, s[16:19], s26 offen offset:3072
    buffer_load_dwordx4 v[48:51], v1, s[16:19], s27 offen offset:0
    s_add_u32 s24, s24, 6144
    s_add_u32 s25, s25, 6144
    s_add_u32 s26, s26, 5120
    s_add_u32 s27, s27, 5120
    buffer_load_dwordx4 v[52:55], v1, s[16:19], s24 offen offset:0
    buffer_load_dwordx4 v[56:59], v1, s[16:19], s24 offen offset:1024
    buffer_load_dwordx4 v[60:63], v1, s[16:19], s24 offen offset:2048
    buffer_load_dwordx4 v[64:67], v1, s[16:19], s24 offen offset:3072
    buffer_load_dwordx4 v[68:71], v1, s[16:19], s25 offen offset:0
    buffer_load_dwordx4 v[72:75], v1, s[16:19], s25 offen offset:1024
    buffer_load_dwordx4 v[76:79], v1, s[16:19], s26 offen offset:0
    buffer_load_dwordx4 v[80:83], v1, s[16:19], s26 offen offset:1024
    buffer_load_dwordx4 v[84:87], v1, s[16:19], s26 offen offset:2048
    buffer_load_dwordx4 v[88:91], v1, s[16:19], s26 offen offset:3072
    buffer_load_dwordx4 v[92:95], v1, s[16:19], s27 offen offset:0
    s_add_u32 s24, s24, 6144
    s_add_u32 s25, s25, 6144
    s_add_u32 s26, s26, 5120
    s_add_u32 s27, s27, 5120
    buffer_load_dwordx4 v[96:99], v1, s[16:19], s24 offen offset:0
    buffer_load_dwordx4 v[100:103], v1, s[16:19], s24 offen offset:1024
    buffer_load_dwordx4 v[104:107], v1, s[16:19], s24 offen offset:2048
    buffer_load_dwordx4 v[108:111], v1, s[16:19], s24 offen offset:3072
    buffer_load_dwordx4 v[112:115], v1, s[16:19], s25 offen offset:0
    buffer_load_dwordx4 v[116:119], v1, s[16:19], s25 offen offset:1024
    buffer_load_dwordx4 v[120:123], v1, s[16:19], s26 offen offset:0
    buffer_load_dwordx4 v[124:127], v1, s[16:19], s26 offen offset:1024
    buffer_load_dwordx4 v[128:131], v1, s[16:19], s26 offen offset:2048
    buffer_load_dwordx4 v[132:135], v1, s[16:19], s26 offen offset:3072
    buffer_load_dwordx4 v[136:139], v1, s[16:19], s27 offen offset:0
    s_add_u32 s24, s24, 6144
    s_add_u32 s25, s25, 6144
    s_add_u32 s26, s26, 5120
    s_add_u32 s27, s27, 5120
    buffer_load_dwordx4 v[140:143], v1, s[16:19], s24 offen offset:0
    buffer_load_dwordx4 v[144:147], v1, s[16:19], s24 offen offset:1024
    buffer_load_dwordx4 v[148:151], v1, s[16:19], s24 offen offset:2048
    buffer_load_dwordx4 v[152:155], v1, s[16:19], s24 offen offset:3072
    buffer_load_dwordx4 v[156:159], v1, s[16:19], s25 offen offset:0
    buffer_load_dwordx4 v[160:163], v1, s[16:19], s25 offen offset:1024
    buffer_load_dwordx4 v[164:167], v1, s[16:19], s26 offen offset:0
    buffer_load_dwordx4 v[168:171], v1, s[16:19], s26 offen offset:1024
    buffer_load_dwordx4 v[172:175], v1, s[16:19], s26 offen offset:2048
    buffer_load_dwordx4 v[176:179], v1, s[16:19], s26 offen offset:3072
    buffer_load_dwordx4 v[180:183], v1, s[16:19], s27 offen offset:0
    s_add_u32 s24, s24, 6144
    s_add_u32 s25, s25, 6144
    s_add_u32 s26, s26, 5120
    s_add_u32 s27, s27, 5120
    s_waitcnt vmcnt(33)
    v_mfma_f32_16x16x32_bf16 a[0:3], v[32:35], v[8:11], 0
    v_mfma_f32_16x16x32_bf16 a[4:7], v[32:35], v[12:15], 0
    buffer_load_dwordx4 v[184:187], v1, s[16:19], s24 offen offset:0
    v_mfma_f32_16x16x32_bf16 a[8:11], v[32:35], v[16:19], 0
    buffer_load_dwordx4 v[188:191], v1, s[16:19], s24 offen offset:1024
    v_mfma_f32_16x16x32_bf16 a[12:15], v[32:35], v[20:23], 0
    buffer_load_dwordx4 v[192:195], v1, s[16:19], s24 offen offset:2048
    v_mfma_f32_16x16x32_bf16 a[16:19], v[32:35], v[24:27], 0
    buffer_load_dwordx4 v[196:199], v1, s[16:19], s24 offen offset:3072
    v_mfma_f32_16x16x32_bf16 a[20:23], v[32:35], v[28:31], 0
    buffer_load_dwordx4 v[200:203], v1, s[16:19], s25 offen offset:0
    v_mfma_f32_16x16x32_bf16 a[24:27], v[36:39], v[8:11], 0
    buffer_load_dwordx4 v[204:207], v1, s[16:19], s25 offen offset:1024
    v_mfma_f32_16x16x32_bf16 a[28:31], v[36:39], v[12:15], 0
    buffer_load_dwordx4 v[208:211], v1, s[16:19], s26 offen offset:0
    v_mfma_f32_16x16x32_bf16 a[32:35], v[36:39], v[16:19], 0
    buffer_load_dwordx4 v[212:215], v1, s[16:19], s26 offen offset:1024
    v_mfma_f32_16x16x32_bf16 a[36:39], v[36:39], v[20:23], 0
    buffer_load_dwordx4 v[216:219], v1, s[16:19], s26 offen offset:2048
    v_mfma_f32_16x16x32_bf16 a[40:43], v[36:39], v[24:27], 0
    buffer_load_dwordx4 v[220:223], v1, s[16:19], s26 offen offset:3072
    v_mfma_f32_16x16x32_bf16 a[44:47], v[36:39], v[28:31], 0
    buffer_load_dwordx4 v[224:227], v1, s[16:19], s27 offen offset:0
    v_mfma_f32_16x16x32_bf16 a[48:51], v[40:43], v[8:11], 0
    s_add_u32 s24, s24, 6144
    v_mfma_f32_16x16x32_bf16 a[52:55], v[40:43], v[12:15], 0
    s_add_u32 s25, s25, 6144
    v_mfma_f32_16x16x32_bf16 a[56:59], v[40:43], v[16:19], 0
    s_add_u32 s26, s26, 5120
    v_mfma_f32_16x16x32_bf16 a[60:63], v[40:43], v[20:23], 0
    s_add_u32 s27, s27, 5120
    v_mfma_f32_16x16x32_bf16 a[64:67], v[40:43], v[24:27], 0
    v_mfma_f32_16x16x32_bf16 a[68:71], v[40:43], v[28:31], 0
    v_mfma_f32_16x16x32_bf16 a[72:75], v[44:47], v[8:11], 0
    v_mfma_f32_16x16x32_bf16 a[76:79], v[44:47], v[12:15], 0
    v_mfma_f32_16x16x32_bf16 a[80:83], v[44:47], v[16:19], 0
    v_mfma_f32_16x16x32_bf16 a[84:87], v[44:47], v[20:23], 0
    v_mfma_f32_16x16x32_bf16 a[88:91], v[44:47], v[24:27], 0
    v_mfma_f32_16x16x32_bf16 a[92:95], v[44:47], v[28:31], 0
    v_mfma_f32_16x16x32_bf16 a[96:99], v[48:51], v[8:11], 0
    v_mfma_f32_16x16x32_bf16 a[100:103], v[48:51], v[12:15], 0
    v_mfma_f32_16x16x32_bf16 a[104:107], v[48:51], v[16:19], 0
    v_mfma_f32_16x16x32_bf16 a[108:111], v[48:51], v[20:23], 0
    v_mfma_f32_16x16x32_bf16 a[112:115], v[48:51], v[24:27], 0
    v_mfma_f32_16x16x32_bf16 a[116:119], v[48:51], v[28:31], 0
    s_waitcnt vmcnt(33)
    v_mfma_f32_16x16x32_bf16 a[0:3], v[76:79], v[52:55], a[0:3]
    v_mfma_f32_16x16x32_bf16 a[4:7], v[76:79], v[56:59], a[4:7]
    buffer_load_dwordx4 v[8:11], v1, s[16:19], s24 offen offset:0
    v_mfma_f32_16x16x32_bf16 a[8:11], v[76:79], v[60:63], a[8:11]
    buffer_load_dwordx4 v[12:15], v1, s[16:19], s24 offen offset:1024
    v_mfma_f32_16x16x32_bf16 a[12:15], v[76:79], v[64:67], a[12:15]
    buffer_load_dwordx4 v[16:19], v1, s[16:19], s24 offen offset:2048
    v_mfma_f32_16x16x32_bf16 a[16:19], v[76:79], v[68:71], a[16:19]
    buffer_load_dwordx4 v[20:23], v1, s[16:19], s24 offen offset:3072
    v_mfma_f32_16x16x32_bf16 a[20:23], v[76:79], v[72:75], a[20:23]
    buffer_load_dwordx4 v[24:27], v1, s[16:19], s25 offen offset:0
    v_mfma_f32_16x16x32_bf16 a[24:27], v[80:83], v[52:55], a[24:27]
    buffer_load_dwordx4 v[28:31], v1, s[16:19], s25 offen offset:1024
    v_mfma_f32_16x16x32_bf16 a[28:31], v[80:83], v[56:59], a[28:31]
    buffer_load_dwordx4 v[32:35], v1, s[16:19], s26 offen offset:0
    v_mfma_f32_16x16x32_bf16 a[32:35], v[80:83], v[60:63], a[32:35]
    buffer_load_dwordx4 v[36:39], v1, s[16:19], s26 offen offset:1024
    v_mfma_f32_16x16x32_bf16 a[36:39], v[80:83], v[64:67], a[36:39]
    buffer_load_dwordx4 v[40:43], v1, s[16:19], s26 offen offset:2048
    v_mfma_f32_16x16x32_bf16 a[40:43], v[80:83], v[68:71], a[40:43]
    buffer_load_dwordx4 v[44:47], v1, s[16:19], s26 offen offset:3072
    v_mfma_f32_16x16x32_bf16 a[44:47], v[80:83], v[72:75], a[44:47]
    buffer_load_dwordx4 v[48:51], v1, s[16:19], s27 offen offset:0
    v_mfma_f32_16x16x32_bf16 a[48:51], v[84:87], v[52:55], a[48:51]
    s_add_u32 s24, s24, 6144
    v_mfma_f32_16x16x32_bf16 a[52:55], v[84:87], v[56:59], a[52:55]
    s_add_u32 s25, s25, 6144
    v_mfma_f32_16x16x32_bf16 a[56:59], v[84:87], v[60:63], a[56:59]
    s_add_u32 s26, s26, 5120
    v_mfma_f32_16x16x32_bf16 a[60:63], v[84:87], v[64:67], a[60:63]
    s_add_u32 s27, s27, 5120
    v_mfma_f32_16x16x32_bf16 a[64:67], v[84:87], v[68:71], a[64:67]
    v_mfma_f32_16x16x32_bf16 a[68:71], v[84:87], v[72:75], a[68:71]
    v_mfma_f32_16x16x32_bf16 a[72:75], v[88:91], v[52:55], a[72:75]
    v_mfma_f32_16x16x32_bf16 a[76:79], v[88:91], v[56:59], a[76:79]
    v_mfma_f32_16x16x32_bf16 a[80:83], v[88:91], v[60:63], a[80:83]
    v_mfma_f32_16x16x32_bf16 a[84:87], v[88:91], v[64:67], a[84:87]
    v_mfma_f32_16x16x32_bf16 a[88:91], v[88:91], v[68:71], a[88:91]
    v_mfma_f32_16x16x32_bf16 a[92:95], v[88:91], v[72:75], a[92:95]
    v_mfma_f32_16x16x32_bf16 a[96:99], v[92:95], v[52:55], a[96:99]
    v_mfma_f32_16x16x32_bf16 a[100:103], v[92:95], v[56:59], a[100:103]
    v_mfma_f32_16x16x32_bf16 a[104:107], v[92:95], v[60:63], a[104:107]
    v_mfma_f32_16x16x32_bf16 a[108:111], v[92:95], v[64:67], a[108:111]
    v_mfma_f32_16x16x32_bf16 a[112:115], v[92:95], v[68:71], a[112:115]
    v_mfma_f32_16x16x32_bf16 a[116:119], v[92:95], v[72:75], a[116:119]
    s_waitcnt vmcnt(33)
    v_mfma_f32_16x16x32_bf16 a[0:3], v[120:123], v[96:99], a[0:3]
    v_mfma_f32_16x16x32_bf16 a[4:7], v[120:123], v[100:103], a[4:7]
    buffer_load_dwordx4 v[52:55], v1, s[16:19], s24 offen offset:0
    v_mfma_f32_16x16x32_bf16 a[8:11], v[120:123], v[104:107], a[8:11]
    buffer_load_dwordx4 v[56:59], v1, s[16:19], s24 offen offset:1024
    v_mfma_f32_16x16x32_bf16 a[12:15], v[120:123], v[108:111], a[12:15]
    buffer_load_dwordx4 v[60:63], v1, s[16:19], s24 offen offset:2048
    v_mfma_f32_16x16x32_bf16 a[16:19], v[120:123], v[112:115], a[16:19]
    buffer_load_dwordx4 v[64:67], v1, s[16:19], s24 offen offset:3072
    v_mfma_f32_16x16x32_bf16 a[20:23], v[120:123], v[116:119], a[20:23]
    buffer_load_dwordx4 v[68:71], v1, s[16:19], s25 offen offset:0
    v_mfma_f32_16x16x32_bf16 a[24:27], v[124:127], v[96:99], a[24:27]
    buffer_load_dwordx4 v[72:75], v1, s[16:19], s25 offen offset:1024
    v_mfma_f32_16x16x32_bf16 a[28:31], v[124:127], v[100:103], a[28:31]
    buffer_load_dwordx4 v[76:79], v1, s[16:19], s26 offen offset:0
    v_mfma_f32_16x16x32_bf16 a[32:35], v[124:127], v[104:107], a[32:35]
    buffer_load_dwordx4 v[80:83], v1, s[16:19], s26 offen offset:1024
    v_mfma_f32_16x16x32_bf16 a[36:39], v[124:127], v[108:111], a[36:39]
    buffer_load_dwordx4 v[84:87], v1, s[16:19], s26 offen offset:2048
    v_mfma_f32_16x16x32_bf16 a[40:43], v[124:127], v[112:115], a[40:43]
    buffer_load_dwordx4 v[88:91], v1, s[16:19], s26 offen offset:3072
    v_mfma_f32_16x16x32_bf16 a[44:47], v[124:127], v[116:119], a[44:47]
    buffer_load_dwordx4 v[92:95], v1, s[16:19], s27 offen offset:0
    v_mfma_f32_16x16x32_bf16 a[48:51], v[128:131], v[96:99], a[48:51]
    s_add_u32 s24, s24, 6144
    v_mfma_f32_16x16x32_bf16 a[52:55], v[128:131], v[100:103], a[52:55]
    s_add_u32 s25, s25, 6144
    v_mfma_f32_16x16x32_bf16 a[56:59], v[128:131], v[104:107], a[56:59]
    s_add_u32 s26, s26, 5120
    v_mfma_f32_16x16x32_bf16 a[60:63], v[128:131], v[108:111], a[60:63]
    s_add_u32 s27, s27, 5120
    v_mfma_f32_16x16x32_bf16 a[64:67], v[128:131], v[112:115], a[64:67]
    v_mfma_f32_16x16x32_bf16 a[68:71], v[128:131], v[116:119], a[68:71]
    v_mfma_f32_16x16x32_bf16 a[72:75], v[132:135], v[96:99], a[72:75]
    v_mfma_f32_16x16x32_bf16 a[76:79], v[132:135], v[100:103], a[76:79]
    v_mfma_f32_16x16x32_bf16 a[80:83], v[132:135], v[104:107], a[80:83]
    v_mfma_f32_16x16x32_bf16 a[84:87], v[132:135], v[108:111], a[84:87]
    v_mfma_f32_16x16x32_bf16 a[88:91], v[132:135], v[112:115], a[88:91]
    v_mfma_f32_16x16x32_bf16 a[92:95], v[132:135], v[116:119], a[92:95]
    v_mfma_f32_16x16x32_bf16 a[96:99], v[136:139], v[96:99], a[96:99]
    v_mfma_f32_16x16x32_bf16 a[100:103], v[136:139], v[100:103], a[100:103]
    v_mfma_f32_16x16x32_bf16 a[104:107], v[136:139], v[104:107], a[104:107]
    v_mfma_f32_16x16x32_bf16 a[108:111], v[136:139], v[108:111], a[108:111]
    v_mfma_f32_16x16x32_bf16 a[112:115], v[136:139], v[112:115], a[112:115]
    v_mfma_f32_16x16x32_bf16 a[116:119], v[136:139], v[116:119], a[116:119]
    s_waitcnt vmcnt(33)
    v_mfma_f32_16x16x32_bf16 a[0:3], v[164:167], v[140:143], a[0:3]
    v_mfma_f32_16x16x32_bf16 a[4:7], v[164:167], v[144:147], a[4:7]
    buffer_load_dwordx4 v[96:99], v1, s[16:19], s24 offen offset:0
    v_mfma_f32_16x16x32_bf16 a[8:11], v[164:167], v[148:151], a[8:11]
    buffer_load_dwordx4 v[100:103], v1, s[16:19], s24 offen offset:1024
    v_mfma_f32_16x16x32_bf16 a[12:15], v[164:167], v[152:155], a[12:15]
    buffer_load_dwordx4 v[104:107], v1, s[16:19], s24 offen offset:2048
    v_mfma_f32_16x16x32_bf16 a[16:19], v[164:167], v[156:159], a[16:19]
    buffer_load_dwordx4 v[108:111], v1, s[16:19], s24 offen offset:3072
    v_mfma_f32_16x16x32_bf16 a[20:23], v[164:167], v[160:163], a[20:23]
    buffer_load_dwordx4 v[112:115], v1, s[16:19], s25 offen offset:0
    v_mfma_f32_16x16x32_bf16 a[24:27], v[168:171], v[140:143], a[24:27]
    buffer_load_dwordx4 v[116:119], v1, s[16:19], s25 offen offset:1024
    v_mfma_f32_16x16x32_bf16 a[28:31], v[168:171], v[144:147], a[28:31]
    buffer_load_dwordx4 v[120:123], v1, s[16:19], s26 offen offset:0
    v_mfma_f32_16x16x32_bf16 a[32:35], v[168:171], v[148:151], a[32:35]
    buffer_load_dwordx4 v[124:127], v1, s[16:19], s26 offen offset:1024
    v_mfma_f32_16x16x32_bf16 a[36:39], v[168:171], v[152:155], a[36:39]
    buffer_load_dwordx4 v[128:131], v1, s[16:19], s26 offen offset:2048
    v_mfma_f32_16x16x32_bf16 a[40:43], v[168:171], v[156:159], a[40:43]
    buffer_load_dwordx4 v[132:135], v1, s[16:19], s26 offen offset:3072
    v_mfma_f32_16x16x32_bf16 a[44:47], v[168:171], v[160:163], a[44:47]
    buffer_load_dwordx4 v[136:139], v1, s[16:19], s27 offen offset:0
    v_mfma_f32_16x16x32_bf16 a[48:51], v[172:175], v[140:143], a[48:51]
    s_add_u32 s24, s24, 6144
    v_mfma_f32_16x16x32_bf16 a[52:55], v[172:175], v[144:147], a[52:55]
    s_add_u32 s25, s25, 6144
    v_mfma_f32_16x16x32_bf16 a[56:59], v[172:175], v[148:151], a[56:59]
    s_add_u32 s26, s26, 5120
    v_mfma_f32_16x16x32_bf16 a[60:63], v[172:175], v[152:155], a[60:63]
    s_add_u32 s27, s27, 5120
    v_mfma_f32_16x16x32_bf16 a[64:67], v[172:175], v[156:159], a[64:67]
    v_mfma_f32_16x16x32_bf16 a[68:71], v[172:175], v[160:163], a[68:71]
    v_mfma_f32_16x16x32_bf16 a[72:75], v[176:179], v[140:143], a[72:75]
    v_mfma_f32_16x16x32_bf16 a[76:79], v[176:179], v[144:147], a[76:79]
    v_mfma_f32_16x16x32_bf16 a[80:83], v[176:179], v[148:151], a[80:83]
    v_mfma_f32_16x16x32_bf16 a[84:87], v[176:179], v[152:155], a[84:87]
    v_mfma_f32_16x16x32_bf16 a[88:91], v[176:179], v[156:159], a[88:91]
    v_mfma_f32_16x16x32_bf16 a[92:95], v[176:179], v[160:163], a[92:95]
    v_mfma_f32_16x16x32_bf16 a[96:99], v[180:183], v[140:143], a[96:99]
    v_mfma_f32_16x16x32_bf16 a[100:103], v[180:183], v[144:147], a[100:103]
    v_mfma_f32_16x16x32_bf16 a[104:107], v[180:183], v[148:151], a[104:107]
    v_mfma_f32_16x16x32_bf16 a[108:111], v[180:183], v[152:155], a[108:111]
    v_mfma_f32_16x16x32_bf16 a[112:115], v[180:183], v[156:159], a[112:115]
    v_mfma_f32_16x16x32_bf16 a[116:119], v[180:183], v[160:163], a[116:119]
    s_waitcnt vmcnt(33)
    v_mfma_f32_16x16x32_bf16 a[0:3], v[208:211], v[184:187], a[0:3]
    v_mfma_f32_16x16x32_bf16 a[4:7], v[208:211], v[188:191], a[4:7]
    buffer_load_dwordx4 v[140:143], v1, s[16:19], s24 offen offset:0
    v_mfma_f32_16x16x32_bf16 a[8:11], v[208:211], v[192:195], a[8:11]
    buffer_load_dwordx4 v[144:147], v1, s[16:19], s24 offen offset:1024
    v_mfma_f32_16x16x32_bf16 a[12:15], v[208:211], v[196:199], a[12:15]
    buffer_load_dwordx4 v[148:151], v1, s[16:19], s24 offen offset:2048
    v_mfma_f32_16x16x32_bf16 a[16:19], v[208:211], v[200:203], a[16:19]
    buffer_load_dwordx4 v[152:155], v1, s[16:19], s24 offen offset:3072
    v_mfma_f32_16x16x32_bf16 a[20:23], v[208:211], v[204:207], a[20:23]
    buffer_load_dwordx4 v[156:159], v1, s[16:19], s25 offen offset:0
    v_mfma_f32_16x16x32_bf16 a[24:27], v[212:215], v[184:187], a[24:27]
    buffer_load_dwordx4 v[160:163], v1, s[16:19], s25 offen offset:1024
    v_mfma_f32_16x16x32_bf16 a[28:31], v[212:215], v[188:191], a[28:31]
    buffer_load_dwordx4 v[164:167], v1, s[16:19], s26 offen offset:0
    v_mfma_f32_16x16x32_bf16 a[32:35], v[212:215], v[192:195], a[32:35]
    buffer_load_dwordx4 v[168:171], v1, s[16:19], s26 offen offset:1024
    v_mfma_f32_16x16x32_bf16 a[36:39], v[212:215], v[196:199], a[36:39]
    buffer_load_dwordx4 v[172:175], v1, s[16:19], s26 offen offset:2048
    v_mfma_f32_16x16x32_bf16 a[40:43], v[212:215], v[200:203], a[40:43]
    buffer_load_dwordx4 v[176:179], v1, s[16:19], s26 offen offset:3072
    v_mfma_f32_16x16x32_bf16 a[44:47], v[212:215], v[204:207], a[44:47]
    buffer_load_dwordx4 v[180:183], v1, s[16:19], s27 offen offset:0
    v_mfma_f32_16x16x32_bf16 a[48:51], v[216:219], v[184:187], a[48:51]
    s_add_u32 s24, s24, 6144
    v_mfma_f32_16x16x32_bf16 a[52:55], v[216:219], v[188:191], a[52:55]
    s_add_u32 s25, s25, 6144
    v_mfma_f32_16x16x32_bf16 a[56:59], v[216:219], v[192:195], a[56:59]
    s_add_u32 s26, s26, 5120
    v_mfma_f32_16x16x32_bf16 a[60:63], v[216:219], v[196:199], a[60:63]
    s_add_u32 s27, s27, 5120
    v_mfma_f32_16x16x32_bf16 a[64:67], v[216:219], v[200:203], a[64:67]
    v_mfma_f32_16x16x32_bf16 a[68:71], v[216:219], v[204:207], a[68:71]
    v_mfma_f32_16x16x32_bf16 a[72:75], v[220:223], v[184:187], a[72:75]
    v_mfma_f32_16x16x32_bf16 a[76:79], v[220:223], v[188:191], a[76:79]
    v_mfma_f32_16x16x32_bf16 a[80:83], v[220:223], v[192:195], a[80:83]
    v_mfma_f32_16x16x32_bf16 a[84:87], v[220:223], v[196:199], a[84:87]
    v_mfma_f32_16x16x32_bf16 a[88:91], v[220:223], v[200:203], a[88:91]
    v_mfma_f32_16x16x32_bf16 a[92:95], v[220:223], v[204:207], a[92:95]
    v_mfma_f32_16x16x32_bf16 a[96:99], v[224:227], v[184:187], a[96:99]
    v_mfma_f32_16x16x32_bf16 a[100:103], v[224:227], v[188:191], a[100:103]
    v_mfma_f32_16x16x32_bf16 a[104:107], v[224:227], v[192:195], a[104:107]
    v_mfma_f32_16x16x32_bf16 a[108:111], v[224:227], v[196:199], a[108:111]
    v_mfma_f32_16x16x32_bf16 a[112:115], v[224:227], v[200:203], a[112:115]
    v_mfma_f32_16x16x32_bf16 a[116:119], v[224:227], v[204:207], a[116:119]
    s_waitcnt vmcnt(33)
    v_mfma_f32_16x16x32_bf16 a[0:3], v[32:35], v[8:11], a[0:3]
    v_mfma_f32_16x16x32_bf16 a[4:7], v[32:35], v[12:15], a[4:7]
    buffer_load_dwordx4 v[184:187], v1, s[16:19], s24 offen offset:0
    v_mfma_f32_16x16x32_bf16 a[8:11], v[32:35], v[16:19], a[8:11]
    buffer_load_dwordx4 v[188:191], v1, s[16:19], s24 offen offset:1024
    v_mfma_f32_16x16x32_bf16 a[12:15], v[32:35], v[20:23], a[12:15]
    buffer_load_dwordx4 v[192:195], v1, s[16:19], s24 offen offset:2048
    v_mfma_f32_16x16x32_bf16 a[16:19], v[32:35], v[24:27], a[16:19]
    buffer_load_dwordx4 v[196:199], v1, s[16:19], s24 offen offset:3072
    v_mfma_f32_16x16x32_bf16 a[20:23], v[32:35], v[28:31], a[20:23]
    buffer_load_dwordx4 v[200:203], v1, s[16:19], s25 offen offset:0
    v_mfma_f32_16x16x32_bf16 a[24:27], v[36:39], v[8:11], a[24:27]
    buffer_load_dwordx4 v[204:207], v1, s[16:19], s25 offen offset:1024
    v_mfma_f32_16x16x32_bf16 a[28:31], v[36:39], v[12:15], a[28:31]
    buffer_load_dwordx4 v[208:211], v1, s[16:19], s26 offen offset:0
    v_mfma_f32_16x16x32_bf16 a[32:35], v[36:39], v[16:19], a[32:35]
    buffer_load_dwordx4 v[212:215], v1, s[16:19], s26 offen offset:1024
    v_mfma_f32_16x16x32_bf16 a[36:39], v[36:39], v[20:23], a[36:39]
    buffer_load_dwordx4 v[216:219], v1, s[16:19], s26 offen offset:2048
    v_mfma_f32_16x16x32_bf16 a[40:43], v[36:39], v[24:27], a[40:43]
    buffer_load_dwordx4 v[220:223], v1, s[16:19], s26 offen offset:3072
    v_mfma_f32_16x16x32_bf16 a[44:47], v[36:39], v[28:31], a[44:47]
    buffer_load_dwordx4 v[224:227], v1, s[16:19], s27 offen offset:0
    v_mfma_f32_16x16x32_bf16 a[48:51], v[40:43], v[8:11], a[48:51]
    s_add_u32 s24, s24, 6144
    v_mfma_f32_16x16x32_bf16 a[52:55], v[40:43], v[12:15], a[52:55]
    s_add_u32 s25, s25, 6144
    v_mfma_f32_16x16x32_bf16 a[56:59], v[40:43], v[16:19], a[56:59]
    s_add_u32 s26, s26, 5120
    v_mfma_f32_16x16x32_bf16 a[60:63], v[40:43], v[20:23], a[60:63]
    s_add_u32 s27, s27, 5120
    v_mfma_f32_16x16x32_bf16 a[64:67], v[40:43], v[24:27], a[64:67]
    v_mfma_f32_16x16x32_bf16 a[68:71], v[40:43], v[28:31], a[68:71]
    v_mfma_f32_16x16x32_bf16 a[72:75], v[44:47], v[8:11], a[72:75]
    v_mfma_f32_16x16x32_bf16 a[76:79], v[44:47], v[12:15], a[76:79]
    v_mfma_f32_16x16x32_bf16 a[80:83], v[44:47], v[16:19], a[80:83]
    v_mfma_f32_16x16x32_bf16 a[84:87], v[44:47], v[20:23], a[84:87]
    v_mfma_f32_16x16x32_bf16 a[88:91], v[44:47], v[24:27], a[88:91]
    v_mfma_f32_16x16x32_bf16 a[92:95], v[44:47], v[28:31], a[92:95]
    v_mfma_f32_16x16x32_bf16 a[96:99], v[48:51], v[8:11], a[96:99]
    v_mfma_f32_16x16x32_bf16 a[100:103], v[48:51], v[12:15], a[100:103]
    v_mfma_f32_16x16x32_bf16 a[104:107], v[48:51], v[16:19], a[104:107]
    v_mfma_f32_16x16x32_bf16 a[108:111], v[48:51], v[20:23], a[108:111]
    v_mfma_f32_16x16x32_bf16 a[112:115], v[48:51], v[24:27], a[112:115]
    v_mfma_f32_16x16x32_bf16 a[116:119], v[48:51], v[28:31], a[116:119]
    s_waitcnt vmcnt(33)
    v_mfma_f32_16x16x32_bf16 a[0:3], v[76:79], v[52:55], a[0:3]
    v_mfma_f32_16x16x32_bf16 a[4:7], v[76:79], v[56:59], a[4:7]
    buffer_load_dwordx4 v[8:11], v1, s[16:19], s24 offen offset:0
    v_mfma_f32_16x16x32_bf16 a[8:11], v[76:79], v[60:63], a[8:11]
    buffer_load_dwordx4 v[12:15], v1, s[16:19], s24 offen offset:1024
    v_mfma_f32_16x16x32_bf16 a[12:15], v[76:79], v[64:67], a[12:15]
    buffer_load_dwordx4 v[16:19], v1, s[16:19], s24 offen offset:2048
    v_mfma_f32_16x16x32_bf16 a[16:19], v[76:79], v[68:71], a[16:19]
    buffer_load_dwordx4 v[20:23], v1, s[16:19], s24 offen offset:3072
    v_mfma_f32_16x16x32_bf16 a[20:23], v[76:79], v[72:75], a[20:23]
    buffer_load_dwordx4 v[24:27], v1, s[16:19], s25 offen offset:0
    v_mfma_f32_16x16x32_bf16 a[24:27], v[80:83], v[52:55], a[24:27]
    buffer_load_dwordx4 v[28:31], v1, s[16:19], s25 offen offset:1024
    v_mfma_f32_16x16x32_bf16 a[28:31], v[80:83], v[56:59], a[28:31]
    buffer_load_dwordx4 v[32:35], v1, s[16:19], s26 offen offset:0
    v_mfma_f32_16x16x32_bf16 a[32:35], v[80:83], v[60:63], a[32:35]
    buffer_load_dwordx4 v[36:39], v1, s[16:19], s26 offen offset:1024
    v_mfma_f32_16x16x32_bf16 a[36:39], v[80:83], v[64:67], a[36:39]
    buffer_load_dwordx4 v[40:43], v1, s[16:19], s26 offen offset:2048
    v_mfma_f32_16x16x32_bf16 a[40:43], v[80:83], v[68:71], a[40:43]
    buffer_load_dwordx4 v[44:47], v1, s[16:19], s26 offen offset:3072
    v_mfma_f32_16x16x32_bf16 a[44:47], v[80:83], v[72:75], a[44:47]
    buffer_load_dwordx4 v[48:51], v1, s[16:19], s27 offen offset:0
    v_mfma_f32_16x16x32_bf16 a[48:51], v[84:87], v[52:55], a[48:51]
    s_add_u32 s24, s24, 6144
    v_mfma_f32_16x16x32_bf16 a[52:55], v[84:87], v[56:59], a[52:55]
    s_add_u32 s25, s25, 6144
    v_mfma_f32_16x16x32_bf16 a[56:59], v[84:87], v[60:63], a[56:59]
    s_add_u32 s26, s26, 5120
    v_mfma_f32_16x16x32_bf16 a[60:63], v[84:87], v[64:67], a[60:63]
    s_add_u32 s27, s27, 5120
    v_mfma_f32_16x16x32_bf16 a[64:67], v[84:87], v[68:71], a[64:67]
    v_mfma_f32_16x16x32_bf16 a[68:71], v[84:87], v[72:75], a[68:71]
    v_mfma_f32_16x16x32_bf16 a[72:75], v[88:91], v[52:55], a[72:75]
    v_mfma_f32_16x16x32_bf16 a[76:79], v[88:91], v[56:59], a[76:79]
    v_mfma_f32_16x16x32_bf16 a[80:83], v[88:91], v[60:63], a[80:83]
    v_mfma_f32_16x16x32_bf16 a[84:87], v[88:91], v[64:67], a[84:87]
    v_mfma_f32_16x16x32_bf16 a[88:91], v[88:91], v[68:71], a[88:91]
    v_mfma_f32_16x16x32_bf16 a[92:95], v[88:91], v[72:75], a[92:95]
    v_mfma_f32_16x16x32_bf16 a[96:99], v[92:95], v[52:55], a[96:99]
    v_mfma_f32_16x16x32_bf16 a[100:103], v[92:95], v[56:59], a[100:103]
    v_mfma_f32_16x16x32_bf16 a[104:107], v[92:95], v[60:63], a[104:107]
    v_mfma_f32_16x16x32_bf16 a[108:111], v[92:95], v[64:67], a[108:111]
    v_mfma_f32_16x16x32_bf16 a[112:115], v[92:95], v[68:71], a[112:115]
    v_mfma_f32_16x16x32_bf16 a[116:119], v[92:95], v[72:75], a[116:119]
    s_waitcnt vmcnt(33)
    v_mfma_f32_16x16x32_bf16 a[0:3], v[120:123], v[96:99], a[0:3]
    v_mfma_f32_16x16x32_bf16 a[4:7], v[120:123], v[100:103], a[4:7]
    buffer_load_dwordx4 v[52:55], v1, s[16:19], s24 offen offset:0
    v_mfma_f32_16x16x32_bf16 a[8:11], v[120:123], v[104:107], a[8:11]
    buffer_load_dwordx4 v[56:59], v1, s[16:19], s24 offen offset:1024
    v_mfma_f32_16x16x32_bf16 a[12:15], v[120:123], v[108:111], a[12:15]
    buffer_load_dwordx4 v[60:63], v1, s[16:19], s24 offen offset:2048
    v_mfma_f32_16x16x32_bf16 a[16:19], v[120:123], v[112:115], a[16:19]
    buffer_load_dwordx4 v[64:67], v1, s[16:19], s24 offen offset:3072
    v_mfma_f32_16x16x32_bf16 a[20:23], v[120:123], v[116:119], a[20:23]
    buffer_load_dwordx4 v[68:71], v1, s[16:19], s25 offen offset:0
    v_mfma_f32_16x16x32_bf16 a[24:27], v[124:127], v[96:99], a[24:27]
    buffer_load_dwordx4 v[72:75], v1, s[16:19], s25 offen offset:1024
    v_mfma_f32_16x16x32_bf16 a[28:31], v[124:127], v[100:103], a[28:31]
    buffer_load_dwordx4 v[76:79], v1, s[16:19], s26 offen offset:0
    v_mfma_f32_16x16x32_bf16 a[32:35], v[124:127], v[104:107], a[32:35]
    buffer_load_dwordx4 v[80:83], v1, s[16:19], s26 offen offset:1024
    v_mfma_f32_16x16x32_bf16 a[36:39], v[124:127], v[108:111], a[36:39]
    buffer_load_dwordx4 v[84:87], v1, s[16:19], s26 offen offset:2048
    v_mfma_f32_16x16x32_bf16 a[40:43], v[124:127], v[112:115], a[40:43]
    buffer_load_dwordx4 v[88:91], v1, s[16:19], s26 offen offset:3072
    v_mfma_f32_16x16x32_bf16 a[44:47], v[124:127], v[116:119], a[44:47]
    buffer_load_dwordx4 v[92:95], v1, s[16:19], s27 offen offset:0
    v_mfma_f32_16x16x32_bf16 a[48:51], v[128:131], v[96:99], a[48:51]
    s_add_u32 s24, s24, 6144
    v_mfma_f32_16x16x32_bf16 a[52:55], v[128:131], v[100:103], a[52:55]
    s_add_u32 s25, s25, 6144
    v_mfma_f32_16x16x32_bf16 a[56:59], v[128:131], v[104:107], a[56:59]
    s_add_u32 s26, s26, 5120
    v_mfma_f32_16x16x32_bf16 a[60:63], v[128:131], v[108:111], a[60:63]
    s_add_u32 s27, s27, 5120
    v_mfma_f32_16x16x32_bf16 a[64:67], v[128:131], v[112:115], a[64:67]
    v_mfma_f32_16x16x32_bf16 a[68:71], v[128:131], v[116:119], a[68:71]
    v_mfma_f32_16x16x32_bf16 a[72:75], v[132:135], v[96:99], a[72:75]
    v_mfma_f32_16x16x32_bf16 a[76:79], v[132:135], v[100:103], a[76:79]
    v_mfma_f32_16x16x32_bf16 a[80:83], v[132:135], v[104:107], a[80:83]
    v_mfma_f32_16x16x32_bf16 a[84:87], v[132:135], v[108:111], a[84:87]
    v_mfma_f32_16x16x32_bf16 a[88:91], v[132:135], v[112:115], a[88:91]
    v_mfma_f32_16x16x32_bf16 a[92:95], v[132:135], v[116:119], a[92:95]
    v_mfma_f32_16x16x32_bf16 a[96:99], v[136:139], v[96:99], a[96:99]
    v_mfma_f32_16x16x32_bf16 a[100:103], v[136:139], v[100:103], a[100:103]
    v_mfma_f32_16x16x32_bf16 a[104:107], v[136:139], v[104:107], a[104:107]
    v_mfma_f32_16x16x32_bf16 a[108:111], v[136:139], v[108:111], a[108:111]
    v_mfma_f32_16x16x32_bf16 a[112:115], v[136:139], v[112:115], a[112:115]
    v_mfma_f32_16x16x32_bf16 a[116:119], v[136:139], v[116:119], a[116:119]
    s_waitcnt vmcnt(33)
    v_mfma_f32_16x16x32_bf16 a[0:3], v[164:167], v[140:143], a[0:3]
    v_mfma_f32_16x16x32_bf16 a[4:7], v[164:167], v[144:147], a[4:7]
    buffer_load_dwordx4 v[96:99], v1, s[16:19], s24 offen offset:0
    v_mfma_f32_16x16x32_bf16 a[8:11], v[164:167], v[148:151], a[8:11]
    buffer_load_dwordx4 v[100:103], v1, s[16:19], s24 offen offset:1024
    v_mfma_f32_16x16x32_bf16 a[12:15], v[164:167], v[152:155], a[12:15]
    buffer_load_dwordx4 v[104:107], v1, s[16:19], s24 offen offset:2048
    v_mfma_f32_16x16x32_bf16 a[16:19], v[164:167], v[156:159], a[16:19]
    buffer_load_dwordx4 v[108:111], v1, s[16:19], s24 offen offset:3072
    v_mfma_f32_16x16x32_bf16 a[20:23], v[164:167], v[160:163], a[20:23]
    buffer_load_dwordx4 v[112:115], v1, s[16:19], s25 offen offset:0
    v_mfma_f32_16x16x32_bf16 a[24:27], v[168:171], v[140:143], a[24:27]
    buffer_load_dwordx4 v[116:119], v1, s[16:19], s25 offen offset:1024
    v_mfma_f32_16x16x32_bf16 a[28:31], v[168:171], v[144:147], a[28:31]
    buffer_load_dwordx4 v[120:123], v1, s[16:19], s26 offen offset:0
    v_mfma_f32_16x16x32_bf16 a[32:35], v[168:171], v[148:151], a[32:35]
    buffer_load_dwordx4 v[124:127], v1, s[16:19], s26 offen offset:1024
    v_mfma_f32_16x16x32_bf16 a[36:39], v[168:171], v[152:155], a[36:39]
    buffer_load_dwordx4 v[128:131], v1, s[16:19], s26 offen offset:2048
    v_mfma_f32_16x16x32_bf16 a[40:43], v[168:171], v[156:159], a[40:43]
    buffer_load_dwordx4 v[132:135], v1, s[16:19], s26 offen offset:3072
    v_mfma_f32_16x16x32_bf16 a[44:47], v[168:171], v[160:163], a[44:47]
    buffer_load_dwordx4 v[136:139], v1, s[16:19], s27 offen offset:0
    v_mfma_f32_16x16x32_bf16 a[48:51], v[172:175], v[140:143], a[48:51]
    s_add_u32 s24, s24, 6144
    v_mfma_f32_16x16x32_bf16 a[52:55], v[172:175], v[144:147], a[52:55]
    s_add_u32 s25, s25, 6144
    v_mfma_f32_16x16x32_bf16 a[56:59], v[172:175], v[148:151], a[56:59]
    s_add_u32 s26, s26, 5120
    v_mfma_f32_16x16x32_bf16 a[60:63], v[172:175], v[152:155], a[60:63]
    s_add_u32 s27, s27, 5120
    v_mfma_f32_16x16x32_bf16 a[64:67], v[172:175], v[156:159], a[64:67]
    v_mfma_f32_16x16x32_bf16 a[68:71], v[172:175], v[160:163], a[68:71]
    v_mfma_f32_16x16x32_bf16 a[72:75], v[176:179], v[140:143], a[72:75]
    v_mfma_f32_16x16x32_bf16 a[76:79], v[176:179], v[144:147], a[76:79]
    v_mfma_f32_16x16x32_bf16 a[80:83], v[176:179], v[148:151], a[80:83]
    v_mfma_f32_16x16x32_bf16 a[84:87], v[176:179], v[152:155], a[84:87]
    v_mfma_f32_16x16x32_bf16 a[88:91], v[176:179], v[156:159], a[88:91]
    v_mfma_f32_16x16x32_bf16 a[92:95], v[176:179], v[160:163], a[92:95]
    v_mfma_f32_16x16x32_bf16 a[96:99], v[180:183], v[140:143], a[96:99]
    v_mfma_f32_16x16x32_bf16 a[100:103], v[180:183], v[144:147], a[100:103]
    v_mfma_f32_16x16x32_bf16 a[104:107], v[180:183], v[148:151], a[104:107]
    v_mfma_f32_16x16x32_bf16 a[108:111], v[180:183], v[152:155], a[108:111]
    v_mfma_f32_16x16x32_bf16 a[112:115], v[180:183], v[156:159], a[112:115]
    v_mfma_f32_16x16x32_bf16 a[116:119], v[180:183], v[160:163], a[116:119]
    s_waitcnt vmcnt(33)
    v_mfma_f32_16x16x32_bf16 a[0:3], v[208:211], v[184:187], a[0:3]
    v_mfma_f32_16x16x32_bf16 a[4:7], v[208:211], v[188:191], a[4:7]
    buffer_load_dwordx4 v[140:143], v1, s[16:19], s24 offen offset:0
    v_mfma_f32_16x16x32_bf16 a[8:11], v[208:211], v[192:195], a[8:11]
    buffer_load_dwordx4 v[144:147], v1, s[16:19], s24 offen offset:1024
    v_mfma_f32_16x16x32_bf16 a[12:15], v[208:211], v[196:199], a[12:15]
    buffer_load_dwordx4 v[148:151], v1, s[16:19], s24 offen offset:2048
    v_mfma_f32_16x16x32_bf16 a[16:19], v[208:211], v[200:203], a[16:19]
    buffer_load_dwordx4 v[152:155], v1, s[16:19], s24 offen offset:3072
    v_mfma_f32_16x16x32_bf16 a[20:23], v[208:211], v[204:207], a[20:23]
    buffer_load_dwordx4 v[156:159], v1, s[16:19], s25 offen offset:0
    v_mfma_f32_16x16x32_bf16 a[24:27], v[212:215], v[184:187], a[24:27]
    buffer_load_dwordx4 v[160:163], v1, s[16:19], s25 offen offset:1024
    v_mfma_f32_16x16x32_bf16 a[28:31], v[212:215], v[188:191], a[28:31]
    buffer_load_dwordx4 v[164:167], v1, s[16:19], s26 offen offset:0
    v_mfma_f32_16x16x32_bf16 a[32:35], v[212:215], v[192:195], a[32:35]
    buffer_load_dwordx4 v[168:171], v1, s[16:19], s26 offen offset:1024
    v_mfma_f32_16x16x32_bf16 a[36:39], v[212:215], v[196:199], a[36:39]
    buffer_load_dwordx4 v[172:175], v1, s[16:19], s26 offen offset:2048
    v_mfma_f32_16x16x32_bf16 a[40:43], v[212:215], v[200:203], a[40:43]
    buffer_load_dwordx4 v[176:179], v1, s[16:19], s26 offen offset:3072
    v_mfma_f32_16x16x32_bf16 a[44:47], v[212:215], v[204:207], a[44:47]
    buffer_load_dwordx4 v[180:183], v1, s[16:19], s27 offen offset:0
    v_mfma_f32_16x16x32_bf16 a[48:51], v[216:219], v[184:187], a[48:51]
    s_add_u32 s24, s24, 6144
    v_mfma_f32_16x16x32_bf16 a[52:55], v[216:219], v[188:191], a[52:55]
    s_add_u32 s25, s25, 6144
    v_mfma_f32_16x16x32_bf16 a[56:59], v[216:219], v[192:195], a[56:59]
    s_add_u32 s26, s26, 5120
    v_mfma_f32_16x16x32_bf16 a[60:63], v[216:219], v[196:199], a[60:63]
    s_add_u32 s27, s27, 5120
    v_mfma_f32_16x16x32_bf16 a[64:67], v[216:219], v[200:203], a[64:67]
    v_mfma_f32_16x16x32_bf16 a[68:71], v[216:219], v[204:207], a[68:71]
    v_mfma_f32_16x16x32_bf16 a[72:75], v[220:223], v[184:187], a[72:75]
    v_mfma_f32_16x16x32_bf16 a[76:79], v[220:223], v[188:191], a[76:79]
    v_mfma_f32_16x16x32_bf16 a[80:83], v[220:223], v[192:195], a[80:83]
    v_mfma_f32_16x16x32_bf16 a[84:87], v[220:223], v[196:199], a[84:87]
    v_mfma_f32_16x16x32_bf16 a[88:91], v[220:223], v[200:203], a[88:91]
    v_mfma_f32_16x16x32_bf16 a[92:95], v[220:223], v[204:207], a[92:95]
    v_mfma_f32_16x16x32_bf16 a[96:99], v[224:227], v[184:187], a[96:99]
    v_mfma_f32_16x16x32_bf16 a[100:103], v[224:227], v[188:191], a[100:103]
    v_mfma_f32_16x16x32_bf16 a[104:107], v[224:227], v[192:195], a[104:107]
    v_mfma_f32_16x16x32_bf16 a[108:111], v[224:227], v[196:199], a[108:111]
    v_mfma_f32_16x16x32_bf16 a[112:115], v[224:227], v[200:203], a[112:115]
    v_mfma_f32_16x16x32_bf16 a[116:119], v[224:227], v[204:207], a[116:119]
    s_waitcnt vmcnt(33)
    v_mfma_f32_16x16x32_bf16 a[0:3], v[32:35], v[8:11], a[0:3]
    v_mfma_f32_16x16x32_bf16 a[4:7], v[32:35], v[12:15], a[4:7]
    buffer_load_dwordx4 v[184:187], v1, s[16:19], s24 offen offset:0
    v_mfma_f32_16x16x32_bf16 a[8:11], v[32:35], v[16:19], a[8:11]
    buffer_load_dwordx4 v[188:191], v1, s[16:19], s24 offen offset:1024
    v_mfma_f32_16x16x32_bf16 a[12:15], v[32:35], v[20:23], a[12:15]
    buffer_load_dwordx4 v[192:195], v1, s[16:19], s24 offen offset:2048
    v_mfma_f32_16x16x32_bf16 a[16:19], v[32:35], v[24:27], a[16:19]
    buffer_load_dwordx4 v[196:199], v1, s[16:19], s24 offen offset:3072
    v_mfma_f32_16x16x32_bf16 a[20:23], v[32:35], v[28:31], a[20:23]
    buffer_load_dwordx4 v[200:203], v1, s[16:19], s25 offen offset:0
    v_mfma_f32_16x16x32_bf16 a[24:27], v[36:39], v[8:11], a[24:27]
    buffer_load_dwordx4 v[204:207], v1, s[16:19], s25 offen offset:1024
    v_mfma_f32_16x16x32_bf16 a[28:31], v[36:39], v[12:15], a[28:31]
    buffer_load_dwordx4 v[208:211], v1, s[16:19], s26 offen offset:0
    v_mfma_f32_16x16x32_bf16 a[32:35], v[36:39], v[16:19], a[32:35]
    buffer_load_dwordx4 v[212:215], v1, s[16:19], s26 offen offset:1024
    v_mfma_f32_16x16x32_bf16 a[36:39], v[36:39], v[20:23], a[36:39]
    buffer_load_dwordx4 v[216:219], v1, s[16:19], s26 offen offset:2048
    v_mfma_f32_16x16x32_bf16 a[40:43], v[36:39], v[24:27], a[40:43]
    buffer_load_dwordx4 v[220:223], v1, s[16:19], s26 offen offset:3072
    v_mfma_f32_16x16x32_bf16 a[44:47], v[36:39], v[28:31], a[44:47]
    buffer_load_dwordx4 v[224:227], v1, s[16:19], s27 offen offset:0
    v_mfma_f32_16x16x32_bf16 a[48:51], v[40:43], v[8:11], a[48:51]
    s_add_u32 s24, s24, 6144
    v_mfma_f32_16x16x32_bf16 a[52:55], v[40:43], v[12:15], a[52:55]
    s_add_u32 s25, s25, 6144
    v_mfma_f32_16x16x32_bf16 a[56:59], v[40:43], v[16:19], a[56:59]
    s_add_u32 s26, s26, 5120
    v_mfma_f32_16x16x32_bf16 a[60:63], v[40:43], v[20:23], a[60:63]
    s_add_u32 s27, s27, 5120
    v_mfma_f32_16x16x32_bf16 a[64:67], v[40:43], v[24:27], a[64:67]
    v_mfma_f32_16x16x32_bf16 a[68:71], v[40:43], v[28:31], a[68:71]
    v_mfma_f32_16x16x32_bf16 a[72:75], v[44:47], v[8:11], a[72:75]
    v_mfma_f32_16x16x32_bf16 a[76:79], v[44:47], v[12:15], a[76:79]
    v_mfma_f32_16x16x32_bf16 a[80:83], v[44:47], v[16:19], a[80:83]
    v_mfma_f32_16x16x32_bf16 a[84:87], v[44:47], v[20:23], a[84:87]
    v_mfma_f32_16x16x32_bf16 a[88:91], v[44:47], v[24:27], a[88:91]
    v_mfma_f32_16x16x32_bf16 a[92:95], v[44:47], v[28:31], a[92:95]
    v_mfma_f32_16x16x32_bf16 a[96:99], v[48:51], v[8:11], a[96:99]
    v_mfma_f32_16x16x32_bf16 a[100:103], v[48:51], v[12:15], a[100:103]
    v_mfma_f32_16x16x32_bf16 a[104:107], v[48:51], v[16:19], a[104:107]
    v_mfma_f32_16x16x32_bf16 a[108:111], v[48:51], v[20:23], a[108:111]
    v_mfma_f32_16x16x32_bf16 a[112:115], v[48:51], v[24:27], a[112:115]
    v_mfma_f32_16x16x32_bf16 a[116:119], v[48:51], v[28:31], a[116:119]
    s_waitcnt vmcnt(33)
    v_mfma_f32_16x16x32_bf16 a[0:3], v[76:79], v[52:55], a[0:3]
    v_mfma_f32_16x16x32_bf16 a[4:7], v[76:79], v[56:59], a[4:7]
    buffer_load_dwordx4 v[8:11], v1, s[16:19], s24 offen offset:0
    v_mfma_f32_16x16x32_bf16 a[8:11], v[76:79], v[60:63], a[8:11]
    buffer_load_dwordx4 v[12:15], v1, s[16:19], s24 offen offset:1024
    v_mfma_f32_16x16x32_bf16 a[12:15], v[76:79], v[64:67], a[12:15]
    buffer_load_dwordx4 v[16:19], v1, s[16:19], s24 offen offset:2048
    v_mfma_f32_16x16x32_bf16 a[16:19], v[76:79], v[68:71], a[16:19]
    buffer_load_dwordx4 v[20:23], v1, s[16:19], s24 offen offset:3072
    v_mfma_f32_16x16x32_bf16 a[20:23], v[76:79], v[72:75], a[20:23]
    buffer_load_dwordx4 v[24:27], v1, s[16:19], s25 offen offset:0
    v_mfma_f32_16x16x32_bf16 a[24:27], v[80:83], v[52:55], a[24:27]
    buffer_load_dwordx4 v[28:31], v1, s[16:19], s25 offen offset:1024
    v_mfma_f32_16x16x32_bf16 a[28:31], v[80:83], v[56:59], a[28:31]
    buffer_load_dwordx4 v[32:35], v1, s[16:19], s26 offen offset:0
    v_mfma_f32_16x16x32_bf16 a[32:35], v[80:83], v[60:63], a[32:35]
    buffer_load_dwordx4 v[36:39], v1, s[16:19], s26 offen offset:1024
    v_mfma_f32_16x16x32_bf16 a[36:39], v[80:83], v[64:67], a[36:39]
    buffer_load_dwordx4 v[40:43], v1, s[16:19], s26 offen offset:2048
    v_mfma_f32_16x16x32_bf16 a[40:43], v[80:83], v[68:71], a[40:43]
    buffer_load_dwordx4 v[44:47], v1, s[16:19], s26 offen offset:3072
    v_mfma_f32_16x16x32_bf16 a[44:47], v[80:83], v[72:75], a[44:47]
    buffer_load_dwordx4 v[48:51], v1, s[16:19], s27 offen offset:0
    v_mfma_f32_16x16x32_bf16 a[48:51], v[84:87], v[52:55], a[48:51]
    s_add_u32 s24, s24, 6144
    v_mfma_f32_16x16x32_bf16 a[52:55], v[84:87], v[56:59], a[52:55]
    s_add_u32 s25, s25, 6144
    v_mfma_f32_16x16x32_bf16 a[56:59], v[84:87], v[60:63], a[56:59]
    s_add_u32 s26, s26, 5120
    v_mfma_f32_16x16x32_bf16 a[60:63], v[84:87], v[64:67], a[60:63]
    s_add_u32 s27, s27, 5120
    v_mfma_f32_16x16x32_bf16 a[64:67], v[84:87], v[68:71], a[64:67]
    v_mfma_f32_16x16x32_bf16 a[68:71], v[84:87], v[72:75], a[68:71]
    v_mfma_f32_16x16x32_bf16 a[72:75], v[88:91], v[52:55], a[72:75]
    v_mfma_f32_16x16x32_bf16 a[76:79], v[88:91], v[56:59], a[76:79]
    v_mfma_f32_16x16x32_bf16 a[80:83], v[88:91], v[60:63], a[80:83]
    v_mfma_f32_16x16x32_bf16 a[84:87], v[88:91], v[64:67], a[84:87]
    v_mfma_f32_16x16x32_bf16 a[88:91], v[88:91], v[68:71], a[88:91]
    v_mfma_f32_16x16x32_bf16 a[92:95], v[88:91], v[72:75], a[92:95]
    v_mfma_f32_16x16x32_bf16 a[96:99], v[92:95], v[52:55], a[96:99]
    v_mfma_f32_16x16x32_bf16 a[100:103], v[92:95], v[56:59], a[100:103]
    v_mfma_f32_16x16x32_bf16 a[104:107], v[92:95], v[60:63], a[104:107]
    v_mfma_f32_16x16x32_bf16 a[108:111], v[92:95], v[64:67], a[108:111]
    v_mfma_f32_16x16x32_bf16 a[112:115], v[92:95], v[68:71], a[112:115]
    v_mfma_f32_16x16x32_bf16 a[116:119], v[92:95], v[72:75], a[116:119]
    s_waitcnt vmcnt(33)
    v_mfma_f32_16x16x32_bf16 a[0:3], v[120:123], v[96:99], a[0:3]
    v_mfma_f32_16x16x32_bf16 a[4:7], v[120:123], v[100:103], a[4:7]
    buffer_load_dwordx4 v[52:55], v1, s[16:19], s24 offen offset:0
    v_mfma_f32_16x16x32_bf16 a[8:11], v[120:123], v[104:107], a[8:11]
    buffer_load_dwordx4 v[56:59], v1, s[16:19], s24 offen offset:1024
    v_mfma_f32_16x16x32_bf16 a[12:15], v[120:123], v[108:111], a[12:15]
    buffer_load_dwordx4 v[60:63], v1, s[16:19], s24 offen offset:2048
    v_mfma_f32_16x16x32_bf16 a[16:19], v[120:123], v[112:115], a[16:19]
    buffer_load_dwordx4 v[64:67], v1, s[16:19], s24 offen offset:3072
    v_mfma_f32_16x16x32_bf16 a[20:23], v[120:123], v[116:119], a[20:23]
    buffer_load_dwordx4 v[68:71], v1, s[16:19], s25 offen offset:0
    v_mfma_f32_16x16x32_bf16 a[24:27], v[124:127], v[96:99], a[24:27]
    buffer_load_dwordx4 v[72:75], v1, s[16:19], s25 offen offset:1024
    v_mfma_f32_16x16x32_bf16 a[28:31], v[124:127], v[100:103], a[28:31]
    buffer_load_dwordx4 v[76:79], v1, s[16:19], s26 offen offset:0
    v_mfma_f32_16x16x32_bf16 a[32:35], v[124:127], v[104:107], a[32:35]
    buffer_load_dwordx4 v[80:83], v1, s[16:19], s26 offen offset:1024
    v_mfma_f32_16x16x32_bf16 a[36:39], v[124:127], v[108:111], a[36:39]
    buffer_load_dwordx4 v[84:87], v1, s[16:19], s26 offen offset:2048
    v_mfma_f32_16x16x32_bf16 a[40:43], v[124:127], v[112:115], a[40:43]
    buffer_load_dwordx4 v[88:91], v1, s[16:19], s26 offen offset:3072
    v_mfma_f32_16x16x32_bf16 a[44:47], v[124:127], v[116:119], a[44:47]
    buffer_load_dwordx4 v[92:95], v1, s[16:19], s27 offen offset:0
    v_mfma_f32_16x16x32_bf16 a[48:51], v[128:131], v[96:99], a[48:51]
    s_add_u32 s24, s24, 6144
    v_mfma_f32_16x16x32_bf16 a[52:55], v[128:131], v[100:103], a[52:55]
    s_add_u32 s25, s25, 6144
    v_mfma_f32_16x16x32_bf16 a[56:59], v[128:131], v[104:107], a[56:59]
    s_add_u32 s26, s26, 5120
    v_mfma_f32_16x16x32_bf16 a[60:63], v[128:131], v[108:111], a[60:63]
    s_add_u32 s27, s27, 5120
    v_mfma_f32_16x16x32_bf16 a[64:67], v[128:131], v[112:115], a[64:67]
    v_mfma_f32_16x16x32_bf16 a[68:71], v[128:131], v[116:119], a[68:71]
    v_mfma_f32_16x16x32_bf16 a[72:75], v[132:135], v[96:99], a[72:75]
    v_mfma_f32_16x16x32_bf16 a[76:79], v[132:135], v[100:103], a[76:79]
    v_mfma_f32_16x16x32_bf16 a[80:83], v[132:135], v[104:107], a[80:83]
    v_mfma_f32_16x16x32_bf16 a[84:87], v[132:135], v[108:111], a[84:87]
    v_mfma_f32_16x16x32_bf16 a[88:91], v[132:135], v[112:115], a[88:91]
    v_mfma_f32_16x16x32_bf16 a[92:95], v[132:135], v[116:119], a[92:95]
    v_mfma_f32_16x16x32_bf16 a[96:99], v[136:139], v[96:99], a[96:99]
    v_mfma_f32_16x16x32_bf16 a[100:103], v[136:139], v[100:103], a[100:103]
    v_mfma_f32_16x16x32_bf16 a[104:107], v[136:139], v[104:107], a[104:107]
    v_mfma_f32_16x16x32_bf16 a[108:111], v[136:139], v[108:111], a[108:111]
    v_mfma_f32_16x16x32_bf16 a[112:115], v[136:139], v[112:115], a[112:115]
    v_mfma_f32_16x16x32_bf16 a[116:119], v[136:139], v[116:119], a[116:119]
    s_waitcnt vmcnt(33)
    v_mfma_f32_16x16x32_bf16 a[0:3], v[164:167], v[140:143], a[0:3]
    v_mfma_f32_16x16x32_bf16 a[4:7], v[164:167], v[144:147], a[4:7]
    buffer_load_dwordx4 v[96:99], v1, s[16:19], s24 offen offset:0
    v_mfma_f32_16x16x32_bf16 a[8:11], v[164:167], v[148:151], a[8:11]
    buffer_load_dwordx4 v[100:103], v1, s[16:19], s24 offen offset:1024
    v_mfma_f32_16x16x32_bf16 a[12:15], v[164:167], v[152:155], a[12:15]
    buffer_load_dwordx4 v[104:107], v1, s[16:19], s24 offen offset:2048
    v_mfma_f32_16x16x32_bf16 a[16:19], v[164:167], v[156:159], a[16:19]
    buffer_load_dwordx4 v[108:111], v1, s[16:19], s24 offen offset:3072
    v_mfma_f32_16x16x32_bf16 a[20:23], v[164:167], v[160:163], a[20:23]
    buffer_load_dwordx4 v[112:115], v1, s[16:19], s25 offen offset:0
    v_mfma_f32_16x16x32_bf16 a[24:27], v[168:171], v[140:143], a[24:27]
    buffer_load_dwordx4 v[116:119], v1, s[16:19], s25 offen offset:1024
    v_mfma_f32_16x16x32_bf16 a[28:31], v[168:171], v[144:147], a[28:31]
    buffer_load_dwordx4 v[120:123], v1, s[16:19], s26 offen offset:0
    v_mfma_f32_16x16x32_bf16 a[32:35], v[168:171], v[148:151], a[32:35]
    buffer_load_dwordx4 v[124:127], v1, s[16:19], s26 offen offset:1024
    v_mfma_f32_16x16x32_bf16 a[36:39], v[168:171], v[152:155], a[36:39]
    buffer_load_dwordx4 v[128:131], v1, s[16:19], s26 offen offset:2048
    v_mfma_f32_16x16x32_bf16 a[40:43], v[168:171], v[156:159], a[40:43]
    buffer_load_dwordx4 v[132:135], v1, s[16:19], s26 offen offset:3072
    v_mfma_f32_16x16x32_bf16 a[44:47], v[168:171], v[160:163], a[44:47]
    buffer_load_dwordx4 v[136:139], v1, s[16:19], s27 offen offset:0
    v_mfma_f32_16x16x32_bf16 a[48:51], v[172:175], v[140:143], a[48:51]
    s_add_u32 s24, s24, 6144
    v_mfma_f32_16x16x32_bf16 a[52:55], v[172:175], v[144:147], a[52:55]
    s_add_u32 s25, s25, 6144
    v_mfma_f32_16x16x32_bf16 a[56:59], v[172:175], v[148:151], a[56:59]
    s_add_u32 s26, s26, 5120
    v_mfma_f32_16x16x32_bf16 a[60:63], v[172:175], v[152:155], a[60:63]
    s_add_u32 s27, s27, 5120
    v_mfma_f32_16x16x32_bf16 a[64:67], v[172:175], v[156:159], a[64:67]
    v_mfma_f32_16x16x32_bf16 a[68:71], v[172:175], v[160:163], a[68:71]
    v_mfma_f32_16x16x32_bf16 a[72:75], v[176:179], v[140:143], a[72:75]
    v_mfma_f32_16x16x32_bf16 a[76:79], v[176:179], v[144:147], a[76:79]
    v_mfma_f32_16x16x32_bf16 a[80:83], v[176:179], v[148:151], a[80:83]
    v_mfma_f32_16x16x32_bf16 a[84:87], v[176:179], v[152:155], a[84:87]
    v_mfma_f32_16x16x32_bf16 a[88:91], v[176:179], v[156:159], a[88:91]
    v_mfma_f32_16x16x32_bf16 a[92:95], v[176:179], v[160:163], a[92:95]
    v_mfma_f32_16x16x32_bf16 a[96:99], v[180:183], v[140:143], a[96:99]
    v_mfma_f32_16x16x32_bf16 a[100:103], v[180:183], v[144:147], a[100:103]
    v_mfma_f32_16x16x32_bf16 a[104:107], v[180:183], v[148:151], a[104:107]
    v_mfma_f32_16x16x32_bf16 a[108:111], v[180:183], v[152:155], a[108:111]
    v_mfma_f32_16x16x32_bf16 a[112:115], v[180:183], v[156:159], a[112:115]
    v_mfma_f32_16x16x32_bf16 a[116:119], v[180:183], v[160:163], a[116:119]
    s_waitcnt vmcnt(33)
    v_mfma_f32_16x16x32_bf16 a[0:3], v[208:211], v[184:187], a[0:3]
    v_mfma_f32_16x16x32_bf16 a[4:7], v[208:211], v[188:191], a[4:7]
    buffer_load_dwordx4 v[140:143], v1, s[16:19], s24 offen offset:0
    v_mfma_f32_16x16x32_bf16 a[8:11], v[208:211], v[192:195], a[8:11]
    buffer_load_dwordx4 v[144:147], v1, s[16:19], s24 offen offset:1024
    v_mfma_f32_16x16x32_bf16 a[12:15], v[208:211], v[196:199], a[12:15]
    buffer_load_dwordx4 v[148:151], v1, s[16:19], s24 offen offset:2048
    v_mfma_f32_16x16x32_bf16 a[16:19], v[208:211], v[200:203], a[16:19]
    buffer_load_dwordx4 v[152:155], v1, s[16:19], s24 offen offset:3072
    v_mfma_f32_16x16x32_bf16 a[20:23], v[208:211], v[204:207], a[20:23]
    buffer_load_dwordx4 v[156:159], v1, s[16:19], s25 offen offset:0
    v_mfma_f32_16x16x32_bf16 a[24:27], v[212:215], v[184:187], a[24:27]
    buffer_load_dwordx4 v[160:163], v1, s[16:19], s25 offen offset:1024
    v_mfma_f32_16x16x32_bf16 a[28:31], v[212:215], v[188:191], a[28:31]
    buffer_load_dwordx4 v[164:167], v1, s[16:19], s26 offen offset:0
    v_mfma_f32_16x16x32_bf16 a[32:35], v[212:215], v[192:195], a[32:35]
    buffer_load_dwordx4 v[168:171], v1, s[16:19], s26 offen offset:1024
    v_mfma_f32_16x16x32_bf16 a[36:39], v[212:215], v[196:199], a[36:39]
    buffer_load_dwordx4 v[172:175], v1, s[16:19], s26 offen offset:2048
    v_mfma_f32_16x16x32_bf16 a[40:43], v[212:215], v[200:203], a[40:43]
    buffer_load_dwordx4 v[176:179], v1, s[16:19], s26 offen offset:3072
    v_mfma_f32_16x16x32_bf16 a[44:47], v[212:215], v[204:207], a[44:47]
    buffer_load_dwordx4 v[180:183], v1, s[16:19], s27 offen offset:0
    v_mfma_f32_16x16x32_bf16 a[48:51], v[216:219], v[184:187], a[48:51]
    s_add_u32 s24, s24, 6144
    v_mfma_f32_16x16x32_bf16 a[52:55], v[216:219], v[188:191], a[52:55]
    s_add_u32 s25, s25, 6144
    v_mfma_f32_16x16x32_bf16 a[56:59], v[216:219], v[192:195], a[56:59]
    s_add_u32 s26, s26, 5120
    v_mfma_f32_16x16x32_bf16 a[60:63], v[216:219], v[196:199], a[60:63]
    s_add_u32 s27, s27, 5120
    v_mfma_f32_16x16x32_bf16 a[64:67], v[216:219], v[200:203], a[64:67]
    v_mfma_f32_16x16x32_bf16 a[68:71], v[216:219], v[204:207], a[68:71]
    v_mfma_f32_16x16x32_bf16 a[72:75], v[220:223], v[184:187], a[72:75]
    v_mfma_f32_16x16x32_bf16 a[76:79], v[220:223], v[188:191], a[76:79]
    v_mfma_f32_16x16x32_bf16 a[80:83], v[220:223], v[192:195], a[80:83]
    v_mfma_f32_16x16x32_bf16 a[84:87], v[220:223], v[196:199], a[84:87]
    v_mfma_f32_16x16x32_bf16 a[88:91], v[220:223], v[200:203], a[88:91]
    v_mfma_f32_16x16x32_bf16 a[92:95], v[220:223], v[204:207], a[92:95]
    v_mfma_f32_16x16x32_bf16 a[96:99], v[224:227], v[184:187], a[96:99]
    v_mfma_f32_16x16x32_bf16 a[100:103], v[224:227], v[188:191], a[100:103]
    v_mfma_f32_16x16x32_bf16 a[104:107], v[224:227], v[192:195], a[104:107]
    v_mfma_f32_16x16x32_bf16 a[108:111], v[224:227], v[196:199], a[108:111]
    v_mfma_f32_16x16x32_bf16 a[112:115], v[224:227], v[200:203], a[112:115]
    v_mfma_f32_16x16x32_bf16 a[116:119], v[224:227], v[204:207], a[116:119]
    s_waitcnt vmcnt(33)
    v_mfma_f32_16x16x32_bf16 a[0:3], v[32:35], v[8:11], a[0:3]
    v_mfma_f32_16x16x32_bf16 a[4:7], v[32:35], v[12:15], a[4:7]
    buffer_load_dwordx4 v[184:187], v1, s[16:19], s24 offen offset:0
    v_mfma_f32_16x16x32_bf16 a[8:11], v[32:35], v[16:19], a[8:11]
    buffer_load_dwordx4 v[188:191], v1, s[16:19], s24 offen offset:1024
    v_mfma_f32_16x16x32_bf16 a[12:15], v[32:35], v[20:23], a[12:15]
    buffer_load_dwordx4 v[192:195], v1, s[16:19], s24 offen offset:2048
    v_mfma_f32_16x16x32_bf16 a[16:19], v[32:35], v[24:27], a[16:19]
    buffer_load_dwordx4 v[196:199], v1, s[16:19], s24 offen offset:3072
    v_mfma_f32_16x16x32_bf16 a[20:23], v[32:35], v[28:31], a[20:23]
    buffer_load_dwordx4 v[200:203], v1, s[16:19], s25 offen offset:0
    v_mfma_f32_16x16x32_bf16 a[24:27], v[36:39], v[8:11], a[24:27]
    buffer_load_dwordx4 v[204:207], v1, s[16:19], s25 offen offset:1024
    v_mfma_f32_16x16x32_bf16 a[28:31], v[36:39], v[12:15], a[28:31]
    buffer_load_dwordx4 v[208:211], v1, s[16:19], s26 offen offset:0
    v_mfma_f32_16x16x32_bf16 a[32:35], v[36:39], v[16:19], a[32:35]
    buffer_load_dwordx4 v[212:215], v1, s[16:19], s26 offen offset:1024
    v_mfma_f32_16x16x32_bf16 a[36:39], v[36:39], v[20:23], a[36:39]
    buffer_load_dwordx4 v[216:219], v1, s[16:19], s26 offen offset:2048
    v_mfma_f32_16x16x32_bf16 a[40:43], v[36:39], v[24:27], a[40:43]
    buffer_load_dwordx4 v[220:223], v1, s[16:19], s26 offen offset:3072
    v_mfma_f32_16x16x32_bf16 a[44:47], v[36:39], v[28:31], a[44:47]
    buffer_load_dwordx4 v[224:227], v1, s[16:19], s27 offen offset:0
    v_mfma_f32_16x16x32_bf16 a[48:51], v[40:43], v[8:11], a[48:51]
    s_add_u32 s24, s24, 6144
    v_mfma_f32_16x16x32_bf16 a[52:55], v[40:43], v[12:15], a[52:55]
    s_add_u32 s25, s25, 6144
    v_mfma_f32_16x16x32_bf16 a[56:59], v[40:43], v[16:19], a[56:59]
    s_add_u32 s26, s26, 5120
    v_mfma_f32_16x16x32_bf16 a[60:63], v[40:43], v[20:23], a[60:63]
    s_add_u32 s27, s27, 5120
    v_mfma_f32_16x16x32_bf16 a[64:67], v[40:43], v[24:27], a[64:67]
    v_mfma_f32_16x16x32_bf16 a[68:71], v[40:43], v[28:31], a[68:71]
    v_mfma_f32_16x16x32_bf16 a[72:75], v[44:47], v[8:11], a[72:75]
    v_mfma_f32_16x16x32_bf16 a[76:79], v[44:47], v[12:15], a[76:79]
    v_mfma_f32_16x16x32_bf16 a[80:83], v[44:47], v[16:19], a[80:83]
    v_mfma_f32_16x16x32_bf16 a[84:87], v[44:47], v[20:23], a[84:87]
    v_mfma_f32_16x16x32_bf16 a[88:91], v[44:47], v[24:27], a[88:91]
    v_mfma_f32_16x16x32_bf16 a[92:95], v[44:47], v[28:31], a[92:95]
    v_mfma_f32_16x16x32_bf16 a[96:99], v[48:51], v[8:11], a[96:99]
    v_mfma_f32_16x16x32_bf16 a[100:103], v[48:51], v[12:15], a[100:103]
    v_mfma_f32_16x16x32_bf16 a[104:107], v[48:51], v[16:19], a[104:107]
    v_mfma_f32_16x16x32_bf16 a[108:111], v[48:51], v[20:23], a[108:111]
    v_mfma_f32_16x16x32_bf16 a[112:115], v[48:51], v[24:27], a[112:115]
    v_mfma_f32_16x16x32_bf16 a[116:119], v[48:51], v[28:31], a[116:119]
    s_waitcnt vmcnt(33)
    v_mfma_f32_16x16x32_bf16 a[0:3], v[76:79], v[52:55], a[0:3]
    v_mfma_f32_16x16x32_bf16 a[4:7], v[76:79], v[56:59], a[4:7]
    buffer_load_dwordx4 v[8:11], v1, s[16:19], s24 offen offset:0
    v_mfma_f32_16x16x32_bf16 a[8:11], v[76:79], v[60:63], a[8:11]
    buffer_load_dwordx4 v[12:15], v1, s[16:19], s24 offen offset:1024
    v_mfma_f32_16x16x32_bf16 a[12:15], v[76:79], v[64:67], a[12:15]
    buffer_load_dwordx4 v[16:19], v1, s[16:19], s24 offen offset:2048
    v_mfma_f32_16x16x32_bf16 a[16:19], v[76:79], v[68:71], a[16:19]
    buffer_load_dwordx4 v[20:23], v1, s[16:19], s24 offen offset:3072
    v_mfma_f32_16x16x32_bf16 a[20:23], v[76:79], v[72:75], a[20:23]
    buffer_load_dwordx4 v[24:27], v1, s[16:19], s25 offen offset:0
    v_mfma_f32_16x16x32_bf16 a[24:27], v[80:83], v[52:55], a[24:27]
    buffer_load_dwordx4 v[28:31], v1, s[16:19], s25 offen offset:1024
    v_mfma_f32_16x16x32_bf16 a[28:31], v[80:83], v[56:59], a[28:31]
    buffer_load_dwordx4 v[32:35], v1, s[16:19], s26 offen offset:0
    v_mfma_f32_16x16x32_bf16 a[32:35], v[80:83], v[60:63], a[32:35]
    buffer_load_dwordx4 v[36:39], v1, s[16:19], s26 offen offset:1024
    v_mfma_f32_16x16x32_bf16 a[36:39], v[80:83], v[64:67], a[36:39]
    buffer_load_dwordx4 v[40:43], v1, s[16:19], s26 offen offset:2048
    v_mfma_f32_16x16x32_bf16 a[40:43], v[80:83], v[68:71], a[40:43]
    buffer_load_dwordx4 v[44:47], v1, s[16:19], s26 offen offset:3072
    v_mfma_f32_16x16x32_bf16 a[44:47], v[80:83], v[72:75], a[44:47]
    buffer_load_dwordx4 v[48:51], v1, s[16:19], s27 offen offset:0
    v_mfma_f32_16x16x32_bf16 a[48:51], v[84:87], v[52:55], a[48:51]
    s_add_u32 s24, s24, 6144
    v_mfma_f32_16x16x32_bf16 a[52:55], v[84:87], v[56:59], a[52:55]
    s_add_u32 s25, s25, 6144
    v_mfma_f32_16x16x32_bf16 a[56:59], v[84:87], v[60:63], a[56:59]
    s_add_u32 s26, s26, 5120
    v_mfma_f32_16x16x32_bf16 a[60:63], v[84:87], v[64:67], a[60:63]
    s_add_u32 s27, s27, 5120
    v_mfma_f32_16x16x32_bf16 a[64:67], v[84:87], v[68:71], a[64:67]
    v_mfma_f32_16x16x32_bf16 a[68:71], v[84:87], v[72:75], a[68:71]
    v_mfma_f32_16x16x32_bf16 a[72:75], v[88:91], v[52:55], a[72:75]
    v_mfma_f32_16x16x32_bf16 a[76:79], v[88:91], v[56:59], a[76:79]
    v_mfma_f32_16x16x32_bf16 a[80:83], v[88:91], v[60:63], a[80:83]
    v_mfma_f32_16x16x32_bf16 a[84:87], v[88:91], v[64:67], a[84:87]
    v_mfma_f32_16x16x32_bf16 a[88:91], v[88:91], v[68:71], a[88:91]
    v_mfma_f32_16x16x32_bf16 a[92:95], v[88:91], v[72:75], a[92:95]
    v_mfma_f32_16x16x32_bf16 a[96:99], v[92:95], v[52:55], a[96:99]
    v_mfma_f32_16x16x32_bf16 a[100:103], v[92:95], v[56:59], a[100:103]
    v_mfma_f32_16x16x32_bf16 a[104:107], v[92:95], v[60:63], a[104:107]
    v_mfma_f32_16x16x32_bf16 a[108:111], v[92:95], v[64:67], a[108:111]
    v_mfma_f32_16x16x32_bf16 a[112:115], v[92:95], v[68:71], a[112:115]
    v_mfma_f32_16x16x32_bf16 a[116:119], v[92:95], v[72:75], a[116:119]
    s_waitcnt vmcnt(33)
    v_mfma_f32_16x16x32_bf16 a[0:3], v[120:123], v[96:99], a[0:3]
    v_mfma_f32_16x16x32_bf16 a[4:7], v[120:123], v[100:103], a[4:7]
    buffer_load_dwordx4 v[52:55], v1, s[16:19], s24 offen offset:0
    v_mfma_f32_16x16x32_bf16 a[8:11], v[120:123], v[104:107], a[8:11]
    buffer_load_dwordx4 v[56:59], v1, s[16:19], s24 offen offset:1024
    v_mfma_f32_16x16x32_bf16 a[12:15], v[120:123], v[108:111], a[12:15]
    buffer_load_dwordx4 v[60:63], v1, s[16:19], s24 offen offset:2048
    v_mfma_f32_16x16x32_bf16 a[16:19], v[120:123], v[112:115], a[16:19]
    buffer_load_dwordx4 v[64:67], v1, s[16:19], s24 offen offset:3072
    v_mfma_f32_16x16x32_bf16 a[20:23], v[120:123], v[116:119], a[20:23]
    buffer_load_dwordx4 v[68:71], v1, s[16:19], s25 offen offset:0
    v_mfma_f32_16x16x32_bf16 a[24:27], v[124:127], v[96:99], a[24:27]
    buffer_load_dwordx4 v[72:75], v1, s[16:19], s25 offen offset:1024
    v_mfma_f32_16x16x32_bf16 a[28:31], v[124:127], v[100:103], a[28:31]
    buffer_load_dwordx4 v[76:79], v1, s[16:19], s26 offen offset:0
    v_mfma_f32_16x16x32_bf16 a[32:35], v[124:127], v[104:107], a[32:35]
    buffer_load_dwordx4 v[80:83], v1, s[16:19], s26 offen offset:1024
    v_mfma_f32_16x16x32_bf16 a[36:39], v[124:127], v[108:111], a[36:39]
    buffer_load_dwordx4 v[84:87], v1, s[16:19], s26 offen offset:2048
    v_mfma_f32_16x16x32_bf16 a[40:43], v[124:127], v[112:115], a[40:43]
    buffer_load_dwordx4 v[88:91], v1, s[16:19], s26 offen offset:3072
    v_mfma_f32_16x16x32_bf16 a[44:47], v[124:127], v[116:119], a[44:47]
    buffer_load_dwordx4 v[92:95], v1, s[16:19], s27 offen offset:0
    v_mfma_f32_16x16x32_bf16 a[48:51], v[128:131], v[96:99], a[48:51]
    s_add_u32 s24, s24, 6144
    v_mfma_f32_16x16x32_bf16 a[52:55], v[128:131], v[100:103], a[52:55]
    s_add_u32 s25, s25, 6144
    v_mfma_f32_16x16x32_bf16 a[56:59], v[128:131], v[104:107], a[56:59]
    s_add_u32 s26, s26, 5120
    v_mfma_f32_16x16x32_bf16 a[60:63], v[128:131], v[108:111], a[60:63]
    s_add_u32 s27, s27, 5120
    v_mfma_f32_16x16x32_bf16 a[64:67], v[128:131], v[112:115], a[64:67]
    v_mfma_f32_16x16x32_bf16 a[68:71], v[128:131], v[116:119], a[68:71]
    v_mfma_f32_16x16x32_bf16 a[72:75], v[132:135], v[96:99], a[72:75]
    v_mfma_f32_16x16x32_bf16 a[76:79], v[132:135], v[100:103], a[76:79]
    v_mfma_f32_16x16x32_bf16 a[80:83], v[132:135], v[104:107], a[80:83]
    v_mfma_f32_16x16x32_bf16 a[84:87], v[132:135], v[108:111], a[84:87]
    v_mfma_f32_16x16x32_bf16 a[88:91], v[132:135], v[112:115], a[88:91]
    v_mfma_f32_16x16x32_bf16 a[92:95], v[132:135], v[116:119], a[92:95]
    v_mfma_f32_16x16x32_bf16 a[96:99], v[136:139], v[96:99], a[96:99]
    v_mfma_f32_16x16x32_bf16 a[100:103], v[136:139], v[100:103], a[100:103]
    v_mfma_f32_16x16x32_bf16 a[104:107], v[136:139], v[104:107], a[104:107]
    v_mfma_f32_16x16x32_bf16 a[108:111], v[136:139], v[108:111], a[108:111]
    v_mfma_f32_16x16x32_bf16 a[112:115], v[136:139], v[112:115], a[112:115]
    v_mfma_f32_16x16x32_bf16 a[116:119], v[136:139], v[116:119], a[116:119]
    s_waitcnt vmcnt(33)
    v_mfma_f32_16x16x32_bf16 a[0:3], v[164:167], v[140:143], a[0:3]
    v_mfma_f32_16x16x32_bf16 a[4:7], v[164:167], v[144:147], a[4:7]
    buffer_load_dwordx4 v[96:99], v1, s[16:19], s24 offen offset:0
    v_mfma_f32_16x16x32_bf16 a[8:11], v[164:167], v[148:151], a[8:11]
    buffer_load_dwordx4 v[100:103], v1, s[16:19], s24 offen offset:1024
    v_mfma_f32_16x16x32_bf16 a[12:15], v[164:167], v[152:155], a[12:15]
    buffer_load_dwordx4 v[104:107], v1, s[16:19], s24 offen offset:2048
    v_mfma_f32_16x16x32_bf16 a[16:19], v[164:167], v[156:159], a[16:19]
    buffer_load_dwordx4 v[108:111], v1, s[16:19], s24 offen offset:3072
    v_mfma_f32_16x16x32_bf16 a[20:23], v[164:167], v[160:163], a[20:23]
    buffer_load_dwordx4 v[112:115], v1, s[16:19], s25 offen offset:0
    v_mfma_f32_16x16x32_bf16 a[24:27], v[168:171], v[140:143], a[24:27]
    buffer_load_dwordx4 v[116:119], v1, s[16:19], s25 offen offset:1024
    v_mfma_f32_16x16x32_bf16 a[28:31], v[168:171], v[144:147], a[28:31]
    buffer_load_dwordx4 v[120:123], v1, s[16:19], s26 offen offset:0
    v_mfma_f32_16x16x32_bf16 a[32:35], v[168:171], v[148:151], a[32:35]
    buffer_load_dwordx4 v[124:127], v1, s[16:19], s26 offen offset:1024
    v_mfma_f32_16x16x32_bf16 a[36:39], v[168:171], v[152:155], a[36:39]
    buffer_load_dwordx4 v[128:131], v1, s[16:19], s26 offen offset:2048
    v_mfma_f32_16x16x32_bf16 a[40:43], v[168:171], v[156:159], a[40:43]
    buffer_load_dwordx4 v[132:135], v1, s[16:19], s26 offen offset:3072
    v_mfma_f32_16x16x32_bf16 a[44:47], v[168:171], v[160:163], a[44:47]
    buffer_load_dwordx4 v[136:139], v1, s[16:19], s27 offen offset:0
    v_mfma_f32_16x16x32_bf16 a[48:51], v[172:175], v[140:143], a[48:51]
    s_add_u32 s24, s24, 6144
    v_mfma_f32_16x16x32_bf16 a[52:55], v[172:175], v[144:147], a[52:55]
    s_add_u32 s25, s25, 6144
    v_mfma_f32_16x16x32_bf16 a[56:59], v[172:175], v[148:151], a[56:59]
    s_add_u32 s26, s26, 5120
    v_mfma_f32_16x16x32_bf16 a[60:63], v[172:175], v[152:155], a[60:63]
    s_add_u32 s27, s27, 5120
    v_mfma_f32_16x16x32_bf16 a[64:67], v[172:175], v[156:159], a[64:67]
    v_mfma_f32_16x16x32_bf16 a[68:71], v[172:175], v[160:163], a[68:71]
    v_mfma_f32_16x16x32_bf16 a[72:75], v[176:179], v[140:143], a[72:75]
    v_mfma_f32_16x16x32_bf16 a[76:79], v[176:179], v[144:147], a[76:79]
    v_mfma_f32_16x16x32_bf16 a[80:83], v[176:179], v[148:151], a[80:83]
    v_mfma_f32_16x16x32_bf16 a[84:87], v[176:179], v[152:155], a[84:87]
    v_mfma_f32_16x16x32_bf16 a[88:91], v[176:179], v[156:159], a[88:91]
    v_mfma_f32_16x16x32_bf16 a[92:95], v[176:179], v[160:163], a[92:95]
    v_mfma_f32_16x16x32_bf16 a[96:99], v[180:183], v[140:143], a[96:99]
    v_mfma_f32_16x16x32_bf16 a[100:103], v[180:183], v[144:147], a[100:103]
    v_mfma_f32_16x16x32_bf16 a[104:107], v[180:183], v[148:151], a[104:107]
    v_mfma_f32_16x16x32_bf16 a[108:111], v[180:183], v[152:155], a[108:111]
    v_mfma_f32_16x16x32_bf16 a[112:115], v[180:183], v[156:159], a[112:115]
    v_mfma_f32_16x16x32_bf16 a[116:119], v[180:183], v[160:163], a[116:119]
    s_waitcnt vmcnt(33)
    v_mfma_f32_16x16x32_bf16 a[0:3], v[208:211], v[184:187], a[0:3]
    v_mfma_f32_16x16x32_bf16 a[4:7], v[208:211], v[188:191], a[4:7]
    buffer_load_dwordx4 v[140:143], v1, s[16:19], s24 offen offset:0
    v_mfma_f32_16x16x32_bf16 a[8:11], v[208:211], v[192:195], a[8:11]
    buffer_load_dwordx4 v[144:147], v1, s[16:19], s24 offen offset:1024
    v_mfma_f32_16x16x32_bf16 a[12:15], v[208:211], v[196:199], a[12:15]
    buffer_load_dwordx4 v[148:151], v1, s[16:19], s24 offen offset:2048
    v_mfma_f32_16x16x32_bf16 a[16:19], v[208:211], v[200:203], a[16:19]
    buffer_load_dwordx4 v[152:155], v1, s[16:19], s24 offen offset:3072
    v_mfma_f32_16x16x32_bf16 a[20:23], v[208:211], v[204:207], a[20:23]
    buffer_load_dwordx4 v[156:159], v1, s[16:19], s25 offen offset:0
    v_mfma_f32_16x16x32_bf16 a[24:27], v[212:215], v[184:187], a[24:27]
    buffer_load_dwordx4 v[160:163], v1, s[16:19], s25 offen offset:1024
    v_mfma_f32_16x16x32_bf16 a[28:31], v[212:215], v[188:191], a[28:31]
    buffer_load_dwordx4 v[164:167], v1, s[16:19], s26 offen offset:0
    v_mfma_f32_16x16x32_bf16 a[32:35], v[212:215], v[192:195], a[32:35]
    buffer_load_dwordx4 v[168:171], v1, s[16:19], s26 offen offset:1024
    v_mfma_f32_16x16x32_bf16 a[36:39], v[212:215], v[196:199], a[36:39]
    buffer_load_dwordx4 v[172:175], v1, s[16:19], s26 offen offset:2048
    v_mfma_f32_16x16x32_bf16 a[40:43], v[212:215], v[200:203], a[40:43]
    buffer_load_dwordx4 v[176:179], v1, s[16:19], s26 offen offset:3072
    v_mfma_f32_16x16x32_bf16 a[44:47], v[212:215], v[204:207], a[44:47]
    buffer_load_dwordx4 v[180:183], v1, s[16:19], s27 offen offset:0
    v_mfma_f32_16x16x32_bf16 a[48:51], v[216:219], v[184:187], a[48:51]
    s_add_u32 s24, s24, 6144
    v_mfma_f32_16x16x32_bf16 a[52:55], v[216:219], v[188:191], a[52:55]
    s_add_u32 s25, s25, 6144
    v_mfma_f32_16x16x32_bf16 a[56:59], v[216:219], v[192:195], a[56:59]
    s_add_u32 s26, s26, 5120
    v_mfma_f32_16x16x32_bf16 a[60:63], v[216:219], v[196:199], a[60:63]
    s_add_u32 s27, s27, 5120
    v_mfma_f32_16x16x32_bf16 a[64:67], v[216:219], v[200:203], a[64:67]
    v_mfma_f32_16x16x32_bf16 a[68:71], v[216:219], v[204:207], a[68:71]
    v_mfma_f32_16x16x32_bf16 a[72:75], v[220:223], v[184:187], a[72:75]
    v_mfma_f32_16x16x32_bf16 a[76:79], v[220:223], v[188:191], a[76:79]
    v_mfma_f32_16x16x32_bf16 a[80:83], v[220:223], v[192:195], a[80:83]
    v_mfma_f32_16x16x32_bf16 a[84:87], v[220:223], v[196:199], a[84:87]
    v_mfma_f32_16x16x32_bf16 a[88:91], v[220:223], v[200:203], a[88:91]
    v_mfma_f32_16x16x32_bf16 a[92:95], v[220:223], v[204:207], a[92:95]
    v_mfma_f32_16x16x32_bf16 a[96:99], v[224:227], v[184:187], a[96:99]
    v_mfma_f32_16x16x32_bf16 a[100:103], v[224:227], v[188:191], a[100:103]
    v_mfma_f32_16x16x32_bf16 a[104:107], v[224:227], v[192:195], a[104:107]
    v_mfma_f32_16x16x32_bf16 a[108:111], v[224:227], v[196:199], a[108:111]
    v_mfma_f32_16x16x32_bf16 a[112:115], v[224:227], v[200:203], a[112:115]
    v_mfma_f32_16x16x32_bf16 a[116:119], v[224:227], v[204:207], a[116:119]
    s_waitcnt vmcnt(33)
    v_mfma_f32_16x16x32_bf16 a[0:3], v[32:35], v[8:11], a[0:3]
    v_mfma_f32_16x16x32_bf16 a[4:7], v[32:35], v[12:15], a[4:7]
    buffer_load_dwordx4 v[184:187], v1, s[16:19], s24 offen offset:0
    v_mfma_f32_16x16x32_bf16 a[8:11], v[32:35], v[16:19], a[8:11]
    buffer_load_dwordx4 v[188:191], v1, s[16:19], s24 offen offset:1024
    v_mfma_f32_16x16x32_bf16 a[12:15], v[32:35], v[20:23], a[12:15]
    buffer_load_dwordx4 v[192:195], v1, s[16:19], s24 offen offset:2048
    v_mfma_f32_16x16x32_bf16 a[16:19], v[32:35], v[24:27], a[16:19]
    buffer_load_dwordx4 v[196:199], v1, s[16:19], s24 offen offset:3072
    v_mfma_f32_16x16x32_bf16 a[20:23], v[32:35], v[28:31], a[20:23]
    buffer_load_dwordx4 v[200:203], v1, s[16:19], s25 offen offset:0
    v_mfma_f32_16x16x32_bf16 a[24:27], v[36:39], v[8:11], a[24:27]
    buffer_load_dwordx4 v[204:207], v1, s[16:19], s25 offen offset:1024
    v_mfma_f32_16x16x32_bf16 a[28:31], v[36:39], v[12:15], a[28:31]
    buffer_load_dwordx4 v[208:211], v1, s[16:19], s26 offen offset:0
    v_mfma_f32_16x16x32_bf16 a[32:35], v[36:39], v[16:19], a[32:35]
    buffer_load_dwordx4 v[212:215], v1, s[16:19], s26 offen offset:1024
    v_mfma_f32_16x16x32_bf16 a[36:39], v[36:39], v[20:23], a[36:39]
    buffer_load_dwordx4 v[216:219], v1, s[16:19], s26 offen offset:2048
    v_mfma_f32_16x16x32_bf16 a[40:43], v[36:39], v[24:27], a[40:43]
    buffer_load_dwordx4 v[220:223], v1, s[16:19], s26 offen offset:3072
    v_mfma_f32_16x16x32_bf16 a[44:47], v[36:39], v[28:31], a[44:47]
    buffer_load_dwordx4 v[224:227], v1, s[16:19], s27 offen offset:0
    v_mfma_f32_16x16x32_bf16 a[48:51], v[40:43], v[8:11], a[48:51]
    s_add_u32 s24, s24, 6144
    v_mfma_f32_16x16x32_bf16 a[52:55], v[40:43], v[12:15], a[52:55]
    s_add_u32 s25, s25, 6144
    v_mfma_f32_16x16x32_bf16 a[56:59], v[40:43], v[16:19], a[56:59]
    s_add_u32 s26, s26, 5120
    v_mfma_f32_16x16x32_bf16 a[60:63], v[40:43], v[20:23], a[60:63]
    s_add_u32 s27, s27, 5120
    v_mfma_f32_16x16x32_bf16 a[64:67], v[40:43], v[24:27], a[64:67]
    v_mfma_f32_16x16x32_bf16 a[68:71], v[40:43], v[28:31], a[68:71]
    v_mfma_f32_16x16x32_bf16 a[72:75], v[44:47], v[8:11], a[72:75]
    v_mfma_f32_16x16x32_bf16 a[76:79], v[44:47], v[12:15], a[76:79]
    v_mfma_f32_16x16x32_bf16 a[80:83], v[44:47], v[16:19], a[80:83]
    v_mfma_f32_16x16x32_bf16 a[84:87], v[44:47], v[20:23], a[84:87]
    v_mfma_f32_16x16x32_bf16 a[88:91], v[44:47], v[24:27], a[88:91]
    v_mfma_f32_16x16x32_bf16 a[92:95], v[44:47], v[28:31], a[92:95]
    v_mfma_f32_16x16x32_bf16 a[96:99], v[48:51], v[8:11], a[96:99]
    v_mfma_f32_16x16x32_bf16 a[100:103], v[48:51], v[12:15], a[100:103]
    v_mfma_f32_16x16x32_bf16 a[104:107], v[48:51], v[16:19], a[104:107]
    v_mfma_f32_16x16x32_bf16 a[108:111], v[48:51], v[20:23], a[108:111]
    v_mfma_f32_16x16x32_bf16 a[112:115], v[48:51], v[24:27], a[112:115]
    v_mfma_f32_16x16x32_bf16 a[116:119], v[48:51], v[28:31], a[116:119]
    s_waitcnt vmcnt(33)
    v_mfma_f32_16x16x32_bf16 a[0:3], v[76:79], v[52:55], a[0:3]
    v_mfma_f32_16x16x32_bf16 a[4:7], v[76:79], v[56:59], a[4:7]
    buffer_load_dwordx4 v[8:11], v1, s[16:19], s24 offen offset:0
    v_mfma_f32_16x16x32_bf16 a[8:11], v[76:79], v[60:63], a[8:11]
    buffer_load_dwordx4 v[12:15], v1, s[16:19], s24 offen offset:1024
    v_mfma_f32_16x16x32_bf16 a[12:15], v[76:79], v[64:67], a[12:15]
    buffer_load_dwordx4 v[16:19], v1, s[16:19], s24 offen offset:2048
    v_mfma_f32_16x16x32_bf16 a[16:19], v[76:79], v[68:71], a[16:19]
    buffer_load_dwordx4 v[20:23], v1, s[16:19], s24 offen offset:3072
    v_mfma_f32_16x16x32_bf16 a[20:23], v[76:79], v[72:75], a[20:23]
    buffer_load_dwordx4 v[24:27], v1, s[16:19], s25 offen offset:0
    v_mfma_f32_16x16x32_bf16 a[24:27], v[80:83], v[52:55], a[24:27]
    buffer_load_dwordx4 v[28:31], v1, s[16:19], s25 offen offset:1024
    v_mfma_f32_16x16x32_bf16 a[28:31], v[80:83], v[56:59], a[28:31]
    buffer_load_dwordx4 v[32:35], v1, s[16:19], s26 offen offset:0
    v_mfma_f32_16x16x32_bf16 a[32:35], v[80:83], v[60:63], a[32:35]
    buffer_load_dwordx4 v[36:39], v1, s[16:19], s26 offen offset:1024
    v_mfma_f32_16x16x32_bf16 a[36:39], v[80:83], v[64:67], a[36:39]
    buffer_load_dwordx4 v[40:43], v1, s[16:19], s26 offen offset:2048
    v_mfma_f32_16x16x32_bf16 a[40:43], v[80:83], v[68:71], a[40:43]
    buffer_load_dwordx4 v[44:47], v1, s[16:19], s26 offen offset:3072
    v_mfma_f32_16x16x32_bf16 a[44:47], v[80:83], v[72:75], a[44:47]
    buffer_load_dwordx4 v[48:51], v1, s[16:19], s27 offen offset:0
    v_mfma_f32_16x16x32_bf16 a[48:51], v[84:87], v[52:55], a[48:51]
    s_add_u32 s24, s24, 6144
    v_mfma_f32_16x16x32_bf16 a[52:55], v[84:87], v[56:59], a[52:55]
    s_add_u32 s25, s25, 6144
    v_mfma_f32_16x16x32_bf16 a[56:59], v[84:87], v[60:63], a[56:59]
    s_add_u32 s26, s26, 5120
    v_mfma_f32_16x16x32_bf16 a[60:63], v[84:87], v[64:67], a[60:63]
    s_add_u32 s27, s27, 5120
    v_mfma_f32_16x16x32_bf16 a[64:67], v[84:87], v[68:71], a[64:67]
    v_mfma_f32_16x16x32_bf16 a[68:71], v[84:87], v[72:75], a[68:71]
    v_mfma_f32_16x16x32_bf16 a[72:75], v[88:91], v[52:55], a[72:75]
    v_mfma_f32_16x16x32_bf16 a[76:79], v[88:91], v[56:59], a[76:79]
    v_mfma_f32_16x16x32_bf16 a[80:83], v[88:91], v[60:63], a[80:83]
    v_mfma_f32_16x16x32_bf16 a[84:87], v[88:91], v[64:67], a[84:87]
    v_mfma_f32_16x16x32_bf16 a[88:91], v[88:91], v[68:71], a[88:91]
    v_mfma_f32_16x16x32_bf16 a[92:95], v[88:91], v[72:75], a[92:95]
    v_mfma_f32_16x16x32_bf16 a[96:99], v[92:95], v[52:55], a[96:99]
    v_mfma_f32_16x16x32_bf16 a[100:103], v[92:95], v[56:59], a[100:103]
    v_mfma_f32_16x16x32_bf16 a[104:107], v[92:95], v[60:63], a[104:107]
    v_mfma_f32_16x16x32_bf16 a[108:111], v[92:95], v[64:67], a[108:111]
    v_mfma_f32_16x16x32_bf16 a[112:115], v[92:95], v[68:71], a[112:115]
    v_mfma_f32_16x16x32_bf16 a[116:119], v[92:95], v[72:75], a[116:119]
    s_waitcnt vmcnt(33)
    v_mfma_f32_16x16x32_bf16 a[0:3], v[120:123], v[96:99], a[0:3]
    v_mfma_f32_16x16x32_bf16 a[4:7], v[120:123], v[100:103], a[4:7]
    buffer_load_dwordx4 v[52:55], v1, s[16:19], s24 offen offset:0
    v_mfma_f32_16x16x32_bf16 a[8:11], v[120:123], v[104:107], a[8:11]
    buffer_load_dwordx4 v[56:59], v1, s[16:19], s24 offen offset:1024
    v_mfma_f32_16x16x32_bf16 a[12:15], v[120:123], v[108:111], a[12:15]
    buffer_load_dwordx4 v[60:63], v1, s[16:19], s24 offen offset:2048
    v_mfma_f32_16x16x32_bf16 a[16:19], v[120:123], v[112:115], a[16:19]
    buffer_load_dwordx4 v[64:67], v1, s[16:19], s24 offen offset:3072
    v_mfma_f32_16x16x32_bf16 a[20:23], v[120:123], v[116:119], a[20:23]
    buffer_load_dwordx4 v[68:71], v1, s[16:19], s25 offen offset:0
    v_mfma_f32_16x16x32_bf16 a[24:27], v[124:127], v[96:99], a[24:27]
    buffer_load_dwordx4 v[72:75], v1, s[16:19], s25 offen offset:1024
    v_mfma_f32_16x16x32_bf16 a[28:31], v[124:127], v[100:103], a[28:31]
    buffer_load_dwordx4 v[76:79], v1, s[16:19], s26 offen offset:0
    v_mfma_f32_16x16x32_bf16 a[32:35], v[124:127], v[104:107], a[32:35]
    buffer_load_dwordx4 v[80:83], v1, s[16:19], s26 offen offset:1024
    v_mfma_f32_16x16x32_bf16 a[36:39], v[124:127], v[108:111], a[36:39]
    buffer_load_dwordx4 v[84:87], v1, s[16:19], s26 offen offset:2048
    v_mfma_f32_16x16x32_bf16 a[40:43], v[124:127], v[112:115], a[40:43]
    buffer_load_dwordx4 v[88:91], v1, s[16:19], s26 offen offset:3072
    v_mfma_f32_16x16x32_bf16 a[44:47], v[124:127], v[116:119], a[44:47]
    buffer_load_dwordx4 v[92:95], v1, s[16:19], s27 offen offset:0
    v_mfma_f32_16x16x32_bf16 a[48:51], v[128:131], v[96:99], a[48:51]
    s_add_u32 s24, s24, 6144
    v_mfma_f32_16x16x32_bf16 a[52:55], v[128:131], v[100:103], a[52:55]
    s_add_u32 s25, s25, 6144
    v_mfma_f32_16x16x32_bf16 a[56:59], v[128:131], v[104:107], a[56:59]
    s_add_u32 s26, s26, 5120
    v_mfma_f32_16x16x32_bf16 a[60:63], v[128:131], v[108:111], a[60:63]
    s_add_u32 s27, s27, 5120
    v_mfma_f32_16x16x32_bf16 a[64:67], v[128:131], v[112:115], a[64:67]
    v_mfma_f32_16x16x32_bf16 a[68:71], v[128:131], v[116:119], a[68:71]
    v_mfma_f32_16x16x32_bf16 a[72:75], v[132:135], v[96:99], a[72:75]
    v_mfma_f32_16x16x32_bf16 a[76:79], v[132:135], v[100:103], a[76:79]
    v_mfma_f32_16x16x32_bf16 a[80:83], v[132:135], v[104:107], a[80:83]
    v_mfma_f32_16x16x32_bf16 a[84:87], v[132:135], v[108:111], a[84:87]
    v_mfma_f32_16x16x32_bf16 a[88:91], v[132:135], v[112:115], a[88:91]
    v_mfma_f32_16x16x32_bf16 a[92:95], v[132:135], v[116:119], a[92:95]
    v_mfma_f32_16x16x32_bf16 a[96:99], v[136:139], v[96:99], a[96:99]
    v_mfma_f32_16x16x32_bf16 a[100:103], v[136:139], v[100:103], a[100:103]
    v_mfma_f32_16x16x32_bf16 a[104:107], v[136:139], v[104:107], a[104:107]
    v_mfma_f32_16x16x32_bf16 a[108:111], v[136:139], v[108:111], a[108:111]
    v_mfma_f32_16x16x32_bf16 a[112:115], v[136:139], v[112:115], a[112:115]
    v_mfma_f32_16x16x32_bf16 a[116:119], v[136:139], v[116:119], a[116:119]
    s_waitcnt vmcnt(33)
    v_mfma_f32_16x16x32_bf16 a[0:3], v[164:167], v[140:143], a[0:3]
    v_mfma_f32_16x16x32_bf16 a[4:7], v[164:167], v[144:147], a[4:7]
    buffer_load_dwordx4 v[96:99], v1, s[16:19], s24 offen offset:0
    v_mfma_f32_16x16x32_bf16 a[8:11], v[164:167], v[148:151], a[8:11]
    buffer_load_dwordx4 v[100:103], v1, s[16:19], s24 offen offset:1024
    v_mfma_f32_16x16x32_bf16 a[12:15], v[164:167], v[152:155], a[12:15]
    buffer_load_dwordx4 v[104:107], v1, s[16:19], s24 offen offset:2048
    v_mfma_f32_16x16x32_bf16 a[16:19], v[164:167], v[156:159], a[16:19]
    buffer_load_dwordx4 v[108:111], v1, s[16:19], s24 offen offset:3072
    v_mfma_f32_16x16x32_bf16 a[20:23], v[164:167], v[160:163], a[20:23]
    buffer_load_dwordx4 v[112:115], v1, s[16:19], s25 offen offset:0
    v_mfma_f32_16x16x32_bf16 a[24:27], v[168:171], v[140:143], a[24:27]
    buffer_load_dwordx4 v[116:119], v1, s[16:19], s25 offen offset:1024
    v_mfma_f32_16x16x32_bf16 a[28:31], v[168:171], v[144:147], a[28:31]
    buffer_load_dwordx4 v[120:123], v1, s[16:19], s26 offen offset:0
    v_mfma_f32_16x16x32_bf16 a[32:35], v[168:171], v[148:151], a[32:35]
    buffer_load_dwordx4 v[124:127], v1, s[16:19], s26 offen offset:1024
    v_mfma_f32_16x16x32_bf16 a[36:39], v[168:171], v[152:155], a[36:39]
    buffer_load_dwordx4 v[128:131], v1, s[16:19], s26 offen offset:2048
    v_mfma_f32_16x16x32_bf16 a[40:43], v[168:171], v[156:159], a[40:43]
    buffer_load_dwordx4 v[132:135], v1, s[16:19], s26 offen offset:3072
    v_mfma_f32_16x16x32_bf16 a[44:47], v[168:171], v[160:163], a[44:47]
    buffer_load_dwordx4 v[136:139], v1, s[16:19], s27 offen offset:0
    v_mfma_f32_16x16x32_bf16 a[48:51], v[172:175], v[140:143], a[48:51]
    s_add_u32 s24, s24, 6144
    v_mfma_f32_16x16x32_bf16 a[52:55], v[172:175], v[144:147], a[52:55]
    s_add_u32 s25, s25, 6144
    v_mfma_f32_16x16x32_bf16 a[56:59], v[172:175], v[148:151], a[56:59]
    s_add_u32 s26, s26, 5120
    v_mfma_f32_16x16x32_bf16 a[60:63], v[172:175], v[152:155], a[60:63]
    s_add_u32 s27, s27, 5120
    v_mfma_f32_16x16x32_bf16 a[64:67], v[172:175], v[156:159], a[64:67]
    v_mfma_f32_16x16x32_bf16 a[68:71], v[172:175], v[160:163], a[68:71]
    v_mfma_f32_16x16x32_bf16 a[72:75], v[176:179], v[140:143], a[72:75]
    v_mfma_f32_16x16x32_bf16 a[76:79], v[176:179], v[144:147], a[76:79]
    v_mfma_f32_16x16x32_bf16 a[80:83], v[176:179], v[148:151], a[80:83]
    v_mfma_f32_16x16x32_bf16 a[84:87], v[176:179], v[152:155], a[84:87]
    v_mfma_f32_16x16x32_bf16 a[88:91], v[176:179], v[156:159], a[88:91]
    v_mfma_f32_16x16x32_bf16 a[92:95], v[176:179], v[160:163], a[92:95]
    v_mfma_f32_16x16x32_bf16 a[96:99], v[180:183], v[140:143], a[96:99]
    v_mfma_f32_16x16x32_bf16 a[100:103], v[180:183], v[144:147], a[100:103]
    v_mfma_f32_16x16x32_bf16 a[104:107], v[180:183], v[148:151], a[104:107]
    v_mfma_f32_16x16x32_bf16 a[108:111], v[180:183], v[152:155], a[108:111]
    v_mfma_f32_16x16x32_bf16 a[112:115], v[180:183], v[156:159], a[112:115]
    v_mfma_f32_16x16x32_bf16 a[116:119], v[180:183], v[160:163], a[116:119]
    s_waitcnt vmcnt(33)
    v_mfma_f32_16x16x32_bf16 a[0:3], v[208:211], v[184:187], a[0:3]
    v_mfma_f32_16x16x32_bf16 a[4:7], v[208:211], v[188:191], a[4:7]
    buffer_load_dwordx4 v[140:143], v1, s[16:19], s24 offen offset:0
    v_mfma_f32_16x16x32_bf16 a[8:11], v[208:211], v[192:195], a[8:11]
    buffer_load_dwordx4 v[144:147], v1, s[16:19], s24 offen offset:1024
    v_mfma_f32_16x16x32_bf16 a[12:15], v[208:211], v[196:199], a[12:15]
    buffer_load_dwordx4 v[148:151], v1, s[16:19], s24 offen offset:2048
    v_mfma_f32_16x16x32_bf16 a[16:19], v[208:211], v[200:203], a[16:19]
    buffer_load_dwordx4 v[152:155], v1, s[16:19], s24 offen offset:3072
    v_mfma_f32_16x16x32_bf16 a[20:23], v[208:211], v[204:207], a[20:23]
    buffer_load_dwordx4 v[156:159], v1, s[16:19], s25 offen offset:0
    v_mfma_f32_16x16x32_bf16 a[24:27], v[212:215], v[184:187], a[24:27]
    buffer_load_dwordx4 v[160:163], v1, s[16:19], s25 offen offset:1024
    v_mfma_f32_16x16x32_bf16 a[28:31], v[212:215], v[188:191], a[28:31]
    buffer_load_dwordx4 v[164:167], v1, s[16:19], s26 offen offset:0
    v_mfma_f32_16x16x32_bf16 a[32:35], v[212:215], v[192:195], a[32:35]
    buffer_load_dwordx4 v[168:171], v1, s[16:19], s26 offen offset:1024
    v_mfma_f32_16x16x32_bf16 a[36:39], v[212:215], v[196:199], a[36:39]
    buffer_load_dwordx4 v[172:175], v1, s[16:19], s26 offen offset:2048
    v_mfma_f32_16x16x32_bf16 a[40:43], v[212:215], v[200:203], a[40:43]
    buffer_load_dwordx4 v[176:179], v1, s[16:19], s26 offen offset:3072
    v_mfma_f32_16x16x32_bf16 a[44:47], v[212:215], v[204:207], a[44:47]
    buffer_load_dwordx4 v[180:183], v1, s[16:19], s27 offen offset:0
    v_mfma_f32_16x16x32_bf16 a[48:51], v[216:219], v[184:187], a[48:51]
    s_add_u32 s24, s24, 6144
    v_mfma_f32_16x16x32_bf16 a[52:55], v[216:219], v[188:191], a[52:55]
    s_add_u32 s25, s25, 6144
    v_mfma_f32_16x16x32_bf16 a[56:59], v[216:219], v[192:195], a[56:59]
    s_add_u32 s26, s26, 5120
    v_mfma_f32_16x16x32_bf16 a[60:63], v[216:219], v[196:199], a[60:63]
    s_add_u32 s27, s27, 5120
    v_mfma_f32_16x16x32_bf16 a[64:67], v[216:219], v[200:203], a[64:67]
    v_mfma_f32_16x16x32_bf16 a[68:71], v[216:219], v[204:207], a[68:71]
    v_mfma_f32_16x16x32_bf16 a[72:75], v[220:223], v[184:187], a[72:75]
    v_mfma_f32_16x16x32_bf16 a[76:79], v[220:223], v[188:191], a[76:79]
    v_mfma_f32_16x16x32_bf16 a[80:83], v[220:223], v[192:195], a[80:83]
    v_mfma_f32_16x16x32_bf16 a[84:87], v[220:223], v[196:199], a[84:87]
    v_mfma_f32_16x16x32_bf16 a[88:91], v[220:223], v[200:203], a[88:91]
    v_mfma_f32_16x16x32_bf16 a[92:95], v[220:223], v[204:207], a[92:95]
    v_mfma_f32_16x16x32_bf16 a[96:99], v[224:227], v[184:187], a[96:99]
    v_mfma_f32_16x16x32_bf16 a[100:103], v[224:227], v[188:191], a[100:103]
    v_mfma_f32_16x16x32_bf16 a[104:107], v[224:227], v[192:195], a[104:107]
    v_mfma_f32_16x16x32_bf16 a[108:111], v[224:227], v[196:199], a[108:111]
    v_mfma_f32_16x16x32_bf16 a[112:115], v[224:227], v[200:203], a[112:115]
    v_mfma_f32_16x16x32_bf16 a[116:119], v[224:227], v[204:207], a[116:119]
    s_waitcnt vmcnt(33)
    v_mfma_f32_16x16x32_bf16 a[0:3], v[32:35], v[8:11], a[0:3]
    v_mfma_f32_16x16x32_bf16 a[4:7], v[32:35], v[12:15], a[4:7]
    buffer_load_dwordx4 v[184:187], v1, s[16:19], s24 offen offset:0
    v_mfma_f32_16x16x32_bf16 a[8:11], v[32:35], v[16:19], a[8:11]
    buffer_load_dwordx4 v[188:191], v1, s[16:19], s24 offen offset:1024
    v_mfma_f32_16x16x32_bf16 a[12:15], v[32:35], v[20:23], a[12:15]
    buffer_load_dwordx4 v[192:195], v1, s[16:19], s24 offen offset:2048
    v_mfma_f32_16x16x32_bf16 a[16:19], v[32:35], v[24:27], a[16:19]
    buffer_load_dwordx4 v[196:199], v1, s[16:19], s24 offen offset:3072
    v_mfma_f32_16x16x32_bf16 a[20:23], v[32:35], v[28:31], a[20:23]
    buffer_load_dwordx4 v[200:203], v1, s[16:19], s25 offen offset:0
    v_mfma_f32_16x16x32_bf16 a[24:27], v[36:39], v[8:11], a[24:27]
    buffer_load_dwordx4 v[204:207], v1, s[16:19], s25 offen offset:1024
    v_mfma_f32_16x16x32_bf16 a[28:31], v[36:39], v[12:15], a[28:31]
    buffer_load_dwordx4 v[208:211], v1, s[16:19], s26 offen offset:0
    v_mfma_f32_16x16x32_bf16 a[32:35], v[36:39], v[16:19], a[32:35]
    buffer_load_dwordx4 v[212:215], v1, s[16:19], s26 offen offset:1024
    v_mfma_f32_16x16x32_bf16 a[36:39], v[36:39], v[20:23], a[36:39]
    buffer_load_dwordx4 v[216:219], v1, s[16:19], s26 offen offset:2048
    v_mfma_f32_16x16x32_bf16 a[40:43], v[36:39], v[24:27], a[40:43]
    buffer_load_dwordx4 v[220:223], v1, s[16:19], s26 offen offset:3072
    v_mfma_f32_16x16x32_bf16 a[44:47], v[36:39], v[28:31], a[44:47]
    buffer_load_dwordx4 v[224:227], v1, s[16:19], s27 offen offset:0
    v_mfma_f32_16x16x32_bf16 a[48:51], v[40:43], v[8:11], a[48:51]
    s_add_u32 s24, s24, 6144
    v_mfma_f32_16x16x32_bf16 a[52:55], v[40:43], v[12:15], a[52:55]
    s_add_u32 s25, s25, 6144
    v_mfma_f32_16x16x32_bf16 a[56:59], v[40:43], v[16:19], a[56:59]
    s_add_u32 s26, s26, 5120
    v_mfma_f32_16x16x32_bf16 a[60:63], v[40:43], v[20:23], a[60:63]
    s_add_u32 s27, s27, 5120
    v_mfma_f32_16x16x32_bf16 a[64:67], v[40:43], v[24:27], a[64:67]
    v_mfma_f32_16x16x32_bf16 a[68:71], v[40:43], v[28:31], a[68:71]
    v_mfma_f32_16x16x32_bf16 a[72:75], v[44:47], v[8:11], a[72:75]
    v_mfma_f32_16x16x32_bf16 a[76:79], v[44:47], v[12:15], a[76:79]
    v_mfma_f32_16x16x32_bf16 a[80:83], v[44:47], v[16:19], a[80:83]
    v_mfma_f32_16x16x32_bf16 a[84:87], v[44:47], v[20:23], a[84:87]
    v_mfma_f32_16x16x32_bf16 a[88:91], v[44:47], v[24:27], a[88:91]
    v_mfma_f32_16x16x32_bf16 a[92:95], v[44:47], v[28:31], a[92:95]
    v_mfma_f32_16x16x32_bf16 a[96:99], v[48:51], v[8:11], a[96:99]
    v_mfma_f32_16x16x32_bf16 a[100:103], v[48:51], v[12:15], a[100:103]
    v_mfma_f32_16x16x32_bf16 a[104:107], v[48:51], v[16:19], a[104:107]
    v_mfma_f32_16x16x32_bf16 a[108:111], v[48:51], v[20:23], a[108:111]
    v_mfma_f32_16x16x32_bf16 a[112:115], v[48:51], v[24:27], a[112:115]
    v_mfma_f32_16x16x32_bf16 a[116:119], v[48:51], v[28:31], a[116:119]
    s_waitcnt vmcnt(33)
    v_mfma_f32_16x16x32_bf16 a[0:3], v[76:79], v[52:55], a[0:3]
    v_mfma_f32_16x16x32_bf16 a[4:7], v[76:79], v[56:59], a[4:7]
    buffer_load_dwordx4 v[8:11], v1, s[16:19], s24 offen offset:0
    v_mfma_f32_16x16x32_bf16 a[8:11], v[76:79], v[60:63], a[8:11]
    buffer_load_dwordx4 v[12:15], v1, s[16:19], s24 offen offset:1024
    v_mfma_f32_16x16x32_bf16 a[12:15], v[76:79], v[64:67], a[12:15]
    buffer_load_dwordx4 v[16:19], v1, s[16:19], s24 offen offset:2048
    v_mfma_f32_16x16x32_bf16 a[16:19], v[76:79], v[68:71], a[16:19]
    buffer_load_dwordx4 v[20:23], v1, s[16:19], s24 offen offset:3072
    v_mfma_f32_16x16x32_bf16 a[20:23], v[76:79], v[72:75], a[20:23]
    buffer_load_dwordx4 v[24:27], v1, s[16:19], s25 offen offset:0
    v_mfma_f32_16x16x32_bf16 a[24:27], v[80:83], v[52:55], a[24:27]
    buffer_load_dwordx4 v[28:31], v1, s[16:19], s25 offen offset:1024
    v_mfma_f32_16x16x32_bf16 a[28:31], v[80:83], v[56:59], a[28:31]
    buffer_load_dwordx4 v[32:35], v1, s[16:19], s26 offen offset:0
    v_mfma_f32_16x16x32_bf16 a[32:35], v[80:83], v[60:63], a[32:35]
    buffer_load_dwordx4 v[36:39], v1, s[16:19], s26 offen offset:1024
    v_mfma_f32_16x16x32_bf16 a[36:39], v[80:83], v[64:67], a[36:39]
    buffer_load_dwordx4 v[40:43], v1, s[16:19], s26 offen offset:2048
    v_mfma_f32_16x16x32_bf16 a[40:43], v[80:83], v[68:71], a[40:43]
    buffer_load_dwordx4 v[44:47], v1, s[16:19], s26 offen offset:3072
    v_mfma_f32_16x16x32_bf16 a[44:47], v[80:83], v[72:75], a[44:47]
    buffer_load_dwordx4 v[48:51], v1, s[16:19], s27 offen offset:0
    v_mfma_f32_16x16x32_bf16 a[48:51], v[84:87], v[52:55], a[48:51]
    s_add_u32 s24, s24, 6144
    v_mfma_f32_16x16x32_bf16 a[52:55], v[84:87], v[56:59], a[52:55]
    s_add_u32 s25, s25, 6144
    v_mfma_f32_16x16x32_bf16 a[56:59], v[84:87], v[60:63], a[56:59]
    s_add_u32 s26, s26, 5120
    v_mfma_f32_16x16x32_bf16 a[60:63], v[84:87], v[64:67], a[60:63]
    s_add_u32 s27, s27, 5120
    v_mfma_f32_16x16x32_bf16 a[64:67], v[84:87], v[68:71], a[64:67]
    v_mfma_f32_16x16x32_bf16 a[68:71], v[84:87], v[72:75], a[68:71]
    v_mfma_f32_16x16x32_bf16 a[72:75], v[88:91], v[52:55], a[72:75]
    v_mfma_f32_16x16x32_bf16 a[76:79], v[88:91], v[56:59], a[76:79]
    v_mfma_f32_16x16x32_bf16 a[80:83], v[88:91], v[60:63], a[80:83]
    v_mfma_f32_16x16x32_bf16 a[84:87], v[88:91], v[64:67], a[84:87]
    v_mfma_f32_16x16x32_bf16 a[88:91], v[88:91], v[68:71], a[88:91]
    v_mfma_f32_16x16x32_bf16 a[92:95], v[88:91], v[72:75], a[92:95]
    v_mfma_f32_16x16x32_bf16 a[96:99], v[92:95], v[52:55], a[96:99]
    v_mfma_f32_16x16x32_bf16 a[100:103], v[92:95], v[56:59], a[100:103]
    v_mfma_f32_16x16x32_bf16 a[104:107], v[92:95], v[60:63], a[104:107]
    v_mfma_f32_16x16x32_bf16 a[108:111], v[92:95], v[64:67], a[108:111]
    v_mfma_f32_16x16x32_bf16 a[112:115], v[92:95], v[68:71], a[112:115]
    v_mfma_f32_16x16x32_bf16 a[116:119], v[92:95], v[72:75], a[116:119]
    s_waitcnt vmcnt(33)
    v_mfma_f32_16x16x32_bf16 a[0:3], v[120:123], v[96:99], a[0:3]
    v_mfma_f32_16x16x32_bf16 a[4:7], v[120:123], v[100:103], a[4:7]
    buffer_load_dwordx4 v[52:55], v1, s[16:19], s24 offen offset:0
    v_mfma_f32_16x16x32_bf16 a[8:11], v[120:123], v[104:107], a[8:11]
    buffer_load_dwordx4 v[56:59], v1, s[16:19], s24 offen offset:1024
    v_mfma_f32_16x16x32_bf16 a[12:15], v[120:123], v[108:111], a[12:15]
    buffer_load_dwordx4 v[60:63], v1, s[16:19], s24 offen offset:2048
    v_mfma_f32_16x16x32_bf16 a[16:19], v[120:123], v[112:115], a[16:19]
    buffer_load_dwordx4 v[64:67], v1, s[16:19], s24 offen offset:3072
    v_mfma_f32_16x16x32_bf16 a[20:23], v[120:123], v[116:119], a[20:23]
    buffer_load_dwordx4 v[68:71], v1, s[16:19], s25 offen offset:0
    v_mfma_f32_16x16x32_bf16 a[24:27], v[124:127], v[96:99], a[24:27]
    buffer_load_dwordx4 v[72:75], v1, s[16:19], s25 offen offset:1024
    v_mfma_f32_16x16x32_bf16 a[28:31], v[124:127], v[100:103], a[28:31]
    buffer_load_dwordx4 v[76:79], v1, s[16:19], s26 offen offset:0
    v_mfma_f32_16x16x32_bf16 a[32:35], v[124:127], v[104:107], a[32:35]
    buffer_load_dwordx4 v[80:83], v1, s[16:19], s26 offen offset:1024
    v_mfma_f32_16x16x32_bf16 a[36:39], v[124:127], v[108:111], a[36:39]
    buffer_load_dwordx4 v[84:87], v1, s[16:19], s26 offen offset:2048
    v_mfma_f32_16x16x32_bf16 a[40:43], v[124:127], v[112:115], a[40:43]
    buffer_load_dwordx4 v[88:91], v1, s[16:19], s26 offen offset:3072
    v_mfma_f32_16x16x32_bf16 a[44:47], v[124:127], v[116:119], a[44:47]
    buffer_load_dwordx4 v[92:95], v1, s[16:19], s27 offen offset:0
    v_mfma_f32_16x16x32_bf16 a[48:51], v[128:131], v[96:99], a[48:51]
    s_add_u32 s24, s24, 6144
    v_mfma_f32_16x16x32_bf16 a[52:55], v[128:131], v[100:103], a[52:55]
    s_add_u32 s25, s25, 6144
    v_mfma_f32_16x16x32_bf16 a[56:59], v[128:131], v[104:107], a[56:59]
    s_add_u32 s26, s26, 5120
    v_mfma_f32_16x16x32_bf16 a[60:63], v[128:131], v[108:111], a[60:63]
    s_add_u32 s27, s27, 5120
    v_mfma_f32_16x16x32_bf16 a[64:67], v[128:131], v[112:115], a[64:67]
    v_mfma_f32_16x16x32_bf16 a[68:71], v[128:131], v[116:119], a[68:71]
    v_mfma_f32_16x16x32_bf16 a[72:75], v[132:135], v[96:99], a[72:75]
    v_mfma_f32_16x16x32_bf16 a[76:79], v[132:135], v[100:103], a[76:79]
    v_mfma_f32_16x16x32_bf16 a[80:83], v[132:135], v[104:107], a[80:83]
    v_mfma_f32_16x16x32_bf16 a[84:87], v[132:135], v[108:111], a[84:87]
    v_mfma_f32_16x16x32_bf16 a[88:91], v[132:135], v[112:115], a[88:91]
    v_mfma_f32_16x16x32_bf16 a[92:95], v[132:135], v[116:119], a[92:95]
    v_mfma_f32_16x16x32_bf16 a[96:99], v[136:139], v[96:99], a[96:99]
    v_mfma_f32_16x16x32_bf16 a[100:103], v[136:139], v[100:103], a[100:103]
    v_mfma_f32_16x16x32_bf16 a[104:107], v[136:139], v[104:107], a[104:107]
    v_mfma_f32_16x16x32_bf16 a[108:111], v[136:139], v[108:111], a[108:111]
    v_mfma_f32_16x16x32_bf16 a[112:115], v[136:139], v[112:115], a[112:115]
    v_mfma_f32_16x16x32_bf16 a[116:119], v[136:139], v[116:119], a[116:119]
    s_waitcnt vmcnt(33)
    v_mfma_f32_16x16x32_bf16 a[0:3], v[164:167], v[140:143], a[0:3]
    v_mfma_f32_16x16x32_bf16 a[4:7], v[164:167], v[144:147], a[4:7]
    v_mfma_f32_16x16x32_bf16 a[8:11], v[164:167], v[148:151], a[8:11]
    v_mfma_f32_16x16x32_bf16 a[12:15], v[164:167], v[152:155], a[12:15]
    v_mfma_f32_16x16x32_bf16 a[16:19], v[164:167], v[156:159], a[16:19]
    v_mfma_f32_16x16x32_bf16 a[20:23], v[164:167], v[160:163], a[20:23]
    v_mfma_f32_16x16x32_bf16 a[24:27], v[168:171], v[140:143], a[24:27]
    v_mfma_f32_16x16x32_bf16 a[28:31], v[168:171], v[144:147], a[28:31]
    v_mfma_f32_16x16x32_bf16 a[32:35], v[168:171], v[148:151], a[32:35]
    v_mfma_f32_16x16x32_bf16 a[36:39], v[168:171], v[152:155], a[36:39]
    v_mfma_f32_16x16x32_bf16 a[40:43], v[168:171], v[156:159], a[40:43]
    v_mfma_f32_16x16x32_bf16 a[44:47], v[168:171], v[160:163], a[44:47]
    v_mfma_f32_16x16x32_bf16 a[48:51], v[172:175], v[140:143], a[48:51]
    v_mfma_f32_16x16x32_bf16 a[52:55], v[172:175], v[144:147], a[52:55]
    v_mfma_f32_16x16x32_bf16 a[56:59], v[172:175], v[148:151], a[56:59]
    v_mfma_f32_16x16x32_bf16 a[60:63], v[172:175], v[152:155], a[60:63]
    v_mfma_f32_16x16x32_bf16 a[64:67], v[172:175], v[156:159], a[64:67]
    v_mfma_f32_16x16x32_bf16 a[68:71], v[172:175], v[160:163], a[68:71]
    v_mfma_f32_16x16x32_bf16 a[72:75], v[176:179], v[140:143], a[72:75]
    v_mfma_f32_16x16x32_bf16 a[76:79], v[176:179], v[144:147], a[76:79]
    v_mfma_f32_16x16x32_bf16 a[80:83], v[176:179], v[148:151], a[80:83]
    v_mfma_f32_16x16x32_bf16 a[84:87], v[176:179], v[152:155], a[84:87]
    v_mfma_f32_16x16x32_bf16 a[88:91], v[176:179], v[156:159], a[88:91]
    v_mfma_f32_16x16x32_bf16 a[92:95], v[176:179], v[160:163], a[92:95]
    v_mfma_f32_16x16x32_bf16 a[96:99], v[180:183], v[140:143], a[96:99]
    v_mfma_f32_16x16x32_bf16 a[100:103], v[180:183], v[144:147], a[100:103]
    v_mfma_f32_16x16x32_bf16 a[104:107], v[180:183], v[148:151], a[104:107]
    v_mfma_f32_16x16x32_bf16 a[108:111], v[180:183], v[152:155], a[108:111]
    v_mfma_f32_16x16x32_bf16 a[112:115], v[180:183], v[156:159], a[112:115]
    v_mfma_f32_16x16x32_bf16 a[116:119], v[180:183], v[160:163], a[116:119]
    s_waitcnt vmcnt(22)
    v_mfma_f32_16x16x32_bf16 a[0:3], v[208:211], v[184:187], a[0:3]
    v_mfma_f32_16x16x32_bf16 a[4:7], v[208:211], v[188:191], a[4:7]
    v_mfma_f32_16x16x32_bf16 a[8:11], v[208:211], v[192:195], a[8:11]
    v_mfma_f32_16x16x32_bf16 a[12:15], v[208:211], v[196:199], a[12:15]
    v_mfma_f32_16x16x32_bf16 a[16:19], v[208:211], v[200:203], a[16:19]
    v_mfma_f32_16x16x32_bf16 a[20:23], v[208:211], v[204:207], a[20:23]
    v_mfma_f32_16x16x32_bf16 a[24:27], v[212:215], v[184:187], a[24:27]
    v_mfma_f32_16x16x32_bf16 a[28:31], v[212:215], v[188:191], a[28:31]
    v_mfma_f32_16x16x32_bf16 a[32:35], v[212:215], v[192:195], a[32:35]
    v_mfma_f32_16x16x32_bf16 a[36:39], v[212:215], v[196:199], a[36:39]
    v_mfma_f32_16x16x32_bf16 a[40:43], v[212:215], v[200:203], a[40:43]
    v_mfma_f32_16x16x32_bf16 a[44:47], v[212:215], v[204:207], a[44:47]
    v_mfma_f32_16x16x32_bf16 a[48:51], v[216:219], v[184:187], a[48:51]
    v_mfma_f32_16x16x32_bf16 a[52:55], v[216:219], v[188:191], a[52:55]
    v_mfma_f32_16x16x32_bf16 a[56:59], v[216:219], v[192:195], a[56:59]
    v_mfma_f32_16x16x32_bf16 a[60:63], v[216:219], v[196:199], a[60:63]
    v_mfma_f32_16x16x32_bf16 a[64:67], v[216:219], v[200:203], a[64:67]
    v_mfma_f32_16x16x32_bf16 a[68:71], v[216:219], v[204:207], a[68:71]
    v_mfma_f32_16x16x32_bf16 a[72:75], v[220:223], v[184:187], a[72:75]
    v_mfma_f32_16x16x32_bf16 a[76:79], v[220:223], v[188:191], a[76:79]
    v_mfma_f32_16x16x32_bf16 a[80:83], v[220:223], v[192:195], a[80:83]
    v_mfma_f32_16x16x32_bf16 a[84:87], v[220:223], v[196:199], a[84:87]
    v_mfma_f32_16x16x32_bf16 a[88:91], v[220:223], v[200:203], a[88:91]
    v_mfma_f32_16x16x32_bf16 a[92:95], v[220:223], v[204:207], a[92:95]
    v_mfma_f32_16x16x32_bf16 a[96:99], v[224:227], v[184:187], a[96:99]
    v_mfma_f32_16x16x32_bf16 a[100:103], v[224:227], v[188:191], a[100:103]
    v_mfma_f32_16x16x32_bf16 a[104:107], v[224:227], v[192:195], a[104:107]
    v_mfma_f32_16x16x32_bf16 a[108:111], v[224:227], v[196:199], a[108:111]
    v_mfma_f32_16x16x32_bf16 a[112:115], v[224:227], v[200:203], a[112:115]
    v_mfma_f32_16x16x32_bf16 a[116:119], v[224:227], v[204:207], a[116:119]
    s_waitcnt vmcnt(11)
    v_mfma_f32_16x16x32_bf16 a[0:3], v[32:35], v[8:11], a[0:3]
    v_mfma_f32_16x16x32_bf16 a[4:7], v[32:35], v[12:15], a[4:7]
    v_mfma_f32_16x16x32_bf16 a[8:11], v[32:35], v[16:19], a[8:11]
    v_mfma_f32_16x16x32_bf16 a[12:15], v[32:35], v[20:23], a[12:15]
    v_mfma_f32_16x16x32_bf16 a[16:19], v[32:35], v[24:27], a[16:19]
    v_mfma_f32_16x16x32_bf16 a[20:23], v[32:35], v[28:31], a[20:23]
    v_mfma_f32_16x16x32_bf16 a[24:27], v[36:39], v[8:11], a[24:27]
    v_mfma_f32_16x16x32_bf16 a[28:31], v[36:39], v[12:15], a[28:31]
    v_mfma_f32_16x16x32_bf16 a[32:35], v[36:39], v[16:19], a[32:35]
    v_mfma_f32_16x16x32_bf16 a[36:39], v[36:39], v[20:23], a[36:39]
    v_mfma_f32_16x16x32_bf16 a[40:43], v[36:39], v[24:27], a[40:43]
    v_mfma_f32_16x16x32_bf16 a[44:47], v[36:39], v[28:31], a[44:47]
    v_mfma_f32_16x16x32_bf16 a[48:51], v[40:43], v[8:11], a[48:51]
    v_mfma_f32_16x16x32_bf16 a[52:55], v[40:43], v[12:15], a[52:55]
    v_mfma_f32_16x16x32_bf16 a[56:59], v[40:43], v[16:19], a[56:59]
    v_mfma_f32_16x16x32_bf16 a[60:63], v[40:43], v[20:23], a[60:63]
    v_mfma_f32_16x16x32_bf16 a[64:67], v[40:43], v[24:27], a[64:67]
    v_mfma_f32_16x16x32_bf16 a[68:71], v[40:43], v[28:31], a[68:71]
    v_mfma_f32_16x16x32_bf16 a[72:75], v[44:47], v[8:11], a[72:75]
    v_mfma_f32_16x16x32_bf16 a[76:79], v[44:47], v[12:15], a[76:79]
    v_mfma_f32_16x16x32_bf16 a[80:83], v[44:47], v[16:19], a[80:83]
    v_mfma_f32_16x16x32_bf16 a[84:87], v[44:47], v[20:23], a[84:87]
    v_mfma_f32_16x16x32_bf16 a[88:91], v[44:47], v[24:27], a[88:91]
    v_mfma_f32_16x16x32_bf16 a[92:95], v[44:47], v[28:31], a[92:95]
    v_mfma_f32_16x16x32_bf16 a[96:99], v[48:51], v[8:11], a[96:99]
    v_mfma_f32_16x16x32_bf16 a[100:103], v[48:51], v[12:15], a[100:103]
    v_mfma_f32_16x16x32_bf16 a[104:107], v[48:51], v[16:19], a[104:107]
    v_mfma_f32_16x16x32_bf16 a[108:111], v[48:51], v[20:23], a[108:111]
    v_mfma_f32_16x16x32_bf16 a[112:115], v[48:51], v[24:27], a[112:115]
    v_mfma_f32_16x16x32_bf16 a[116:119], v[48:51], v[28:31], a[116:119]
    s_waitcnt vmcnt(0)
    v_mfma_f32_16x16x32_bf16 a[0:3], v[76:79], v[52:55], a[0:3]
    v_mfma_f32_16x16x32_bf16 a[4:7], v[76:79], v[56:59], a[4:7]
    v_mfma_f32_16x16x32_bf16 a[8:11], v[76:79], v[60:63], a[8:11]
    v_mfma_f32_16x16x32_bf16 a[12:15], v[76:79], v[64:67], a[12:15]
    v_mfma_f32_16x16x32_bf16 a[16:19], v[76:79], v[68:71], a[16:19]
    v_mfma_f32_16x16x32_bf16 a[20:23], v[76:79], v[72:75], a[20:23]
    v_mfma_f32_16x16x32_bf16 a[24:27], v[80:83], v[52:55], a[24:27]
    v_mfma_f32_16x16x32_bf16 a[28:31], v[80:83], v[56:59], a[28:31]
    v_mfma_f32_16x16x32_bf16 a[32:35], v[80:83], v[60:63], a[32:35]
    v_mfma_f32_16x16x32_bf16 a[36:39], v[80:83], v[64:67], a[36:39]
    v_mfma_f32_16x16x32_bf16 a[40:43], v[80:83], v[68:71], a[40:43]
    v_mfma_f32_16x16x32_bf16 a[44:47], v[80:83], v[72:75], a[44:47]
    v_mfma_f32_16x16x32_bf16 a[48:51], v[84:87], v[52:55], a[48:51]
    v_mfma_f32_16x16x32_bf16 a[52:55], v[84:87], v[56:59], a[52:55]
    v_mfma_f32_16x16x32_bf16 a[56:59], v[84:87], v[60:63], a[56:59]
    v_mfma_f32_16x16x32_bf16 a[60:63], v[84:87], v[64:67], a[60:63]
    v_mfma_f32_16x16x32_bf16 a[64:67], v[84:87], v[68:71], a[64:67]
    v_mfma_f32_16x16x32_bf16 a[68:71], v[84:87], v[72:75], a[68:71]
    v_mfma_f32_16x16x32_bf16 a[72:75], v[88:91], v[52:55], a[72:75]
    v_mfma_f32_16x16x32_bf16 a[76:79], v[88:91], v[56:59], a[76:79]
    v_mfma_f32_16x16x32_bf16 a[80:83], v[88:91], v[60:63], a[80:83]
    v_mfma_f32_16x16x32_bf16 a[84:87], v[88:91], v[64:67], a[84:87]
    v_mfma_f32_16x16x32_bf16 a[88:91], v[88:91], v[68:71], a[88:91]
    v_mfma_f32_16x16x32_bf16 a[92:95], v[88:91], v[72:75], a[92:95]
    v_mfma_f32_16x16x32_bf16 a[96:99], v[92:95], v[52:55], a[96:99]
    v_mfma_f32_16x16x32_bf16 a[100:103], v[92:95], v[56:59], a[100:103]
    v_mfma_f32_16x16x32_bf16 a[104:107], v[92:95], v[60:63], a[104:107]
    v_mfma_f32_16x16x32_bf16 a[108:111], v[92:95], v[64:67], a[108:111]
    v_mfma_f32_16x16x32_bf16 a[112:115], v[92:95], v[68:71], a[112:115]
    v_mfma_f32_16x16x32_bf16 a[116:119], v[92:95], v[72:75], a[116:119]
    s_nop 15
    s_mul_i32 s36, s6, 30720
    v_add_u32 v2, s36, v1
    ds_write_b128 v2, a[0:3] offset:0
    ds_write_b128 v2, a[4:7] offset:1024
    ds_write_b128 v2, a[8:11] offset:2048
    ds_write_b128 v2, a[12:15] offset:3072
    ds_write_b128 v2, a[16:19] offset:4096
    ds_write_b128 v2, a[20:23] offset:5120
    ds_write_b128 v2, a[24:27] offset:6144
    ds_write_b128 v2, a[28:31] offset:7168
    ds_write_b128 v2, a[32:35] offset:8192
    ds_write_b128 v2, a[36:39] offset:9216
    ds_write_b128 v2, a[40:43] offset:10240
    ds_write_b128 v2, a[44:47] offset:11264
    ds_write_b128 v2, a[48:51] offset:12288
    ds_write_b128 v2, a[52:55] offset:13312
    ds_write_b128 v2, a[56:59] offset:14336
    ds_write_b128 v2, a[60:63] offset:15360
    ds_write_b128 v2, a[64:67] offset:16384
    ds_write_b128 v2, a[68:71] offset:17408
    ds_write_b128 v2, a[72:75] offset:18432
    ds_write_b128 v2, a[76:79] offset:19456
    ds_write_b128 v2, a[80:83] offset:20480
    ds_write_b128 v2, a[84:87] offset:21504
    ds_write_b128 v2, a[88:91] offset:22528
    ds_write_b128 v2, a[92:95] offset:23552
    ds_write_b128 v2, a[96:99] offset:24576
    ds_write_b128 v2, a[100:103] offset:25600
    ds_write_b128 v2, a[104:107] offset:26624
    ds_write_b128 v2, a[108:111] offset:27648
    ds_write_b128 v2, a[112:115] offset:28672
    ds_write_b128 v2, a[116:119] offset:29696
    s_lshl_b32 s36, s6, 10
    v_add_u32 v2, s36, v1
    v_add_u32 v5, 61440, v2
    v_and_b32 v3, 15, v0
    v_mul_u32_u24 v3, 2560, v3
    v_lshrrev_b32 v4, 4, v0
    v_lshl_add_u32 v3, v4, 3, v3
    s_mul_i32 s37, s4, 245760
    s_mul_i32 s38, s3, 1280
    s_add_u32 s37, s37, s38
    s_mul_i32 s38, s5, 160
    s_add_u32 s37, s37, s38
    s_waitcnt lgkmcnt(0)
    s_barrier
    ds_read_b128 v[8:11], v2 offset:0
    ds_read_b128 v[12:15], v2 offset:30720
    ds_read_b128 v[16:19], v5 offset:0
    ds_read_b128 v[20:23], v5 offset:30720
    ds_read_b128 v[24:27], v2 offset:4096
    ds_read_b128 v[28:31], v2 offset:34816
    ds_read_b128 v[32:35], v5 offset:4096
    ds_read_b128 v[36:39], v5 offset:34816
    ds_read_b128 v[40:43], v2 offset:8192
    ds_read_b128 v[44:47], v2 offset:38912
    ds_read_b128 v[48:51], v5 offset:8192
    ds_read_b128 v[52:55], v5 offset:38912
    ds_read_b128 v[56:59], v2 offset:12288
    ds_read_b128 v[60:63], v2 offset:43008
    ds_read_b128 v[64:67], v5 offset:12288
    ds_read_b128 v[68:71], v5 offset:43008
    ds_read_b128 v[72:75], v2 offset:16384
    ds_read_b128 v[76:79], v2 offset:47104
    ds_read_b128 v[80:83], v5 offset:16384
    ds_read_b128 v[84:87], v5 offset:47104
    ds_read_b128 v[88:91], v2 offset:20480
    ds_read_b128 v[92:95], v2 offset:51200
    ds_read_b128 v[96:99], v5 offset:20480
    ds_read_b128 v[100:103], v5 offset:51200
    ds_read_b128 v[104:107], v2 offset:24576
    ds_read_b128 v[108:111], v2 offset:55296
    ds_read_b128 v[112:115], v5 offset:24576
    ds_read_b128 v[116:119], v5 offset:55296
    ds_read_b128 v[120:123], v2 offset:28672
    ds_read_b128 v[124:127], v2 offset:59392
    ds_read_b128 v[128:131], v5 offset:28672
    ds_read_b128 v[132:135], v5 offset:59392
    s_add_u32 s39, s6, 0
    s_mul_i32 s40, s39, 43
    s_lshr_b32 s40, s40, 8
    s_mul_i32 s41, s40, 6
    s_sub_u32 s41, s39, s41
    s_mul_i32 s41, s41, 40960
    s_lshl_b32 s40, s40, 5
    s_add_u32 s41, s41, s40
    s_add_u32 s41, s41, s37
    s_waitcnt lgkmcnt(15)
    v_add_f32 v8, v8, v12
    v_add_f32 v16, v16, v20
    v_add_f32 v9, v9, v13
    v_add_f32 v17, v17, v21
    v_add_f32 v10, v10, v14
    v_add_f32 v18, v18, v22
    v_add_f32 v11, v11, v15
    v_add_f32 v19, v19, v23
    v_add_f32 v8, v8, v16
    v_add_f32 v9, v9, v17
    v_add_f32 v10, v10, v18
    v_add_f32 v11, v11, v19
    v_cvt_pk_bf16_f32 v12, v8, v9
    v_cvt_pk_bf16_f32 v13, v10, v11
    buffer_store_dwordx2 v[12:13], v3, s[12:15], s41 offen
    s_add_u32 s39, s6, 4
    s_mul_i32 s40, s39, 43
    s_lshr_b32 s40, s40, 8
    s_mul_i32 s41, s40, 6
    s_sub_u32 s41, s39, s41
    s_mul_i32 s41, s41, 40960
    s_lshl_b32 s40, s40, 5
    s_add_u32 s41, s41, s40
    s_add_u32 s41, s41, s37
    s_waitcnt lgkmcnt(15)
    v_add_f32 v24, v24, v28
    v_add_f32 v32, v32, v36
    v_add_f32 v25, v25, v29
    v_add_f32 v33, v33, v37
    v_add_f32 v26, v26, v30
    v_add_f32 v34, v34, v38
    v_add_f32 v27, v27, v31
    v_add_f32 v35, v35, v39
    v_add_f32 v24, v24, v32
    v_add_f32 v25, v25, v33
    v_add_f32 v26, v26, v34
    v_add_f32 v27, v27, v35
    v_cvt_pk_bf16_f32 v28, v24, v25
    v_cvt_pk_bf16_f32 v29, v26, v27
    buffer_store_dwordx2 v[28:29], v3, s[12:15], s41 offen
    s_add_u32 s39, s6, 8
    s_mul_i32 s40, s39, 43
    s_lshr_b32 s40, s40, 8
    s_mul_i32 s41, s40, 6
    s_sub_u32 s41, s39, s41
    s_mul_i32 s41, s41, 40960
    s_lshl_b32 s40, s40, 5
    s_add_u32 s41, s41, s40
    s_add_u32 s41, s41, s37
    s_waitcnt lgkmcnt(15)
    v_add_f32 v40, v40, v44
    v_add_f32 v48, v48, v52
    v_add_f32 v41, v41, v45
    v_add_f32 v49, v49, v53
    v_add_f32 v42, v42, v46
    v_add_f32 v50, v50, v54
    v_add_f32 v43, v43, v47
    v_add_f32 v51, v51, v55
    v_add_f32 v40, v40, v48
    v_add_f32 v41, v41, v49
    v_add_f32 v42, v42, v50
    v_add_f32 v43, v43, v51
    v_cvt_pk_bf16_f32 v44, v40, v41
    v_cvt_pk_bf16_f32 v45, v42, v43
    buffer_store_dwordx2 v[44:45], v3, s[12:15], s41 offen
    s_add_u32 s39, s6, 12
    s_mul_i32 s40, s39, 43
    s_lshr_b32 s40, s40, 8
    s_mul_i32 s41, s40, 6
    s_sub_u32 s41, s39, s41
    s_mul_i32 s41, s41, 40960
    s_lshl_b32 s40, s40, 5
    s_add_u32 s41, s41, s40
    s_add_u32 s41, s41, s37
    s_waitcnt lgkmcnt(15)
    v_add_f32 v56, v56, v60
    v_add_f32 v64, v64, v68
    v_add_f32 v57, v57, v61
    v_add_f32 v65, v65, v69
    v_add_f32 v58, v58, v62
    v_add_f32 v66, v66, v70
    v_add_f32 v59, v59, v63
    v_add_f32 v67, v67, v71
    v_add_f32 v56, v56, v64
    v_add_f32 v57, v57, v65
    v_add_f32 v58, v58, v66
    v_add_f32 v59, v59, v67
    v_cvt_pk_bf16_f32 v60, v56, v57
    v_cvt_pk_bf16_f32 v61, v58, v59
    buffer_store_dwordx2 v[60:61], v3, s[12:15], s41 offen
    s_add_u32 s39, s6, 16
    s_mul_i32 s40, s39, 43
    s_lshr_b32 s40, s40, 8
    s_mul_i32 s41, s40, 6
    s_sub_u32 s41, s39, s41
    s_mul_i32 s41, s41, 40960
    s_lshl_b32 s40, s40, 5
    s_add_u32 s41, s41, s40
    s_add_u32 s41, s41, s37
    s_waitcnt lgkmcnt(12)
    v_add_f32 v72, v72, v76
    v_add_f32 v80, v80, v84
    v_add_f32 v73, v73, v77
    v_add_f32 v81, v81, v85
    v_add_f32 v74, v74, v78
    v_add_f32 v82, v82, v86
    v_add_f32 v75, v75, v79
    v_add_f32 v83, v83, v87
    v_add_f32 v72, v72, v80
    v_add_f32 v73, v73, v81
    v_add_f32 v74, v74, v82
    v_add_f32 v75, v75, v83
    v_cvt_pk_bf16_f32 v76, v72, v73
    v_cvt_pk_bf16_f32 v77, v74, v75
    buffer_store_dwordx2 v[76:77], v3, s[12:15], s41 offen
    s_add_u32 s39, s6, 20
    s_mul_i32 s40, s39, 43
    s_lshr_b32 s40, s40, 8
    s_mul_i32 s41, s40, 6
    s_sub_u32 s41, s39, s41
    s_mul_i32 s41, s41, 40960
    s_lshl_b32 s40, s40, 5
    s_add_u32 s41, s41, s40
    s_add_u32 s41, s41, s37
    s_waitcnt lgkmcnt(8)
    v_add_f32 v88, v88, v92
    v_add_f32 v96, v96, v100
    v_add_f32 v89, v89, v93
    v_add_f32 v97, v97, v101
    v_add_f32 v90, v90, v94
    v_add_f32 v98, v98, v102
    v_add_f32 v91, v91, v95
    v_add_f32 v99, v99, v103
    v_add_f32 v88, v88, v96
    v_add_f32 v89, v89, v97
    v_add_f32 v90, v90, v98
    v_add_f32 v91, v91, v99
    v_cvt_pk_bf16_f32 v92, v88, v89
    v_cvt_pk_bf16_f32 v93, v90, v91
    buffer_store_dwordx2 v[92:93], v3, s[12:15], s41 offen
    s_add_u32 s39, s6, 24
    s_mul_i32 s40, s39, 43
    s_lshr_b32 s40, s40, 8
    s_mul_i32 s41, s40, 6
    s_sub_u32 s41, s39, s41
    s_mul_i32 s41, s41, 40960
    s_lshl_b32 s40, s40, 5
    s_add_u32 s41, s41, s40
    s_add_u32 s41, s41, s37
    s_waitcnt lgkmcnt(4)
    v_add_f32 v104, v104, v108
    v_add_f32 v112, v112, v116
    v_add_f32 v105, v105, v109
    v_add_f32 v113, v113, v117
    v_add_f32 v106, v106, v110
    v_add_f32 v114, v114, v118
    v_add_f32 v107, v107, v111
    v_add_f32 v115, v115, v119
    v_add_f32 v104, v104, v112
    v_add_f32 v105, v105, v113
    v_add_f32 v106, v106, v114
    v_add_f32 v107, v107, v115
    v_cvt_pk_bf16_f32 v108, v104, v105
    v_cvt_pk_bf16_f32 v109, v106, v107
    buffer_store_dwordx2 v[108:109], v3, s[12:15], s41 offen
    s_cmp_ge_u32 s6, 2
    s_cbranch_scc1 L_k2_fin
    s_add_u32 s39, s6, 28
    s_mul_i32 s40, s39, 43
    s_lshr_b32 s40, s40, 8
    s_mul_i32 s41, s40, 6
    s_sub_u32 s41, s39, s41
    s_mul_i32 s41, s41, 40960
    s_lshl_b32 s40, s40, 5
    s_add_u32 s41, s41, s40
    s_add_u32 s41, s41, s37
    s_waitcnt lgkmcnt(0)
    v_add_f32 v120, v120, v124
    v_add_f32 v128, v128, v132
    v_add_f32 v121, v121, v125
    v_add_f32 v129, v129, v133
    v_add_f32 v122, v122, v126
    v_add_f32 v130, v130, v134
    v_add_f32 v123, v123, v127
    v_add_f32 v131, v131, v135
    v_add_f32 v120, v120, v128
    v_add_f32 v121, v121, v129
    v_add_f32 v122, v122, v130
    v_add_f32 v123, v123, v131
    v_cvt_pk_bf16_f32 v124, v120, v121
    v_cvt_pk_bf16_f32 v125, v122, v123
    buffer_store_dwordx2 v[124:125], v3, s[12:15], s41 offen
L_k2_fin:
L_k2_end:
    s_endpgm
.section .rodata,"a"
.p2align 6
.amdhsa_kernel attn_kernel
  .amdhsa_next_free_vgpr 168
  .amdhsa_next_free_sgpr 102
  .amdhsa_accum_offset 168
  .amdhsa_group_segment_fixed_size 0
  .amdhsa_kernarg_size 104
  .amdhsa_user_sgpr_count 2
  .amdhsa_user_sgpr_kernarg_segment_ptr 1
  .amdhsa_system_sgpr_workgroup_id_x 1
.end_amdhsa_kernel
.p2align 6
.amdhsa_kernel oproj_kernel
  .amdhsa_next_free_vgpr 348
  .amdhsa_next_free_sgpr 102
  .amdhsa_accum_offset 228
  .amdhsa_group_segment_fixed_size 0
  .amdhsa_kernarg_size 104
  .amdhsa_user_sgpr_count 2
  .amdhsa_user_sgpr_kernarg_segment_ptr 1
  .amdhsa_system_sgpr_workgroup_id_x 1
.end_amdhsa_kernel
```
